```python
import torch

def _softmax(x, axis=-1):
    return torch.softmax(x, dim=axis)
def _gelu(x):
    return torch.nn.functional.gelu(x, approximate="tanh")
def _silu(x):
    return torch.nn.functional.silu(x)
def _sigmoid(x):
    return torch.sigmoid(x)
def _layernorm(x, axis=-1, eps=1e-5):
    m = x.mean(dim=axis, keepdim=True)
    v = x.var(dim=axis, keepdim=True, unbiased=False)
    return (x - m) / torch.sqrt(v + eps)
def _scatter_add(tgt, idx, src, axis=0):
    return tgt.clone().index_add_(axis, idx, src)
def _segment_sum(src, seg, n):
    out = torch.zeros((n,) + src.shape[1:], dtype=src.dtype)
    return out.index_add_(0, seg, src)
def _pad(x, pw):
    flat = tuple(v for pair in reversed(pw) for v in pair)
    return torch.nn.functional.pad(x, flat)

kernel_name = 'parallel_sum__linear_kernel_hedgehog__dense_activation_squared_relu__prompt'

def setup_inputs():

    _w = (lambda a: (lambda t: t.to(torch.bfloat16) if t.is_floating_point() else t)(torch.as_tensor(a)))
    def _A_setup():
        B, S, D, H = 1, 2048, 1024, 32
        Dh = D // H
        return {
            "x": _w((lambda *s: torch.randn(*s, dtype=torch.bfloat16) * 0.05)(B, S, D)),
            "wqkv": _w((lambda *s: torch.randn(*s, dtype=torch.bfloat16) * 0.8)(D, 3 * D)),
            "w_phi": _w((lambda *s: torch.randn(*s, dtype=torch.bfloat16) * 0.8)(H, Dh, Dh) * (Dh ** -0.5)),
            "wo": _w((lambda *s: torch.randn(*s, dtype=torch.bfloat16) * 0.2)(D, D)),
        }
    _A_in = _A_setup()

    def _B_setup():
        B, S, D, F = 1, 2048, 1024, 3584
        return {
            "x": _w((lambda *s: torch.randn(*s, dtype=torch.bfloat16) * 0.05)(B, S, D)),
            "w1": _w((lambda *s: torch.randn(*s, dtype=torch.bfloat16) * 0.05)(D, F)),
            "b1": _w((lambda *s: torch.randn(*s, dtype=torch.bfloat16) * 1.6)(F)),
            "w2": _w((lambda *s: torch.randn(*s, dtype=torch.bfloat16) * 0.05)(F, D)),
            "b2": _w((lambda *s: torch.randn(*s, dtype=torch.bfloat16) * 12.8)(D)),
        }
    _B_in = _B_setup()

    return {
        "A_x": _A_in["x"],
        "A_wqkv": _A_in["wqkv"],
        "A_w_phi": _A_in["w_phi"],
        "A_wo": _A_in["wo"],
        "B_x": _B_in["x"],
        "B_w1": _B_in["w1"],
        "B_b1": _B_in["b1"],
        "B_w2": _B_in["w2"],
        "B_b2": _B_in["b2"],
    }

def reference(A_x, A_wqkv, A_w_phi, A_wo, B_x, B_w1, B_b1, B_w2, B_b2):
    def _A_ref(x, wqkv, w_phi, wo):
        B, S, D = x.shape
        H = 32; Dh = D // H
        qkv = (lambda x, *d: x.permute(*d))((x @ wqkv).reshape(B, S, 3, H, Dh), 2, 0, 3, 1, 4)
        q, k, v = qkv[0], qkv[1], qkv[2]
        pq = torch.einsum("bhsd,hdf->bhsf", q, w_phi)
        pk = torch.einsum("bhsd,hdf->bhsf", k, w_phi)
        phi_q = torch.concatenate([_softmax(pq, axis=-1), _softmax(-pq, axis=-1)], axis=-1)
        phi_k = torch.concatenate([_softmax(pk, axis=-1), _softmax(-pk, axis=-1)], axis=-1)
        kv = torch.einsum("bhsf,bhsd->bhfd", phi_k, v)
        z  = torch.einsum("bhsf->bhf", phi_k)
        num = torch.einsum("bhqf,bhfd->bhqd", phi_q, kv)
        den = torch.einsum("bhqf,bhf->bhq", phi_q, z)[..., None] + 1e-6
        o = num / den
        return (lambda x, *d: x.permute(*d))(o, 0, 2, 1, 3).reshape(B, S, D) @ wo

    def _B_ref(x, w1, b1, w2, b2):
        h = torch.einsum("bsd,df->bsf", x, w1) + b1
        zero = torch.zeros_like(h)
        r = torch.where(h > zero, h, zero)
        h = r * r
        out = torch.einsum("bsf,fd->bsd", h, w2) + b2
        return out

    x = A_x
    xn = _layernorm(x, axis=-1)
    return x + _A_ref(xn, A_wqkv, A_w_phi, A_wo) + _B_ref(xn, B_w1, B_b1, B_w2, B_b2)
```

```asm
; @launch kernel=fused_kernel grid=(256,1,1) block=(512,1,1) lds=163840
.amdgcn_target "amdgcn-amd-amdhsa--gfx950"
.text
.globl fused_kernel
.p2align 8
.type fused_kernel,@function
fused_kernel:
    s_cmp_ge_u32 s2, 256
    s_cbranch_scc1 L_done
    s_load_dwordx8 s[4:11], s[0:1], 0
    s_load_dwordx8 s[12:19], s[0:1], 40
    s_load_dwordx4 s[20:23], s[0:1], 80
    s_and_b32 s24, s2, 7
    s_lshr_b32 s25, s2, 3
    s_and_b32 s26, s24, 1
    s_lshl_b32 s26, s26, 2
    s_and_b32 s31, s25, 3
    s_add_u32 s26, s26, s31
    s_lshr_b32 s31, s25, 2
    s_lshr_b32 s27, s24, 1
    s_lshl_b32 s27, s27, 3
    s_add_u32 s27, s27, s31
    v_and_b32 v1, 63, v0
    v_lshrrev_b32 v2, 6, v0
    s_nop 0
    v_readfirstlane_b32 s28, v2
    v_and_b32 v3, 15, v1
    v_lshrrev_b32 v4, 4, v1
    v_lshlrev_b32 v11, 4, v1
    s_and_b32 s29, s28, 3
    s_lshr_b32 s30, s28, 2
    s_lshr_b32 s101, s27, 1
    s_and_b32 s100, s27, 1
    s_mul_i32 s33, s101, 448
    s_and_b32 s32, s101, 1
    s_lshl_b32 s98, s32, 6
    s_add_u32 s98, s98, s33
    s_mul_i32 s99, s32, 384
    s_sub_u32 s99, s33, s99
    s_add_u32 s99, s99, 384
    s_lshl_b32 s31, s100, 7
    s_sub_u32 s84, s98, s31
    s_add_u32 s84, s84, 256
    s_lshl_b32 s31, s100, 5
    s_add_u32 s85, s99, s31
    s_lshl_b32 s90, s26, 19
    s_lshl_b32 s31, s28, 16
    s_add_u32 s90, s90, s31
    s_add_u32 s91, s90, 0x8000
    s_lshl_b32 s92, s28, 13
    v_lshrrev_b32 v9, 3, v1
    v_lshlrev_b32 v9, 11, v9
    v_and_b32 v14, 7, v1
    v_xor_b32 v15, v14, v4
    v_lshl_add_u32 v9, v15, 4, v9
    v_xor_b32 v10, 64, v9
    v_add_u32 v10, 0x4000, v10
    s_and_b32 s31, s29, 1
    s_lshl_b32 s31, s31, 4
    s_lshr_b32 s32, s29, 1
    s_lshl_b32 s32, s32, 2
    s_add_u32 s31, s31, s32
    s_lshl_b32 s35, s30, 5
    s_add_u32 s31, s31, s35
    v_lshrrev_b32 v15, 5, v1
    v_bfe_u32 v16, v1, 3, 2
    v_lshl_add_u32 v15, v15, 3, v16
    v_lshlrev_b32 v16, 1, v4
    v_xor_b32 v16, v16, v14
    v_lshlrev_b32 v16, 4, v16
    s_movk_i32 s34, 6144
    v_mad_u32_u24 v5, v15, s34, v16
    s_lshl_b32 s32, s101, 7
    s_mul_i32 s64, s31, 6144
    s_add_u32 s64, s64, s32
    s_add_u32 s65, s64, 4096
    s_mul_i32 s33, s31, 7168
    s_add_u32 s33, s33, s98
    s_cmp_eq_u32 s100, 1
    s_cselect_b32 s65, s33, s65
    s_cselect_b32 s33, 0, 2048
    s_cselect_b32 s34, 7168, s34
    s_add_u32 s64, s64, s33
    v_mad_u32_u24 v6, v15, s34, v16
    s_lshl_b32 s68, s34, 6
    s_mul_i32 s33, s101, 448
    s_sub_u32 s31, s85, s33
    s_sub_u32 s31, s31, 128
    v_mov_b32 v20, s31
    s_sub_u32 s31, s84, s33
    v_mov_b32 v19, s31
    s_lshl_b32 s31, s29, 6
    v_add_u32 v14, s31, v1
    v_mul_u32_u24 v15, 0x199a, v14
    v_lshrrev_b32 v15, 16, v15
    v_mul_u32_u24 v16, 10, v15
    v_sub_u32 v16, v14, v16
    v_bfe_u32 v17, v15, 2, 2
    v_and_b32 v14, 3, v15
    v_lshl_add_u32 v17, v17, 3, v14
    v_lshrrev_b32 v14, 4, v15
    v_lshl_add_u32 v17, v14, 2, v17
    v_mul_u32_u24 v7, 7168, v17
    v_lshl_add_u32 v7, v16, 4, v7
    v_cmp_gt_u32 vcc, 8, v16
    s_nop 1
    v_cndmask_b32 v17, v20, v19, vcc
    v_add_u32 v7, v7, v17
    v_add_u32 v14, 256, v1
    v_mul_u32_u24 v15, 0x199a, v14
    v_lshrrev_b32 v15, 16, v15
    v_mul_u32_u24 v16, 10, v15
    v_sub_u32 v16, v14, v16
    v_bfe_u32 v17, v15, 2, 2
    v_and_b32 v14, 3, v15
    v_lshl_add_u32 v17, v17, 3, v14
    v_lshrrev_b32 v14, 4, v15
    v_lshl_add_u32 v17, v14, 2, v17
    v_mul_u32_u24 v8, 7168, v17
    v_lshl_add_u32 v8, v16, 4, v8
    v_cmp_gt_u32 vcc, 8, v16
    s_nop 1
    v_cndmask_b32 v17, v20, v19, vcc
    v_add_u32 v8, v8, v17
    s_mul_i32 s66, s35, 7168
    s_add_u32 s66, s66, s33
    s_mov_b32 s3, s24
    s_mul_i32 s31, s3, 786432
    s_add_u32 s64, s64, s31
    s_lshl_b32 s31, s68, 1
    s_mul_i32 s31, s31, s3
    s_add_u32 s65, s65, s31
    s_mul_i32 s31, s3, 917504
    s_add_u32 s66, s66, s31
    s_lshl_b32 s31, s3, 8
    s_add_u32 s90, s90, s31
    s_add_u32 s91, s91, s31
    s_sub_u32 s76, 6, s3
    s_mov_b32 s67, s66
    s_mov_b32 s69, 458752
    s_mul_i32 s88, s30, 13312
    s_lshl_b32 s31, s29, 10
    s_add_u32 s88, s88, s31
    s_add_u32 s88, s88, 65536
    s_add_u32 s87, s31, 158720
    s_mov_b32 s39, 0x00020000
    s_mov_b32 s43, 0x00020000
    s_mov_b32 s47, 0x00020000
    s_mov_b32 s51, 0x00020000
    s_mov_b32 s55, 0x00020000
    s_mov_b32 s38, 6291456
    s_mov_b32 s46, 7340032
    s_mov_b32 s54, 4194304
    s_cmp_eq_u32 s29, 0
    s_cselect_b32 s50, s46, 0
    s_cmp_eq_u32 s100, 1
    s_cselect_b32 s42, s46, s38
    s_waitcnt lgkmcnt(0)
    s_cselect_b32 s40, s12, s6
    s_cselect_b32 s41, s13, s7
    s_mov_b32 s36, s6
    s_mov_b32 s37, s7
    s_mov_b32 s44, s12
    s_mov_b32 s45, s13
    s_mov_b32 s48, s12
    s_mov_b32 s49, s13
    s_mov_b32 s52, s4
    s_mov_b32 s53, s5
    s_mov_b32 m0, s88
    s_nop 0
    buffer_load_dwordx4 v5, s[36:39], s64 offen sc1 lds
    s_add_u32 s64, s64, 393216
    s_add_u32 m0, s88, 4096
    s_nop 0
    buffer_load_dwordx4 v6, s[40:43], s65 offen sc1 lds
    s_add_u32 s65, s65, s68
    s_add_u32 m0, s88, 8192
    s_nop 0
    buffer_load_dwordx4 v7, s[44:47], s66 offen sc1 lds
    s_add_u32 s66, s66, 458752
    s_add_u32 s89, s88, 12288
    s_cmp_eq_u32 s29, 0
    s_cselect_b32 m0, s89, 158720
    s_nop 0
    buffer_load_dwordx4 v8, s[48:51], s67 offen sc1 lds
    s_add_u32 s67, s67, s69
    s_add_u32 s88, s88, 26624
    s_sub_u32 s89, s88, 93184
    s_cmp_ge_u32 s88, s87
    s_cselect_b32 s88, s89, s88
    s_add_u32 m0, s92, 0
    s_nop 0
    buffer_load_dwordx4 v9, s[52:55], s90 offen lds
    s_add_u32 m0, s92, 1024
    s_nop 0
    buffer_load_dwordx4 v10, s[52:55], s90 offen lds
    s_add_u32 s90, s90, 128
    s_add_u32 m0, s92, 2048
    s_nop 0
    buffer_load_dwordx4 v9, s[52:55], s91 offen lds
    s_add_u32 m0, s92, 3072
    s_nop 0
    buffer_load_dwordx4 v10, s[52:55], s91 offen lds
    s_add_u32 s91, s91, 128
    s_mov_b32 m0, s88
    s_nop 0
    buffer_load_dwordx4 v5, s[36:39], s64 offen sc1 lds
    s_add_u32 s64, s64, 393216
    s_add_u32 m0, s88, 4096
    s_nop 0
    buffer_load_dwordx4 v6, s[40:43], s65 offen sc1 lds
    s_add_u32 s65, s65, s68
    s_add_u32 m0, s88, 8192
    s_nop 0
    buffer_load_dwordx4 v7, s[44:47], s66 offen sc1 lds
    s_add_u32 s66, s66, 458752
    s_add_u32 s89, s88, 12288
    s_cmp_eq_u32 s29, 0
    s_cselect_b32 m0, s89, 158720
    s_nop 0
    buffer_load_dwordx4 v8, s[48:51], s67 offen sc1 lds
    s_add_u32 s67, s67, s69
    s_add_u32 s88, s88, 26624
    s_sub_u32 s89, s88, 93184
    s_cmp_ge_u32 s88, s87
    s_cselect_b32 s88, s89, s88
    s_add_u32 m0, s92, 4096
    s_nop 0
    buffer_load_dwordx4 v9, s[52:55], s90 offen lds
    s_add_u32 m0, s92, 5120
    s_nop 0
    buffer_load_dwordx4 v10, s[52:55], s90 offen lds
    s_add_u32 s90, s90, 128
    s_add_u32 m0, s92, 6144
    s_nop 0
    buffer_load_dwordx4 v9, s[52:55], s91 offen lds
    s_add_u32 m0, s92, 7168
    s_nop 0
    buffer_load_dwordx4 v10, s[52:55], s91 offen lds
    s_add_u32 s91, s91, 128
    s_lshl_b32 s31, s26, 8
    s_lshl_b32 s32, s27, 3
    s_add_u32 s80, s31, s32
    s_add_u32 s80, s80, s28
    s_lshl_b32 s34, s80, 11
    buffer_load_dwordx4 v[244:247], v11, s[52:55], s34 offen
    buffer_load_dwordx4 v[248:251], v11, s[52:55], s34 offen offset:1024
    s_mov_b32 s56, s22
    s_mov_b32 s57, s23
    s_mov_b32 s58, 58720256
    s_mov_b32 s59, 0x00020000
    v_bfe_u32 v14, v3, 1, 3
    v_xor_b32 v14, v14, v4
    v_lshlrev_b32 v12, 7, v3
    v_lshl_add_u32 v12, v14, 4, v12
    v_add_u32 v12, s92, v12
    v_xor_b32 v13, 64, v12
    v_lshrrev_b32 v14, 2, v1
    v_and_b32 v15, 3, v1
    v_lshlrev_b32 v15, 3, v15
    v_lshl_add_u32 v18, v14, 7, v15
    v_bfe_u32 v16, v1, 3, 2
    v_lshl_add_u32 v18, v16, 5, v18
    v_add_u32 v18, 65536, v18
    v_xor_b32 v19, 32, v18
    v_xor_b32 v21, 64, v18
    v_xor_b32 v22, 96, v18
    v_mul_u32_u24 v23, 160, v14
    v_add_u32 v23, v23, v15
    v_add_u32 v23, 73728, v23
    s_mov_b32 s93, 0
    s_mov_b32 s94, 0
    s_mov_b32 s95, 13312
    v_mov_b32 v20, 0x40000000
    s_lshr_b32 s31, s24, 1
    s_mul_i32 s33, s25, 28
    s_mul_i32 s34, s29, 14
    s_add_u32 s33, s33, s34
    s_mul_i32 s34, s31, 14336
    s_add_u32 s33, s33, s34
    s_sub_u32 s33, s33, 14
    s_lshl_b32 s34, s31, 12
    s_lshl_b32 s35, s25, 3
    s_add_u32 s34, s34, s35
    s_cmp_eq_u32 s28, 3
    s_cselect_b32 s33, s34, s33
    s_cselect_b32 s34, 8, 14
    s_cselect_b32 s35, 2, 7
    s_cselect_b32 s60, s10, s16
    s_cselect_b32 s61, s11, s17
    s_mov_b32 s62, 7340032
    s_cselect_b32 s62, 0x200000, s62
    s_lshl_b32 s33, s33, 7
    s_lshl_b32 s35, s35, 14
    s_lshl_b32 s31, s26, 3
    s_and_b32 s32, s27, 3
    s_lshl_b32 s32, s32, 1
    s_add_u32 s31, s31, s32
    s_add_u32 s31, s31, s29
    s_sub_u32 s31, s31, 1
    s_lshl_b32 s31, s31, 16
    s_add_u32 s31, s31, 0
    s_cmp_eq_u32 s30, 1
    s_cselect_b32 s33, s31, s33
    s_cselect_b32 s34, 32, s34
    s_cselect_b32 s35, 128, s35
    s_cselect_b32 s60, s4, s60
    s_cselect_b32 s61, s5, s61
    s_cselect_b32 s62, 0, s62
    s_cselect_b32 s32, 11, 7
    s_cmp_eq_u32 s28, 7
    s_cselect_b32 s62, 0, s62
    v_lshlrev_b32 v14, s32, v1
    v_cmp_gt_u32 vcc, s34, v1
    s_nop 1
    v_cndmask_b32 v14, v20, v14, vcc
    s_cmp_eq_u32 s29, 0
    s_cselect_b32 s48, s48, s60
    s_cselect_b32 s49, s49, s61
    s_cselect_b32 s50, s50, s62
    s_cselect_b32 s67, s67, s33
    s_cselect_b32 s69, s69, s35
    s_cselect_b32 s96, 7340032, 0
    s_cselect_b64 vcc, -1, 0
    v_cndmask_b32 v8, v14, v8, vcc
    s_lshr_b32 s31, s28, 1
    s_lshl_b32 s32, s101, 7
    s_add_u32 s33, s32, 4096
    s_add_u32 s34, s32, 2048
    s_cmp_eq_u32 s100, 1
    s_cselect_b32 s33, s98, s33
    s_cselect_b32 s32, s32, s34
    s_cselect_b32 s35, 1, 2
    s_cmp_eq_u32 s31, 1
    s_cselect_b32 s86, s33, s32
    s_cmp_eq_u32 s31, 2
    s_cselect_b32 s86, s84, s86
    s_cmp_eq_u32 s31, 3
    s_cselect_b32 s86, s85, s86
    s_cselect_b32 s34, 2, 8
    s_cmp_lt_u32 s31, s35
    s_cselect_b32 s60, s6, s12
    s_cselect_b32 s61, s7, s13
    s_cselect_b32 s62, s38, s46
    s_mov_b32 s63, 0x00020000
    s_movk_i32 s33, 7168
    s_cselect_b32 s33, 6144, s33
    s_mov_b32 s78, 36831232
    s_cselect_b32 s78, 36700160, s78
    s_add_u32 s78, s78, s86
    s_lshl_b32 s31, s26, 1
    s_and_b32 s32, s28, 1
    s_add_u32 s31, s31, s32
    s_mul_i32 s32, s31, s33
    s_add_u32 s78, s78, s32
    s_lshl_b32 s32, s32, 3
    s_add_u32 s86, s86, s32
    v_lshrrev_b32 v14, 3, v1
    v_mul_lo_u32 v252, v14, s33
    v_and_b32 v14, 7, v1
    v_lshl_add_u32 v252, v14, 4, v252
    v_cmp_gt_u32 vcc, s34, v14
    s_nop 1
    v_cndmask_b32 v252, v20, v252, vcc
    s_lshl_b32 s79, s33, 7
    v_lshlrev_b32 v253, 4, v3
    v_lshl_add_u32 v253, v4, 3, v253
    v_cmp_gt_u32 vcc, s34, v3
    s_nop 1
    v_cndmask_b32 v253, v20, v253, vcc
    v_cmp_gt_u32 vcc, 2, v4
    s_nop 1
    v_cndmask_b32 v253, v20, v253, vcc
    v_mov_b32 v24, 0
    v_mov_b32 v25, 0
    v_mov_b32 v26, 0
    v_mov_b32 v27, 0
    v_mov_b32 v28, 0
    v_mov_b32 v29, 0
    v_mov_b32 v30, 0
    v_mov_b32 v31, 0
    v_mov_b32 v32, 0
    v_mov_b32 v33, 0
    v_mov_b32 v34, 0
    v_mov_b32 v35, 0
    v_mov_b32 v36, 0
    v_mov_b32 v37, 0
    v_mov_b32 v38, 0
    v_mov_b32 v39, 0
    v_mov_b32 v40, 0
    v_mov_b32 v41, 0
    v_mov_b32 v42, 0
    v_mov_b32 v43, 0
    v_mov_b32 v44, 0
    v_mov_b32 v45, 0
    v_mov_b32 v46, 0
    v_mov_b32 v47, 0
    v_mov_b32 v48, 0
    v_mov_b32 v49, 0
    v_mov_b32 v50, 0
    v_mov_b32 v51, 0
    v_mov_b32 v52, 0
    v_mov_b32 v53, 0
    v_mov_b32 v54, 0
    v_mov_b32 v55, 0
    v_mov_b32 v56, 0
    v_mov_b32 v57, 0
    v_mov_b32 v58, 0
    v_mov_b32 v59, 0
    v_mov_b32 v60, 0
    v_mov_b32 v61, 0
    v_mov_b32 v62, 0
    v_mov_b32 v63, 0
    v_mov_b32 v64, 0
    v_mov_b32 v65, 0
    v_mov_b32 v66, 0
    v_mov_b32 v67, 0
    v_mov_b32 v68, 0
    v_mov_b32 v69, 0
    v_mov_b32 v70, 0
    v_mov_b32 v71, 0
    v_mov_b32 v72, 0
    v_mov_b32 v73, 0
    v_mov_b32 v74, 0
    v_mov_b32 v75, 0
    v_mov_b32 v76, 0
    v_mov_b32 v77, 0
    v_mov_b32 v78, 0
    v_mov_b32 v79, 0
    v_mov_b32 v80, 0
    v_mov_b32 v81, 0
    v_mov_b32 v82, 0
    v_mov_b32 v83, 0
    v_mov_b32 v84, 0
    v_mov_b32 v85, 0
    v_mov_b32 v86, 0
    v_mov_b32 v87, 0
    v_mov_b32 v88, 0
    v_mov_b32 v89, 0
    v_mov_b32 v90, 0
    v_mov_b32 v91, 0
    v_mov_b32 v92, 0
    v_mov_b32 v93, 0
    v_mov_b32 v94, 0
    v_mov_b32 v95, 0
    v_mov_b32 v96, 0
    v_mov_b32 v97, 0
    v_mov_b32 v98, 0
    v_mov_b32 v99, 0
    v_mov_b32 v100, 0
    v_mov_b32 v101, 0
    v_mov_b32 v102, 0
    v_mov_b32 v103, 0
    v_mov_b32 v104, 0
    v_mov_b32 v105, 0
    v_mov_b32 v106, 0
    v_mov_b32 v107, 0
    v_mov_b32 v108, 0
    v_mov_b32 v109, 0
    v_mov_b32 v110, 0
    v_mov_b32 v111, 0
    v_mov_b32 v112, 0
    v_mov_b32 v113, 0
    v_mov_b32 v114, 0
    v_mov_b32 v115, 0
    v_mov_b32 v116, 0
    v_mov_b32 v117, 0
    v_mov_b32 v118, 0
    v_mov_b32 v119, 0
    v_mov_b32 v120, 0
    v_mov_b32 v121, 0
    v_mov_b32 v122, 0
    v_mov_b32 v123, 0
    v_mov_b32 v124, 0
    v_mov_b32 v125, 0
    v_mov_b32 v126, 0
    v_mov_b32 v127, 0
    s_mov_b32 s97, -1
    s_lshl_b32 s32, s68, 4
    s_cmp_eq_u32 s97, s76
    s_cselect_b32 s31, 6291456, 0
    s_cselect_b32 s32, s32, 0
    s_cselect_b32 s33, 7340032, 0
    s_cselect_b32 s34, s96, 0
    s_sub_u32 s64, s64, s31
    s_sub_u32 s65, s65, s32
    s_sub_u32 s66, s66, s33
    s_sub_u32 s67, s67, s34
    s_cmp_eq_u32 s97, s76
    s_cselect_b32 s31, 2048, 0
    s_sub_u32 s90, s90, s31
    s_sub_u32 s91, s91, s31
    s_mov_b32 s97, 0
    s_waitcnt vmcnt(10)
    s_barrier
    ds_read_b128 v[180:183], v12 offset:0
    ds_read_b128 v[184:187], v12 offset:2048
    ds_read_b128 v[188:191], v13 offset:0
    ds_read_b128 v[192:195], v13 offset:2048
    ds_read_b64_tr_b16 v[128:129], v18 offset:0
    ds_read_b64_tr_b16 v[130:131], v18 offset:2048
    ds_read_b64_tr_b16 v[132:133], v19 offset:0
    ds_read_b64_tr_b16 v[134:135], v19 offset:2048
    ds_read_b64_tr_b16 v[136:137], v21 offset:0
    ds_read_b64_tr_b16 v[138:139], v21 offset:2048
    ds_read_b64_tr_b16 v[140:141], v22 offset:0
    ds_read_b64_tr_b16 v[142:143], v22 offset:2048
    ds_read_b64_tr_b16 v[144:145], v18 offset:4096
    ds_read_b64_tr_b16 v[146:147], v18 offset:6144
    ds_read_b64_tr_b16 v[148:149], v19 offset:4096
    ds_read_b64_tr_b16 v[150:151], v19 offset:6144
    s_cmp_lt_u32 s28, 4
    s_cbranch_scc1 L_grpX
    s_waitcnt lgkmcnt(10)
    v_mfma_f32_16x16x32_bf16 v[24:27], v[128:131], v[180:183], v[24:27]
    ds_read_b64_tr_b16 v[152:153], v21 offset:4096
    v_mfma_f32_16x16x32_bf16 v[28:31], v[128:131], v[184:187], v[28:31]
    ds_read_b64_tr_b16 v[154:155], v21 offset:6144
    s_mov_b32 m0, s88
    s_nop 0
    buffer_load_dwordx4 v5, s[36:39], s64 offen sc1 lds
    s_add_u32 s64, s64, 393216
    s_waitcnt lgkmcnt(10)
    v_mfma_f32_16x16x32_bf16 v[32:35], v[132:135], v[180:183], v[32:35]
    ds_read_b64_tr_b16 v[156:157], v22 offset:4096
    v_mfma_f32_16x16x32_bf16 v[36:39], v[132:135], v[184:187], v[36:39]
    ds_read_b64_tr_b16 v[158:159], v22 offset:6144
    v_add_u32 v23, s94, v23
    s_waitcnt lgkmcnt(10)
    v_mfma_f32_16x16x32_bf16 v[40:43], v[136:139], v[180:183], v[40:43]
    ds_read_b64_tr_b16 v[160:161], v23 offset:0
    v_mfma_f32_16x16x32_bf16 v[44:47], v[136:139], v[184:187], v[44:47]
    ds_read_b64_tr_b16 v[162:163], v23 offset:2560
    s_add_u32 m0, s88, 4096
    s_nop 0
    buffer_load_dwordx4 v6, s[40:43], s65 offen sc1 lds
    s_add_u32 s65, s65, s68
    s_waitcnt lgkmcnt(10)
    v_mfma_f32_16x16x32_bf16 v[48:51], v[140:143], v[180:183], v[48:51]
    ds_read_b64_tr_b16 v[164:165], v23 offset:32
    v_mfma_f32_16x16x32_bf16 v[52:55], v[140:143], v[184:187], v[52:55]
    ds_read_b64_tr_b16 v[166:167], v23 offset:2592
    s_waitcnt lgkmcnt(10)
    v_mfma_f32_16x16x32_bf16 v[56:59], v[144:147], v[180:183], v[56:59]
    ds_read_b64_tr_b16 v[168:169], v23 offset:64
    v_mfma_f32_16x16x32_bf16 v[60:63], v[144:147], v[184:187], v[60:63]
    ds_read_b64_tr_b16 v[170:171], v23 offset:2624
    s_add_u32 m0, s88, 8192
    s_nop 0
    buffer_load_dwordx4 v7, s[44:47], s66 offen sc1 lds
    s_add_u32 s66, s66, 458752
    s_add_u32 s93, s93, 1
    s_cmp_eq_u32 s93, 7
    s_cselect_b32 s94, 4294887424, s95
    s_cselect_b32 s93, 0, s93
    s_waitcnt lgkmcnt(10)
    v_mfma_f32_16x16x32_bf16 v[64:67], v[148:151], v[180:183], v[64:67]
    ds_read_b64_tr_b16 v[172:173], v23 offset:96
    v_mfma_f32_16x16x32_bf16 v[68:71], v[148:151], v[184:187], v[68:71]
    ds_read_b64_tr_b16 v[174:175], v23 offset:2656
    s_waitcnt lgkmcnt(10)
    v_mfma_f32_16x16x32_bf16 v[72:75], v[152:155], v[180:183], v[72:75]
    ds_read_b64_tr_b16 v[176:177], v23 offset:128
    v_mfma_f32_16x16x32_bf16 v[76:79], v[152:155], v[184:187], v[76:79]
    ds_read_b64_tr_b16 v[178:179], v23 offset:2688
    s_add_u32 s89, s88, 12288
    s_cmp_eq_u32 s29, 0
    s_cselect_b32 m0, s89, 158720
    s_nop 0
    buffer_load_dwordx4 v8, s[48:51], s67 offen sc1 lds
    s_add_u32 s67, s67, s69
    s_add_u32 s88, s88, 26624
    s_sub_u32 s89, s88, 93184
    s_cmp_ge_u32 s88, s87
    s_cselect_b32 s88, s89, s88
    s_waitcnt vmcnt(10)
    s_barrier
    v_add_u32 v18, s94, v18
    s_waitcnt lgkmcnt(10)
    v_mfma_f32_16x16x32_bf16 v[80:83], v[156:159], v[180:183], v[80:83]
    ds_read_b64_tr_b16 v[128:129], v18 offset:0
    v_mfma_f32_16x16x32_bf16 v[84:87], v[156:159], v[184:187], v[84:87]
    ds_read_b64_tr_b16 v[130:131], v18 offset:2048
    s_add_u32 m0, s92, 0
    s_nop 0
    buffer_load_dwordx4 v9, s[52:55], s90 offen lds
    v_add_u32 v19, s94, v19
    s_waitcnt lgkmcnt(10)
    v_mfma_f32_16x16x32_bf16 v[88:91], v[160:163], v[180:183], v[88:91]
    ds_read_b64_tr_b16 v[132:133], v19 offset:0
    v_mfma_f32_16x16x32_bf16 v[92:95], v[160:163], v[184:187], v[92:95]
    ds_read_b64_tr_b16 v[134:135], v19 offset:2048
    s_add_u32 m0, s92, 1024
    s_nop 0
    buffer_load_dwordx4 v10, s[52:55], s90 offen lds
    s_add_u32 s90, s90, 128
    v_add_u32 v21, s94, v21
    s_waitcnt lgkmcnt(10)
    v_mfma_f32_16x16x32_bf16 v[96:99], v[164:167], v[180:183], v[96:99]
    ds_read_b64_tr_b16 v[136:137], v21 offset:0
    v_mfma_f32_16x16x32_bf16 v[100:103], v[164:167], v[184:187], v[100:103]
    ds_read_b64_tr_b16 v[138:139], v21 offset:2048
    s_mov_b32 m0, s88
    s_nop 0
    buffer_load_dwordx4 v5, s[36:39], s64 offen sc1 lds
    s_add_u32 s64, s64, 393216
    s_add_u32 m0, s92, 2048
    s_nop 0
    buffer_load_dwordx4 v9, s[52:55], s91 offen lds
    v_add_u32 v22, s94, v22
    s_waitcnt lgkmcnt(10)
    v_mfma_f32_16x16x32_bf16 v[104:107], v[168:171], v[180:183], v[104:107]
    ds_read_b64_tr_b16 v[140:141], v22 offset:0
    v_mfma_f32_16x16x32_bf16 v[108:111], v[168:171], v[184:187], v[108:111]
    ds_read_b64_tr_b16 v[142:143], v22 offset:2048
    s_add_u32 m0, s92, 3072
    s_nop 0
    buffer_load_dwordx4 v10, s[52:55], s91 offen lds
    s_add_u32 s91, s91, 128
    s_waitcnt lgkmcnt(10)
    v_mfma_f32_16x16x32_bf16 v[112:115], v[172:175], v[180:183], v[112:115]
    ds_read_b64_tr_b16 v[144:145], v18 offset:4096
    v_mfma_f32_16x16x32_bf16 v[116:119], v[172:175], v[184:187], v[116:119]
    ds_read_b64_tr_b16 v[146:147], v18 offset:6144
    s_add_u32 m0, s88, 4096
    s_nop 0
    buffer_load_dwordx4 v6, s[40:43], s65 offen sc1 lds
    s_add_u32 s65, s65, s68
    s_add_u32 s31, s3, 2
    s_and_b32 s31, s31, 7
    s_mul_i32 s31, s79, s31
    s_add_u32 s31, s31, s86
    buffer_load_dwordx4 v[220:223], v252, s[60:63], s31 offen
    s_waitcnt lgkmcnt(10)
    v_mfma_f32_16x16x32_bf16 v[120:123], v[176:179], v[180:183], v[120:123]
    ds_read_b64_tr_b16 v[148:149], v19 offset:4096
    v_mfma_f32_16x16x32_bf16 v[124:127], v[176:179], v[184:187], v[124:127]
    ds_read_b64_tr_b16 v[150:151], v19 offset:6144
    s_waitcnt vmcnt(13)
    ds_read_b128 v[196:199], v12 offset:4096
    s_waitcnt lgkmcnt(11)
    v_mfma_f32_16x16x32_bf16 v[24:27], v[128:131], v[188:191], v[24:27]
    ds_read_b64_tr_b16 v[152:153], v21 offset:4096
    v_mfma_f32_16x16x32_bf16 v[28:31], v[128:131], v[192:195], v[28:31]
    ds_read_b64_tr_b16 v[154:155], v21 offset:6144
    ds_read_b128 v[200:203], v12 offset:6144
    s_lshr_b32 s31, s27, 3
    s_lshl_b32 s31, s31, 3
    s_add_u32 s31, s31, s26
    s_lshl_b32 s31, s31, 3
    s_add_u32 s31, s31, s28
    s_lshl_b32 s31, s31, 7
    s_add_u32 s83, s31, 39845888
    s_and_b32 s32, s27, 7
    s_lshl_b32 s32, s32, 2
    s_add_u32 s81, s83, s32
    v_mov_b32 v14, v20
    v_writelane_b32 v14, s81, 0
    s_add_u32 s31, s81, 64
    v_writelane_b32 v14, s31, 2
    s_lshr_b32 s32, s32, 3
    s_lshl_b32 s32, s32, 2
    s_add_u32 s82, s83, s32
    s_add_u32 s82, s82, 32
    s_cmp_eq_u32 s100, 1
    s_cselect_b32 s31, s82, s81
    v_writelane_b32 v14, s31, 1
    s_getreg_b32 s31, hwreg(HW_REG_XCC_ID, 0, 16)
    v_mov_b32 v15, 0
    v_writelane_b32 v15, s31, 2
    buffer_store_dword v15, v14, s[56:59], 0 offen sc1
    s_waitcnt lgkmcnt(12)
    v_mfma_f32_16x16x32_bf16 v[32:35], v[132:135], v[188:191], v[32:35]
    ds_read_b64_tr_b16 v[156:157], v22 offset:4096
    v_mfma_f32_16x16x32_bf16 v[36:39], v[132:135], v[192:195], v[36:39]
    ds_read_b64_tr_b16 v[158:159], v22 offset:6144
    s_add_u32 m0, s88, 8192
    s_nop 0
    buffer_load_dwordx4 v7, s[44:47], s66 offen sc1 lds
    s_add_u32 s66, s66, 458752
    v_add_u32 v23, s94, v23
    s_waitcnt lgkmcnt(12)
    v_mfma_f32_16x16x32_bf16 v[40:43], v[136:139], v[188:191], v[40:43]
    ds_read_b64_tr_b16 v[160:161], v23 offset:0
    v_mfma_f32_16x16x32_bf16 v[44:47], v[136:139], v[192:195], v[44:47]
    ds_read_b64_tr_b16 v[162:163], v23 offset:2560
    ds_read_b128 v[204:207], v13 offset:4096
    s_waitcnt lgkmcnt(13)
    v_mfma_f32_16x16x32_bf16 v[48:51], v[140:143], v[188:191], v[48:51]
    ds_read_b64_tr_b16 v[164:165], v23 offset:32
    v_mfma_f32_16x16x32_bf16 v[52:55], v[140:143], v[192:195], v[52:55]
    ds_read_b64_tr_b16 v[166:167], v23 offset:2592
    ds_read_b128 v[208:211], v13 offset:6144
    s_add_u32 s31, s3, 3
    s_and_b32 s31, s31, 7
    s_mul_i32 s31, s79, s31
    s_add_u32 s31, s31, s86
    buffer_load_dwordx4 v[224:227], v252, s[60:63], s31 offen
    s_waitcnt lgkmcnt(14)
    v_mfma_f32_16x16x32_bf16 v[56:59], v[144:147], v[188:191], v[56:59]
    ds_read_b64_tr_b16 v[168:169], v23 offset:64
    v_mfma_f32_16x16x32_bf16 v[60:63], v[144:147], v[192:195], v[60:63]
    ds_read_b64_tr_b16 v[170:171], v23 offset:2624
    s_add_u32 s89, s88, 12288
    s_cmp_eq_u32 s29, 0
    s_cselect_b32 m0, s89, 158720
    s_nop 0
    buffer_load_dwordx4 v8, s[48:51], s67 offen sc1 lds
    s_add_u32 s67, s67, s69
    s_add_u32 s88, s88, 26624
    s_sub_u32 s89, s88, 93184
    s_cmp_ge_u32 s88, s87
    s_cselect_b32 s88, s89, s88
    s_add_u32 s93, s93, 1
    s_cmp_eq_u32 s93, 7
    s_cselect_b32 s94, 4294887424, s95
    s_cselect_b32 s93, 0, s93
    s_waitcnt lgkmcnt(14)
    v_mfma_f32_16x16x32_bf16 v[64:67], v[148:151], v[188:191], v[64:67]
    ds_read_b64_tr_b16 v[172:173], v23 offset:96
    v_mfma_f32_16x16x32_bf16 v[68:71], v[148:151], v[192:195], v[68:71]
    ds_read_b64_tr_b16 v[174:175], v23 offset:2656
    s_waitcnt lgkmcnt(13)
    v_mfma_f32_16x16x32_bf16 v[72:75], v[152:155], v[188:191], v[72:75]
    ds_read_b64_tr_b16 v[176:177], v23 offset:128
    v_mfma_f32_16x16x32_bf16 v[76:79], v[152:155], v[192:195], v[76:79]
    ds_read_b64_tr_b16 v[178:179], v23 offset:2688
    v_add_u32 v18, s94, v18
    s_waitcnt lgkmcnt(12)
    v_mfma_f32_16x16x32_bf16 v[80:83], v[156:159], v[188:191], v[80:83]
    ds_read_b64_tr_b16 v[128:129], v18 offset:0
    v_mfma_f32_16x16x32_bf16 v[84:87], v[156:159], v[192:195], v[84:87]
    ds_read_b64_tr_b16 v[130:131], v18 offset:2048
    v_add_u32 v19, s94, v19
    s_waitcnt lgkmcnt(12)
    v_mfma_f32_16x16x32_bf16 v[88:91], v[160:163], v[188:191], v[88:91]
    ds_read_b64_tr_b16 v[132:133], v19 offset:0
    v_mfma_f32_16x16x32_bf16 v[92:95], v[160:163], v[192:195], v[92:95]
    ds_read_b64_tr_b16 v[134:135], v19 offset:2048
    s_add_u32 s31, s3, 0
    s_and_b32 s31, s31, 7
    s_mul_i32 s31, s79, s31
    s_add_u32 s31, s31, s86
    buffer_load_dwordx4 v[212:215], v252, s[60:63], s31 offen
    v_add_u32 v21, s94, v21
    s_waitcnt lgkmcnt(11)
    v_mfma_f32_16x16x32_bf16 v[96:99], v[164:167], v[188:191], v[96:99]
    ds_read_b64_tr_b16 v[136:137], v21 offset:0
    v_mfma_f32_16x16x32_bf16 v[100:103], v[164:167], v[192:195], v[100:103]
    ds_read_b64_tr_b16 v[138:139], v21 offset:2048
    v_add_u32 v22, s94, v22
    s_waitcnt lgkmcnt(10)
    v_mfma_f32_16x16x32_bf16 v[104:107], v[168:171], v[188:191], v[104:107]
    ds_read_b64_tr_b16 v[140:141], v22 offset:0
    v_mfma_f32_16x16x32_bf16 v[108:111], v[168:171], v[192:195], v[108:111]
    ds_read_b64_tr_b16 v[142:143], v22 offset:2048
    s_add_u32 m0, s92, 4096
    s_nop 0
    buffer_load_dwordx4 v9, s[52:55], s90 offen lds
    s_waitcnt lgkmcnt(10)
    v_mfma_f32_16x16x32_bf16 v[112:115], v[172:175], v[188:191], v[112:115]
    ds_read_b64_tr_b16 v[144:145], v18 offset:4096
    v_mfma_f32_16x16x32_bf16 v[116:119], v[172:175], v[192:195], v[116:119]
    ds_read_b64_tr_b16 v[146:147], v18 offset:6144
    s_lshl_b32 s32, s68, 4
    s_cmp_eq_u32 s97, s76
    s_cselect_b32 s31, 6291456, 0
    s_cselect_b32 s32, s32, 0
    s_cselect_b32 s33, 7340032, 0
    s_cselect_b32 s34, s96, 0
    s_sub_u32 s64, s64, s31
    s_sub_u32 s65, s65, s32
    s_sub_u32 s66, s66, s33
    s_sub_u32 s67, s67, s34
    s_waitcnt vmcnt(17)
    v_lshlrev_b32 v16, 16, v244
    v_and_b32 v17, 0xffff0000, v244
    v_pk_mul_f32 v[254:255], v[16:17], v[16:17]
    v_add_f32 v14, v16, v17
    v_lshlrev_b32 v16, 16, v245
    s_waitcnt lgkmcnt(10)
    v_mfma_f32_16x16x32_bf16 v[120:123], v[176:179], v[188:191], v[120:123]
    ds_read_b64_tr_b16 v[148:149], v19 offset:4096
    v_mfma_f32_16x16x32_bf16 v[124:127], v[176:179], v[192:195], v[124:127]
    ds_read_b64_tr_b16 v[150:151], v19 offset:6144
    s_add_u32 m0, s92, 5120
    s_nop 0
    buffer_load_dwordx4 v10, s[52:55], s90 offen lds
    s_add_u32 s90, s90, 128
    v_and_b32 v17, 0xffff0000, v245
    v_pk_fma_f32 v[254:255], v[16:17], v[16:17], v[254:255]
    v_add_f32 v14, v14, v16
    v_add_f32 v14, v14, v17
    v_lshlrev_b32 v16, 16, v246
    v_and_b32 v17, 0xffff0000, v246
    s_waitcnt lgkmcnt(10)
    v_mfma_f32_16x16x32_bf16 v[24:27], v[128:131], v[196:199], v[24:27]
    ds_read_b64_tr_b16 v[152:153], v21 offset:4096
    v_mfma_f32_16x16x32_bf16 v[28:31], v[128:131], v[200:203], v[28:31]
    ds_read_b64_tr_b16 v[154:155], v21 offset:6144
    v_pk_fma_f32 v[254:255], v[16:17], v[16:17], v[254:255]
    v_add_f32 v14, v14, v16
    v_add_f32 v14, v14, v17
    v_lshlrev_b32 v16, 16, v247
    v_and_b32 v17, 0xffff0000, v247
    v_pk_fma_f32 v[254:255], v[16:17], v[16:17], v[254:255]
    s_waitcnt lgkmcnt(10)
    v_mfma_f32_16x16x32_bf16 v[32:35], v[132:135], v[196:199], v[32:35]
    ds_read_b64_tr_b16 v[156:157], v22 offset:4096
    v_mfma_f32_16x16x32_bf16 v[36:39], v[132:135], v[200:203], v[36:39]
    ds_read_b64_tr_b16 v[158:159], v22 offset:6144
    v_add_f32 v14, v14, v16
    v_add_f32 v14, v14, v17
    v_lshlrev_b32 v16, 16, v248
    v_and_b32 v17, 0xffff0000, v248
    v_pk_fma_f32 v[254:255], v[16:17], v[16:17], v[254:255]
    v_add_f32 v14, v14, v16
    v_add_u32 v23, s94, v23
    s_waitcnt lgkmcnt(10)
    v_mfma_f32_16x16x32_bf16 v[40:43], v[136:139], v[196:199], v[40:43]
    ds_read_b64_tr_b16 v[160:161], v23 offset:0
    v_mfma_f32_16x16x32_bf16 v[44:47], v[136:139], v[200:203], v[44:47]
    ds_read_b64_tr_b16 v[162:163], v23 offset:2560
    s_add_u32 m0, s92, 6144
    s_nop 0
    buffer_load_dwordx4 v9, s[52:55], s91 offen lds
    v_add_f32 v14, v14, v17
    v_lshlrev_b32 v16, 16, v249
    v_and_b32 v17, 0xffff0000, v249
    v_pk_fma_f32 v[254:255], v[16:17], v[16:17], v[254:255]
    v_add_f32 v14, v14, v16
    v_add_f32 v14, v14, v17
    s_waitcnt lgkmcnt(10)
    v_mfma_f32_16x16x32_bf16 v[48:51], v[140:143], v[196:199], v[48:51]
    ds_read_b64_tr_b16 v[164:165], v23 offset:32
    v_mfma_f32_16x16x32_bf16 v[52:55], v[140:143], v[200:203], v[52:55]
    ds_read_b64_tr_b16 v[166:167], v23 offset:2592
    v_lshlrev_b32 v16, 16, v250
    v_and_b32 v17, 0xffff0000, v250
    v_pk_fma_f32 v[254:255], v[16:17], v[16:17], v[254:255]
    v_add_f32 v14, v14, v16
    v_add_f32 v14, v14, v17
    v_lshlrev_b32 v16, 16, v251
    s_waitcnt lgkmcnt(10)
    v_mfma_f32_16x16x32_bf16 v[56:59], v[144:147], v[196:199], v[56:59]
    ds_read_b64_tr_b16 v[168:169], v23 offset:64
    v_mfma_f32_16x16x32_bf16 v[60:63], v[144:147], v[200:203], v[60:63]
    ds_read_b64_tr_b16 v[170:171], v23 offset:2624
    s_add_u32 m0, s92, 7168
    s_nop 0
    buffer_load_dwordx4 v10, s[52:55], s91 offen lds
    s_add_u32 s91, s91, 128
    v_and_b32 v17, 0xffff0000, v251
    v_pk_fma_f32 v[254:255], v[16:17], v[16:17], v[254:255]
    v_add_f32 v14, v14, v16
    v_add_f32 v14, v14, v17
    v_add_f32 v15, v254, v255
    s_nop 1
    v_permlane32_swap_b32 v14, v15
    s_add_u32 s93, s93, 1
    s_cmp_eq_u32 s93, 7
    s_cselect_b32 s94, 4294887424, s95
    s_cselect_b32 s93, 0, s93
    s_waitcnt lgkmcnt(10)
    v_mfma_f32_16x16x32_bf16 v[64:67], v[148:151], v[196:199], v[64:67]
    ds_read_b64_tr_b16 v[172:173], v23 offset:96
    v_mfma_f32_16x16x32_bf16 v[68:71], v[148:151], v[200:203], v[68:71]
    ds_read_b64_tr_b16 v[174:175], v23 offset:2656
    v_add_f32 v14, v14, v15
    v_mov_b32 v15, v14
    s_nop 1
    v_permlane16_swap_b32 v14, v15
    v_add_f32 v14, v14, v15
    s_nop 1
    v_add_f32_dpp v14, v14, v14 row_ror:1 row_mask:0xf bank_mask:0xf
    s_nop 1
    v_add_f32_dpp v14, v14, v14 row_ror:2 row_mask:0xf bank_mask:0xf
    s_waitcnt lgkmcnt(10)
    v_mfma_f32_16x16x32_bf16 v[72:75], v[152:155], v[196:199], v[72:75]
    ds_read_b64_tr_b16 v[176:177], v23 offset:128
    v_mfma_f32_16x16x32_bf16 v[76:79], v[152:155], v[200:203], v[76:79]
    ds_read_b64_tr_b16 v[178:179], v23 offset:2688
    v_add_f32_dpp v14, v14, v14 row_ror:4 row_mask:0xf bank_mask:0xf
    s_nop 1
    v_add_f32_dpp v14, v14, v14 row_ror:8 row_mask:0xf bank_mask:0xf
    v_mul_f32 v14, 0x3a800000, v14
    s_nop 0
    v_readlane_b32 s31, v14, 32
    v_mul_f32 v15, v14, v14
    s_nop 0
    v_sub_f32 v15, s31, v15
    v_max_f32 v15, 0, v15
    v_cvt_pk_bf16_f32 v244, -v14, -v14
    v_add_f32 v15, 0x3727c5ac, v15
    v_sqrt_f32 v15, v15
    s_nop 0
    v_cvt_pk_bf16_f32 v15, 0, v15
    v_lshrrev_b32 v245, 16, v15
    v_rcp_f32 v246, v15
    v_mul_f32 v247, v15, v15
    v_cmp_eq_u32 vcc, 0, v1
    s_nop 1
    v_cndmask_b32 v14, v20, v1, vcc
    s_lshl_b32 s31, s80, 4
    s_add_u32 s31, s31, 37748736
    buffer_store_dwordx4 v[244:247], v14, s[56:59], s31 offen sc1
    s_waitcnt vmcnt(17)
    s_barrier
    v_add_u32 v18, s94, v18
    s_waitcnt lgkmcnt(10)
    v_mfma_f32_16x16x32_bf16 v[80:83], v[156:159], v[196:199], v[80:83]
    ds_read_b64_tr_b16 v[128:129], v18 offset:0
    v_mfma_f32_16x16x32_bf16 v[84:87], v[156:159], v[200:203], v[84:87]
    ds_read_b64_tr_b16 v[130:131], v18 offset:2048
    v_add_u32 v19, s94, v19
    s_waitcnt lgkmcnt(10)
    v_mfma_f32_16x16x32_bf16 v[88:91], v[160:163], v[196:199], v[88:91]
    ds_read_b64_tr_b16 v[132:133], v19 offset:0
    v_mfma_f32_16x16x32_bf16 v[92:95], v[160:163], v[200:203], v[92:95]
    ds_read_b64_tr_b16 v[134:135], v19 offset:2048
    v_add_u32 v21, s94, v21
    s_waitcnt lgkmcnt(10)
    v_mfma_f32_16x16x32_bf16 v[96:99], v[164:167], v[196:199], v[96:99]
    ds_read_b64_tr_b16 v[136:137], v21 offset:0
    v_mfma_f32_16x16x32_bf16 v[100:103], v[164:167], v[200:203], v[100:103]
    ds_read_b64_tr_b16 v[138:139], v21 offset:2048
    s_mov_b32 m0, s88
    s_nop 0
    buffer_load_dwordx4 v5, s[36:39], s64 offen sc1 lds
    s_add_u32 s64, s64, 393216
    s_add_u32 s31, s3, 1
    s_and_b32 s31, s31, 7
    s_mul_i32 s31, s79, s31
    s_add_u32 s31, s31, s86
    buffer_load_dwordx4 v[216:219], v252, s[60:63], s31 offen
    v_add_u32 v22, s94, v22
    s_waitcnt lgkmcnt(10)
    v_mfma_f32_16x16x32_bf16 v[104:107], v[168:171], v[196:199], v[104:107]
    ds_read_b64_tr_b16 v[140:141], v22 offset:0
    v_mfma_f32_16x16x32_bf16 v[108:111], v[168:171], v[200:203], v[108:111]
    ds_read_b64_tr_b16 v[142:143], v22 offset:2048
    s_waitcnt lgkmcnt(10)
    v_mfma_f32_16x16x32_bf16 v[112:115], v[172:175], v[196:199], v[112:115]
    ds_read_b64_tr_b16 v[144:145], v18 offset:4096
    v_mfma_f32_16x16x32_bf16 v[116:119], v[172:175], v[200:203], v[116:119]
    ds_read_b64_tr_b16 v[146:147], v18 offset:6144
    s_add_u32 m0, s88, 4096
    s_nop 0
    buffer_load_dwordx4 v6, s[40:43], s65 offen sc1 lds
    s_add_u32 s65, s65, s68
    s_waitcnt lgkmcnt(10)
    v_mfma_f32_16x16x32_bf16 v[120:123], v[176:179], v[196:199], v[120:123]
    ds_read_b64_tr_b16 v[148:149], v19 offset:4096
    v_mfma_f32_16x16x32_bf16 v[124:127], v[176:179], v[200:203], v[124:127]
    ds_read_b64_tr_b16 v[150:151], v19 offset:6144
    s_waitcnt vmcnt(15)
    ds_read_b128 v[180:183], v12 offset:0
    s_waitcnt lgkmcnt(11)
    v_mfma_f32_16x16x32_bf16 v[24:27], v[128:131], v[204:207], v[24:27]
    ds_read_b64_tr_b16 v[152:153], v21 offset:4096
    v_mfma_f32_16x16x32_bf16 v[28:31], v[128:131], v[208:211], v[28:31]
    ds_read_b64_tr_b16 v[154:155], v21 offset:6144
    ds_read_b128 v[184:187], v12 offset:2048
    s_waitcnt lgkmcnt(12)
    v_mfma_f32_16x16x32_bf16 v[32:35], v[132:135], v[204:207], v[32:35]
    ds_read_b64_tr_b16 v[156:157], v22 offset:4096
    v_mfma_f32_16x16x32_bf16 v[36:39], v[132:135], v[208:211], v[36:39]
    ds_read_b64_tr_b16 v[158:159], v22 offset:6144
    s_add_u32 m0, s88, 8192
    s_nop 0
    buffer_load_dwordx4 v7, s[44:47], s66 offen sc1 lds
    s_add_u32 s66, s66, 458752
    s_cmp_eq_u32 s97, s76
    s_cselect_b32 s31, 2048, 0
    s_sub_u32 s90, s90, s31
    s_sub_u32 s91, s91, s31
    v_add_u32 v23, s94, v23
    s_waitcnt lgkmcnt(12)
    v_mfma_f32_16x16x32_bf16 v[40:43], v[136:139], v[204:207], v[40:43]
    ds_read_b64_tr_b16 v[160:161], v23 offset:0
    v_mfma_f32_16x16x32_bf16 v[44:47], v[136:139], v[208:211], v[44:47]
    ds_read_b64_tr_b16 v[162:163], v23 offset:2560
    ds_read_b128 v[188:191], v13 offset:0
    s_waitcnt lgkmcnt(13)
    v_mfma_f32_16x16x32_bf16 v[48:51], v[140:143], v[204:207], v[48:51]
    ds_read_b64_tr_b16 v[164:165], v23 offset:32
    v_mfma_f32_16x16x32_bf16 v[52:55], v[140:143], v[208:211], v[52:55]
    ds_read_b64_tr_b16 v[166:167], v23 offset:2592
    ds_read_b128 v[192:195], v13 offset:2048
    s_waitcnt lgkmcnt(14)
    v_mfma_f32_16x16x32_bf16 v[56:59], v[144:147], v[204:207], v[56:59]
    ds_read_b64_tr_b16 v[168:169], v23 offset:64
    v_mfma_f32_16x16x32_bf16 v[60:63], v[144:147], v[208:211], v[60:63]
    ds_read_b64_tr_b16 v[170:171], v23 offset:2624
    s_add_u32 s89, s88, 12288
    s_cmp_eq_u32 s29, 0
    s_cselect_b32 m0, s89, 158720
    s_nop 0
    buffer_load_dwordx4 v8, s[48:51], s67 offen sc1 lds
    s_add_u32 s67, s67, s69
    s_add_u32 s88, s88, 26624
    s_sub_u32 s89, s88, 93184
    s_cmp_ge_u32 s88, s87
    s_cselect_b32 s88, s89, s88
    s_add_u32 s93, s93, 1
    s_cmp_eq_u32 s93, 7
    s_cselect_b32 s94, 4294887424, s95
    s_cselect_b32 s93, 0, s93
    s_waitcnt lgkmcnt(14)
    v_mfma_f32_16x16x32_bf16 v[64:67], v[148:151], v[204:207], v[64:67]
    ds_read_b64_tr_b16 v[172:173], v23 offset:96
    v_mfma_f32_16x16x32_bf16 v[68:71], v[148:151], v[208:211], v[68:71]
    ds_read_b64_tr_b16 v[174:175], v23 offset:2656
    s_waitcnt lgkmcnt(13)
    v_mfma_f32_16x16x32_bf16 v[72:75], v[152:155], v[204:207], v[72:75]
    ds_read_b64_tr_b16 v[176:177], v23 offset:128
    v_mfma_f32_16x16x32_bf16 v[76:79], v[152:155], v[208:211], v[76:79]
    ds_read_b64_tr_b16 v[178:179], v23 offset:2688
    s_mov_b32 s72, s14
    s_mov_b32 s73, s15
    s_mov_b32 s74, 7168
    s_mov_b32 s75, 0x00020000
    s_cmp_eq_u32 s28, 7
    s_cselect_b32 s33, 7, 0
    v_lshlrev_b32 v255, 2, v1
    v_cmp_gt_u32 vcc, s33, v1
    s_nop 1
    v_cndmask_b32 v255, v20, v255, vcc
    s_mul_i32 s31, s2, 28
    s_add_u32 s77, s31, 36945920
    buffer_load_dword v254, v255, s[72:75], s31 offen
    v_add_u32 v18, s94, v18
    s_waitcnt lgkmcnt(12)
    v_mfma_f32_16x16x32_bf16 v[80:83], v[156:159], v[204:207], v[80:83]
    ds_read_b64_tr_b16 v[128:129], v18 offset:0
    v_mfma_f32_16x16x32_bf16 v[84:87], v[156:159], v[208:211], v[84:87]
    ds_read_b64_tr_b16 v[130:131], v18 offset:2048
    v_add_u32 v19, s94, v19
    s_waitcnt lgkmcnt(12)
    v_mfma_f32_16x16x32_bf16 v[88:91], v[160:163], v[204:207], v[88:91]
    ds_read_b64_tr_b16 v[132:133], v19 offset:0
    v_mfma_f32_16x16x32_bf16 v[92:95], v[160:163], v[208:211], v[92:95]
    ds_read_b64_tr_b16 v[134:135], v19 offset:2048
    v_add_u32 v21, s94, v21
    s_waitcnt lgkmcnt(11)
    v_mfma_f32_16x16x32_bf16 v[96:99], v[164:167], v[204:207], v[96:99]
    ds_read_b64_tr_b16 v[136:137], v21 offset:0
    v_mfma_f32_16x16x32_bf16 v[100:103], v[164:167], v[208:211], v[100:103]
    ds_read_b64_tr_b16 v[138:139], v21 offset:2048
    v_add_u32 v22, s94, v22
    s_waitcnt lgkmcnt(10)
    v_mfma_f32_16x16x32_bf16 v[104:107], v[168:171], v[204:207], v[104:107]
    ds_read_b64_tr_b16 v[140:141], v22 offset:0
    v_mfma_f32_16x16x32_bf16 v[108:111], v[168:171], v[208:211], v[108:111]
    ds_read_b64_tr_b16 v[142:143], v22 offset:2048
    s_add_u32 m0, s92, 0
    s_nop 0
    buffer_load_dwordx4 v9, s[52:55], s90 offen lds
    s_waitcnt lgkmcnt(10)
    v_mfma_f32_16x16x32_bf16 v[112:115], v[172:175], v[204:207], v[112:115]
    ds_read_b64_tr_b16 v[144:145], v18 offset:4096
    v_mfma_f32_16x16x32_bf16 v[116:119], v[172:175], v[208:211], v[116:119]
    ds_read_b64_tr_b16 v[146:147], v18 offset:6144
    s_waitcnt lgkmcnt(10)
    v_mfma_f32_16x16x32_bf16 v[120:123], v[176:179], v[204:207], v[120:123]
    ds_read_b64_tr_b16 v[148:149], v19 offset:4096
    v_mfma_f32_16x16x32_bf16 v[124:127], v[176:179], v[208:211], v[124:127]
    ds_read_b64_tr_b16 v[150:151], v19 offset:6144
    s_add_u32 m0, s92, 1024
    s_nop 0
    buffer_load_dwordx4 v10, s[52:55], s90 offen lds
    s_add_u32 s90, s90, 128
    s_mov_b32 s97, 1
.p2align 6
L_loopY:
    s_waitcnt lgkmcnt(10)
    v_mfma_f32_16x16x32_bf16 v[24:27], v[128:131], v[180:183], v[24:27]
    ds_read_b64_tr_b16 v[152:153], v21 offset:4096
    v_mfma_f32_16x16x32_bf16 v[28:31], v[128:131], v[184:187], v[28:31]
    ds_read_b64_tr_b16 v[154:155], v21 offset:6144
    s_waitcnt lgkmcnt(10)
    v_mfma_f32_16x16x32_bf16 v[32:35], v[132:135], v[180:183], v[32:35]
    ds_read_b64_tr_b16 v[156:157], v22 offset:4096
    v_mfma_f32_16x16x32_bf16 v[36:39], v[132:135], v[184:187], v[36:39]
    ds_read_b64_tr_b16 v[158:159], v22 offset:6144
    v_add_u32 v23, s94, v23
    s_waitcnt lgkmcnt(10)
    v_mfma_f32_16x16x32_bf16 v[40:43], v[136:139], v[180:183], v[40:43]
    ds_read_b64_tr_b16 v[160:161], v23 offset:0
    v_mfma_f32_16x16x32_bf16 v[44:47], v[136:139], v[184:187], v[44:47]
    ds_read_b64_tr_b16 v[162:163], v23 offset:2560
    s_add_u32 m0, s92, 2048
    s_nop 0
    buffer_load_dwordx4 v9, s[52:55], s91 offen lds
    s_waitcnt lgkmcnt(10)
    v_mfma_f32_16x16x32_bf16 v[48:51], v[140:143], v[180:183], v[48:51]
    ds_read_b64_tr_b16 v[164:165], v23 offset:32
    v_mfma_f32_16x16x32_bf16 v[52:55], v[140:143], v[184:187], v[52:55]
    ds_read_b64_tr_b16 v[166:167], v23 offset:2592
    s_waitcnt lgkmcnt(10)
    v_mfma_f32_16x16x32_bf16 v[56:59], v[144:147], v[180:183], v[56:59]
    ds_read_b64_tr_b16 v[168:169], v23 offset:64
    v_mfma_f32_16x16x32_bf16 v[60:63], v[144:147], v[184:187], v[60:63]
    ds_read_b64_tr_b16 v[170:171], v23 offset:2624
    s_add_u32 m0, s92, 3072
    s_nop 0
    buffer_load_dwordx4 v10, s[52:55], s91 offen lds
    s_add_u32 s91, s91, 128
    s_add_u32 s93, s93, 1
    s_cmp_eq_u32 s93, 7
    s_cselect_b32 s94, 4294887424, s95
    s_cselect_b32 s93, 0, s93
    s_waitcnt lgkmcnt(10)
    v_mfma_f32_16x16x32_bf16 v[64:67], v[148:151], v[180:183], v[64:67]
    ds_read_b64_tr_b16 v[172:173], v23 offset:96
    v_mfma_f32_16x16x32_bf16 v[68:71], v[148:151], v[184:187], v[68:71]
    ds_read_b64_tr_b16 v[174:175], v23 offset:2656
    s_waitcnt lgkmcnt(10)
    v_mfma_f32_16x16x32_bf16 v[72:75], v[152:155], v[180:183], v[72:75]
    ds_read_b64_tr_b16 v[176:177], v23 offset:128
    v_mfma_f32_16x16x32_bf16 v[76:79], v[152:155], v[184:187], v[76:79]
    ds_read_b64_tr_b16 v[178:179], v23 offset:2688
    s_waitcnt vmcnt(12)
    s_barrier
    v_add_u32 v18, s94, v18
    s_waitcnt lgkmcnt(10)
    v_mfma_f32_16x16x32_bf16 v[80:83], v[156:159], v[180:183], v[80:83]
    ds_read_b64_tr_b16 v[128:129], v18 offset:0
    v_mfma_f32_16x16x32_bf16 v[84:87], v[156:159], v[184:187], v[84:87]
    ds_read_b64_tr_b16 v[130:131], v18 offset:2048
    v_add_u32 v19, s94, v19
    s_waitcnt lgkmcnt(10)
    v_mfma_f32_16x16x32_bf16 v[88:91], v[160:163], v[180:183], v[88:91]
    ds_read_b64_tr_b16 v[132:133], v19 offset:0
    v_mfma_f32_16x16x32_bf16 v[92:95], v[160:163], v[184:187], v[92:95]
    ds_read_b64_tr_b16 v[134:135], v19 offset:2048
    v_add_u32 v21, s94, v21
    s_waitcnt lgkmcnt(10)
    v_mfma_f32_16x16x32_bf16 v[96:99], v[164:167], v[180:183], v[96:99]
    ds_read_b64_tr_b16 v[136:137], v21 offset:0
    v_mfma_f32_16x16x32_bf16 v[100:103], v[164:167], v[184:187], v[100:103]
    ds_read_b64_tr_b16 v[138:139], v21 offset:2048
    s_mov_b32 m0, s88
    s_nop 0
    buffer_load_dwordx4 v5, s[36:39], s64 offen sc1 lds
    s_add_u32 s64, s64, 393216
    v_add_u32 v22, s94, v22
    s_waitcnt lgkmcnt(10)
    v_mfma_f32_16x16x32_bf16 v[104:107], v[168:171], v[180:183], v[104:107]
    ds_read_b64_tr_b16 v[140:141], v22 offset:0
    v_mfma_f32_16x16x32_bf16 v[108:111], v[168:171], v[184:187], v[108:111]
    ds_read_b64_tr_b16 v[142:143], v22 offset:2048
    s_waitcnt lgkmcnt(10)
    v_mfma_f32_16x16x32_bf16 v[112:115], v[172:175], v[180:183], v[112:115]
    ds_read_b64_tr_b16 v[144:145], v18 offset:4096
    v_mfma_f32_16x16x32_bf16 v[116:119], v[172:175], v[184:187], v[116:119]
    ds_read_b64_tr_b16 v[146:147], v18 offset:6144
    s_add_u32 m0, s88, 4096
    s_nop 0
    buffer_load_dwordx4 v6, s[40:43], s65 offen sc1 lds
    s_add_u32 s65, s65, s68
    s_waitcnt lgkmcnt(10)
    v_mfma_f32_16x16x32_bf16 v[120:123], v[176:179], v[180:183], v[120:123]
    ds_read_b64_tr_b16 v[148:149], v19 offset:4096
    v_mfma_f32_16x16x32_bf16 v[124:127], v[176:179], v[184:187], v[124:127]
    ds_read_b64_tr_b16 v[150:151], v19 offset:6144
    s_waitcnt vmcnt(10)
    ds_read_b128 v[196:199], v12 offset:4096
    s_waitcnt lgkmcnt(11)
    v_mfma_f32_16x16x32_bf16 v[24:27], v[128:131], v[188:191], v[24:27]
    ds_read_b64_tr_b16 v[152:153], v21 offset:4096
    v_mfma_f32_16x16x32_bf16 v[28:31], v[128:131], v[192:195], v[28:31]
    ds_read_b64_tr_b16 v[154:155], v21 offset:6144
    ds_read_b128 v[200:203], v12 offset:6144
    s_waitcnt lgkmcnt(12)
    v_mfma_f32_16x16x32_bf16 v[32:35], v[132:135], v[188:191], v[32:35]
    ds_read_b64_tr_b16 v[156:157], v22 offset:4096
    v_mfma_f32_16x16x32_bf16 v[36:39], v[132:135], v[192:195], v[36:39]
    ds_read_b64_tr_b16 v[158:159], v22 offset:6144
    s_add_u32 m0, s88, 8192
    s_nop 0
    buffer_load_dwordx4 v7, s[44:47], s66 offen sc1 lds
    s_add_u32 s66, s66, 458752
    v_add_u32 v23, s94, v23
    s_waitcnt lgkmcnt(12)
    v_mfma_f32_16x16x32_bf16 v[40:43], v[136:139], v[188:191], v[40:43]
    ds_read_b64_tr_b16 v[160:161], v23 offset:0
    v_mfma_f32_16x16x32_bf16 v[44:47], v[136:139], v[192:195], v[44:47]
    ds_read_b64_tr_b16 v[162:163], v23 offset:2560
    ds_read_b128 v[204:207], v13 offset:4096
    s_waitcnt lgkmcnt(13)
    v_mfma_f32_16x16x32_bf16 v[48:51], v[140:143], v[188:191], v[48:51]
    ds_read_b64_tr_b16 v[164:165], v23 offset:32
    v_mfma_f32_16x16x32_bf16 v[52:55], v[140:143], v[192:195], v[52:55]
    ds_read_b64_tr_b16 v[166:167], v23 offset:2592
    ds_read_b128 v[208:211], v13 offset:6144
    s_waitcnt lgkmcnt(14)
    v_mfma_f32_16x16x32_bf16 v[56:59], v[144:147], v[188:191], v[56:59]
    ds_read_b64_tr_b16 v[168:169], v23 offset:64
    v_mfma_f32_16x16x32_bf16 v[60:63], v[144:147], v[192:195], v[60:63]
    ds_read_b64_tr_b16 v[170:171], v23 offset:2624
    s_add_u32 s89, s88, 12288
    s_cmp_eq_u32 s29, 0
    s_cselect_b32 m0, s89, 158720
    s_nop 0
    buffer_load_dwordx4 v8, s[48:51], s67 offen sc1 lds
    s_add_u32 s67, s67, s69
    s_add_u32 s88, s88, 26624
    s_sub_u32 s89, s88, 93184
    s_cmp_ge_u32 s88, s87
    s_cselect_b32 s88, s89, s88
    s_add_u32 s93, s93, 1
    s_cmp_eq_u32 s93, 7
    s_cselect_b32 s94, 4294887424, s95
    s_cselect_b32 s93, 0, s93
    s_waitcnt lgkmcnt(14)
    v_mfma_f32_16x16x32_bf16 v[64:67], v[148:151], v[188:191], v[64:67]
    ds_read_b64_tr_b16 v[172:173], v23 offset:96
    v_mfma_f32_16x16x32_bf16 v[68:71], v[148:151], v[192:195], v[68:71]
    ds_read_b64_tr_b16 v[174:175], v23 offset:2656
    s_waitcnt lgkmcnt(13)
    v_mfma_f32_16x16x32_bf16 v[72:75], v[152:155], v[188:191], v[72:75]
    ds_read_b64_tr_b16 v[176:177], v23 offset:128
    v_mfma_f32_16x16x32_bf16 v[76:79], v[152:155], v[192:195], v[76:79]
    ds_read_b64_tr_b16 v[178:179], v23 offset:2688
    v_add_u32 v18, s94, v18
    s_waitcnt lgkmcnt(12)
    v_mfma_f32_16x16x32_bf16 v[80:83], v[156:159], v[188:191], v[80:83]
    ds_read_b64_tr_b16 v[128:129], v18 offset:0
    v_mfma_f32_16x16x32_bf16 v[84:87], v[156:159], v[192:195], v[84:87]
    ds_read_b64_tr_b16 v[130:131], v18 offset:2048
    v_add_u32 v19, s94, v19
    s_waitcnt lgkmcnt(12)
    v_mfma_f32_16x16x32_bf16 v[88:91], v[160:163], v[188:191], v[88:91]
    ds_read_b64_tr_b16 v[132:133], v19 offset:0
    v_mfma_f32_16x16x32_bf16 v[92:95], v[160:163], v[192:195], v[92:95]
    ds_read_b64_tr_b16 v[134:135], v19 offset:2048
    v_add_u32 v21, s94, v21
    s_waitcnt lgkmcnt(11)
    v_mfma_f32_16x16x32_bf16 v[96:99], v[164:167], v[188:191], v[96:99]
    ds_read_b64_tr_b16 v[136:137], v21 offset:0
    v_mfma_f32_16x16x32_bf16 v[100:103], v[164:167], v[192:195], v[100:103]
    ds_read_b64_tr_b16 v[138:139], v21 offset:2048
    v_add_u32 v22, s94, v22
    s_waitcnt lgkmcnt(10)
    v_mfma_f32_16x16x32_bf16 v[104:107], v[168:171], v[188:191], v[104:107]
    ds_read_b64_tr_b16 v[140:141], v22 offset:0
    v_mfma_f32_16x16x32_bf16 v[108:111], v[168:171], v[192:195], v[108:111]
    ds_read_b64_tr_b16 v[142:143], v22 offset:2048
    s_add_u32 m0, s92, 4096
    s_nop 0
    buffer_load_dwordx4 v9, s[52:55], s90 offen lds
    s_waitcnt lgkmcnt(10)
    v_mfma_f32_16x16x32_bf16 v[112:115], v[172:175], v[188:191], v[112:115]
    ds_read_b64_tr_b16 v[144:145], v18 offset:4096
    v_mfma_f32_16x16x32_bf16 v[116:119], v[172:175], v[192:195], v[116:119]
    ds_read_b64_tr_b16 v[146:147], v18 offset:6144
    s_lshl_b32 s32, s68, 4
    s_cmp_eq_u32 s97, s76
    s_cselect_b32 s31, 6291456, 0
    s_cselect_b32 s32, s32, 0
    s_cselect_b32 s33, 7340032, 0
    s_cselect_b32 s34, s96, 0
    s_sub_u32 s64, s64, s31
    s_sub_u32 s65, s65, s32
    s_sub_u32 s66, s66, s33
    s_sub_u32 s67, s67, s34
    s_waitcnt lgkmcnt(10)
    v_mfma_f32_16x16x32_bf16 v[120:123], v[176:179], v[188:191], v[120:123]
    ds_read_b64_tr_b16 v[148:149], v19 offset:4096
    v_mfma_f32_16x16x32_bf16 v[124:127], v[176:179], v[192:195], v[124:127]
    ds_read_b64_tr_b16 v[150:151], v19 offset:6144
    s_add_u32 m0, s92, 5120
    s_nop 0
    buffer_load_dwordx4 v10, s[52:55], s90 offen lds
    s_add_u32 s90, s90, 128
    s_bitcmp1_b32 0x46, s97
    s_cbranch_scc1 L_hk25Y
L_hr25Y:
    s_waitcnt lgkmcnt(10)
    v_mfma_f32_16x16x32_bf16 v[24:27], v[128:131], v[196:199], v[24:27]
    ds_read_b64_tr_b16 v[152:153], v21 offset:4096
    v_mfma_f32_16x16x32_bf16 v[28:31], v[128:131], v[200:203], v[28:31]
    ds_read_b64_tr_b16 v[154:155], v21 offset:6144
    s_waitcnt lgkmcnt(10)
    v_mfma_f32_16x16x32_bf16 v[32:35], v[132:135], v[196:199], v[32:35]
    ds_read_b64_tr_b16 v[156:157], v22 offset:4096
    v_mfma_f32_16x16x32_bf16 v[36:39], v[132:135], v[200:203], v[36:39]
    ds_read_b64_tr_b16 v[158:159], v22 offset:6144
    v_add_u32 v23, s94, v23
    s_waitcnt lgkmcnt(10)
    v_mfma_f32_16x16x32_bf16 v[40:43], v[136:139], v[196:199], v[40:43]
    ds_read_b64_tr_b16 v[160:161], v23 offset:0
    v_mfma_f32_16x16x32_bf16 v[44:47], v[136:139], v[200:203], v[44:47]
    ds_read_b64_tr_b16 v[162:163], v23 offset:2560
    s_add_u32 m0, s92, 6144
    s_nop 0
    buffer_load_dwordx4 v9, s[52:55], s91 offen lds
    s_waitcnt lgkmcnt(10)
    v_mfma_f32_16x16x32_bf16 v[48:51], v[140:143], v[196:199], v[48:51]
    ds_read_b64_tr_b16 v[164:165], v23 offset:32
    v_mfma_f32_16x16x32_bf16 v[52:55], v[140:143], v[200:203], v[52:55]
    ds_read_b64_tr_b16 v[166:167], v23 offset:2592
    s_waitcnt lgkmcnt(10)
    v_mfma_f32_16x16x32_bf16 v[56:59], v[144:147], v[196:199], v[56:59]
    ds_read_b64_tr_b16 v[168:169], v23 offset:64
    v_mfma_f32_16x16x32_bf16 v[60:63], v[144:147], v[200:203], v[60:63]
    ds_read_b64_tr_b16 v[170:171], v23 offset:2624
    s_add_u32 m0, s92, 7168
    s_nop 0
    buffer_load_dwordx4 v10, s[52:55], s91 offen lds
    s_add_u32 s91, s91, 128
    s_add_u32 s93, s93, 1
    s_cmp_eq_u32 s93, 7
    s_cselect_b32 s94, 4294887424, s95
    s_cselect_b32 s93, 0, s93
    s_waitcnt lgkmcnt(10)
    v_mfma_f32_16x16x32_bf16 v[64:67], v[148:151], v[196:199], v[64:67]
    ds_read_b64_tr_b16 v[172:173], v23 offset:96
    v_mfma_f32_16x16x32_bf16 v[68:71], v[148:151], v[200:203], v[68:71]
    ds_read_b64_tr_b16 v[174:175], v23 offset:2656
    s_waitcnt lgkmcnt(10)
    v_mfma_f32_16x16x32_bf16 v[72:75], v[152:155], v[196:199], v[72:75]
    ds_read_b64_tr_b16 v[176:177], v23 offset:128
    v_mfma_f32_16x16x32_bf16 v[76:79], v[152:155], v[200:203], v[76:79]
    ds_read_b64_tr_b16 v[178:179], v23 offset:2688
    s_waitcnt vmcnt(12)
    s_barrier
    v_add_u32 v18, s94, v18
    s_waitcnt lgkmcnt(10)
    v_mfma_f32_16x16x32_bf16 v[80:83], v[156:159], v[196:199], v[80:83]
    ds_read_b64_tr_b16 v[128:129], v18 offset:0
    v_mfma_f32_16x16x32_bf16 v[84:87], v[156:159], v[200:203], v[84:87]
    ds_read_b64_tr_b16 v[130:131], v18 offset:2048
    v_add_u32 v19, s94, v19
    s_waitcnt lgkmcnt(10)
    v_mfma_f32_16x16x32_bf16 v[88:91], v[160:163], v[196:199], v[88:91]
    ds_read_b64_tr_b16 v[132:133], v19 offset:0
    v_mfma_f32_16x16x32_bf16 v[92:95], v[160:163], v[200:203], v[92:95]
    ds_read_b64_tr_b16 v[134:135], v19 offset:2048
    v_add_u32 v21, s94, v21
    s_waitcnt lgkmcnt(10)
    v_mfma_f32_16x16x32_bf16 v[96:99], v[164:167], v[196:199], v[96:99]
    ds_read_b64_tr_b16 v[136:137], v21 offset:0
    v_mfma_f32_16x16x32_bf16 v[100:103], v[164:167], v[200:203], v[100:103]
    ds_read_b64_tr_b16 v[138:139], v21 offset:2048
    s_mov_b32 m0, s88
    s_nop 0
    buffer_load_dwordx4 v5, s[36:39], s64 offen sc1 lds
    s_add_u32 s64, s64, 393216
    v_add_u32 v22, s94, v22
    s_waitcnt lgkmcnt(10)
    v_mfma_f32_16x16x32_bf16 v[104:107], v[168:171], v[196:199], v[104:107]
    ds_read_b64_tr_b16 v[140:141], v22 offset:0
    v_mfma_f32_16x16x32_bf16 v[108:111], v[168:171], v[200:203], v[108:111]
    ds_read_b64_tr_b16 v[142:143], v22 offset:2048
    s_waitcnt lgkmcnt(10)
    v_mfma_f32_16x16x32_bf16 v[112:115], v[172:175], v[196:199], v[112:115]
    ds_read_b64_tr_b16 v[144:145], v18 offset:4096
    v_mfma_f32_16x16x32_bf16 v[116:119], v[172:175], v[200:203], v[116:119]
    ds_read_b64_tr_b16 v[146:147], v18 offset:6144
    s_add_u32 m0, s88, 4096
    s_nop 0
    buffer_load_dwordx4 v6, s[40:43], s65 offen sc1 lds
    s_add_u32 s65, s65, s68
    s_waitcnt lgkmcnt(10)
    v_mfma_f32_16x16x32_bf16 v[120:123], v[176:179], v[196:199], v[120:123]
    ds_read_b64_tr_b16 v[148:149], v19 offset:4096
    v_mfma_f32_16x16x32_bf16 v[124:127], v[176:179], v[200:203], v[124:127]
    ds_read_b64_tr_b16 v[150:151], v19 offset:6144
    s_waitcnt vmcnt(10)
    ds_read_b128 v[180:183], v12 offset:0
    s_waitcnt lgkmcnt(11)
    v_mfma_f32_16x16x32_bf16 v[24:27], v[128:131], v[204:207], v[24:27]
    ds_read_b64_tr_b16 v[152:153], v21 offset:4096
    v_mfma_f32_16x16x32_bf16 v[28:31], v[128:131], v[208:211], v[28:31]
    ds_read_b64_tr_b16 v[154:155], v21 offset:6144
    ds_read_b128 v[184:187], v12 offset:2048
    s_waitcnt lgkmcnt(12)
    v_mfma_f32_16x16x32_bf16 v[32:35], v[132:135], v[204:207], v[32:35]
    ds_read_b64_tr_b16 v[156:157], v22 offset:4096
    v_mfma_f32_16x16x32_bf16 v[36:39], v[132:135], v[208:211], v[36:39]
    ds_read_b64_tr_b16 v[158:159], v22 offset:6144
    s_add_u32 m0, s88, 8192
    s_nop 0
    buffer_load_dwordx4 v7, s[44:47], s66 offen sc1 lds
    s_add_u32 s66, s66, 458752
    s_cmp_eq_u32 s97, s76
    s_cselect_b32 s31, 2048, 0
    s_sub_u32 s90, s90, s31
    s_sub_u32 s91, s91, s31
    v_add_u32 v23, s94, v23
    s_waitcnt lgkmcnt(12)
    v_mfma_f32_16x16x32_bf16 v[40:43], v[136:139], v[204:207], v[40:43]
    ds_read_b64_tr_b16 v[160:161], v23 offset:0
    v_mfma_f32_16x16x32_bf16 v[44:47], v[136:139], v[208:211], v[44:47]
    ds_read_b64_tr_b16 v[162:163], v23 offset:2560
    ds_read_b128 v[188:191], v13 offset:0
    s_waitcnt lgkmcnt(13)
    v_mfma_f32_16x16x32_bf16 v[48:51], v[140:143], v[204:207], v[48:51]
    ds_read_b64_tr_b16 v[164:165], v23 offset:32
    v_mfma_f32_16x16x32_bf16 v[52:55], v[140:143], v[208:211], v[52:55]
    ds_read_b64_tr_b16 v[166:167], v23 offset:2592
    ds_read_b128 v[192:195], v13 offset:2048
    s_waitcnt lgkmcnt(14)
    v_mfma_f32_16x16x32_bf16 v[56:59], v[144:147], v[204:207], v[56:59]
    ds_read_b64_tr_b16 v[168:169], v23 offset:64
    v_mfma_f32_16x16x32_bf16 v[60:63], v[144:147], v[208:211], v[60:63]
    ds_read_b64_tr_b16 v[170:171], v23 offset:2624
    s_add_u32 s89, s88, 12288
    s_cmp_eq_u32 s29, 0
    s_cselect_b32 m0, s89, 158720
    s_nop 0
    buffer_load_dwordx4 v8, s[48:51], s67 offen sc1 lds
    s_add_u32 s67, s67, s69
    s_add_u32 s88, s88, 26624
    s_sub_u32 s89, s88, 93184
    s_cmp_ge_u32 s88, s87
    s_cselect_b32 s88, s89, s88
    s_add_u32 s93, s93, 1
    s_cmp_eq_u32 s93, 7
    s_cselect_b32 s94, 4294887424, s95
    s_cselect_b32 s93, 0, s93
    s_waitcnt lgkmcnt(14)
    v_mfma_f32_16x16x32_bf16 v[64:67], v[148:151], v[204:207], v[64:67]
    ds_read_b64_tr_b16 v[172:173], v23 offset:96
    v_mfma_f32_16x16x32_bf16 v[68:71], v[148:151], v[208:211], v[68:71]
    ds_read_b64_tr_b16 v[174:175], v23 offset:2656
    s_waitcnt lgkmcnt(13)
    v_mfma_f32_16x16x32_bf16 v[72:75], v[152:155], v[204:207], v[72:75]
    ds_read_b64_tr_b16 v[176:177], v23 offset:128
    v_mfma_f32_16x16x32_bf16 v[76:79], v[152:155], v[208:211], v[76:79]
    ds_read_b64_tr_b16 v[178:179], v23 offset:2688
    v_add_u32 v18, s94, v18
    s_waitcnt lgkmcnt(12)
    v_mfma_f32_16x16x32_bf16 v[80:83], v[156:159], v[204:207], v[80:83]
    ds_read_b64_tr_b16 v[128:129], v18 offset:0
    v_mfma_f32_16x16x32_bf16 v[84:87], v[156:159], v[208:211], v[84:87]
    ds_read_b64_tr_b16 v[130:131], v18 offset:2048
    v_add_u32 v19, s94, v19
    s_waitcnt lgkmcnt(12)
    v_mfma_f32_16x16x32_bf16 v[88:91], v[160:163], v[204:207], v[88:91]
    ds_read_b64_tr_b16 v[132:133], v19 offset:0
    v_mfma_f32_16x16x32_bf16 v[92:95], v[160:163], v[208:211], v[92:95]
    ds_read_b64_tr_b16 v[134:135], v19 offset:2048
    v_add_u32 v21, s94, v21
    s_waitcnt lgkmcnt(11)
    v_mfma_f32_16x16x32_bf16 v[96:99], v[164:167], v[204:207], v[96:99]
    ds_read_b64_tr_b16 v[136:137], v21 offset:0
    v_mfma_f32_16x16x32_bf16 v[100:103], v[164:167], v[208:211], v[100:103]
    ds_read_b64_tr_b16 v[138:139], v21 offset:2048
    v_add_u32 v22, s94, v22
    s_waitcnt lgkmcnt(10)
    v_mfma_f32_16x16x32_bf16 v[104:107], v[168:171], v[204:207], v[104:107]
    ds_read_b64_tr_b16 v[140:141], v22 offset:0
    v_mfma_f32_16x16x32_bf16 v[108:111], v[168:171], v[208:211], v[108:111]
    ds_read_b64_tr_b16 v[142:143], v22 offset:2048
    s_add_u32 m0, s92, 0
    s_nop 0
    buffer_load_dwordx4 v9, s[52:55], s90 offen lds
    s_waitcnt lgkmcnt(10)
    v_mfma_f32_16x16x32_bf16 v[112:115], v[172:175], v[204:207], v[112:115]
    ds_read_b64_tr_b16 v[144:145], v18 offset:4096
    v_mfma_f32_16x16x32_bf16 v[116:119], v[172:175], v[208:211], v[116:119]
    ds_read_b64_tr_b16 v[146:147], v18 offset:6144
    s_waitcnt lgkmcnt(10)
    v_mfma_f32_16x16x32_bf16 v[120:123], v[176:179], v[204:207], v[120:123]
    ds_read_b64_tr_b16 v[148:149], v19 offset:4096
    v_mfma_f32_16x16x32_bf16 v[124:127], v[176:179], v[208:211], v[124:127]
    ds_read_b64_tr_b16 v[150:151], v19 offset:6144
    s_add_u32 m0, s92, 1024
    s_nop 0
    buffer_load_dwordx4 v10, s[52:55], s90 offen lds
    s_add_u32 s90, s90, 128
    s_bitcmp1_b32 0x46, s97
    s_cbranch_scc1 L_hk51Y
L_hr51Y:
    s_add_u32 s97, s97, 1
    s_cmp_lt_u32 s97, 8
    s_cbranch_scc1 L_loopY
    s_branch L_tail
L_hk25Y:
    s_cmp_lg_u32 s97, 1
    s_cbranch_scc1 L_hk25Y_0
    s_add_u32 s31, s3, 4
    s_and_b32 s31, s31, 7
    s_mul_i32 s31, s79, s31
    s_add_u32 s31, s31, s86
    buffer_load_dwordx4 v[228:231], v252, s[60:63], s31 offen
    s_add_u32 s31, s3, 5
    s_and_b32 s31, s31, 7
    s_mul_i32 s31, s79, s31
    s_add_u32 s31, s31, s86
    buffer_load_dwordx4 v[232:235], v252, s[60:63], s31 offen
    s_nop 1
    s_branch L_hr25Y
L_hk25Y_0:
    s_cmp_lg_u32 s97, 2
    s_cbranch_scc1 L_hk25Y_1
    v_mov_b32 v248, -1
    v_mov_b32 v249, -1
    v_mov_b32 v250, -1
    v_mov_b32 v251, -1
    s_lshl_b32 s31, s26, 3
    s_and_b32 s32, s27, 7
    s_add_u32 s31, s31, s32
    s_mul_i32 s31, s31, 196608
    s_lshl_b32 s32, s28, 11
    s_add_u32 s31, s31, s32
    s_add_u32 s31, s31, 41943040
    s_lshr_b32 s32, s24, 1
    s_xor_b32 s32, s32, 1
    s_mul_i32 s32, s32, 49152
    s_add_u32 s32, s32, s31
    buffer_store_dwordx4 v[248:251], v11, s[56:59], s32 offen offset:0 sc1
    buffer_store_dwordx4 v[248:251], v11, s[56:59], s32 offen offset:1024 sc1
    s_lshr_b32 s32, s24, 1
    s_xor_b32 s32, s32, 2
    s_mul_i32 s32, s32, 49152
    s_add_u32 s32, s32, s31
    s_add_u32 s32, s32, 16384
    buffer_store_dwordx4 v[248:251], v11, s[56:59], s32 offen offset:0 sc1
    buffer_store_dwordx4 v[248:251], v11, s[56:59], s32 offen offset:1024 sc1
    s_nop 1
    s_branch L_hr25Y
L_hk25Y_1:
    s_mov_b32 s60, s20
    s_mov_b32 s61, s21
    s_mov_b32 s62, 64
    s_mov_b32 s38, 0
    s_mov_b32 s42, 0
    s_mov_b32 s46, 0
    s_mov_b32 s50, 0
    v_lshlrev_b32 v14, 2, v3
    buffer_load_dword v244, v14, s[60:63], 0 offen sc1
    s_nop 1
    s_branch L_hr25Y
L_hk51Y:
    s_cmp_lg_u32 s97, 1
    s_cbranch_scc1 L_hk51Y_0
    s_add_u32 s31, s3, 6
    s_and_b32 s31, s31, 7
    s_mul_i32 s31, s79, s31
    s_add_u32 s31, s31, s86
    buffer_load_dwordx4 v[236:239], v252, s[60:63], s31 offen
    s_add_u32 s31, s3, 7
    s_and_b32 s31, s31, 7
    s_mul_i32 s31, s79, s31
    s_add_u32 s31, s31, s86
    buffer_load_dwordx4 v[240:243], v252, s[60:63], s31 offen
    s_nop 1
    s_branch L_hr51Y
L_hk51Y_0:
    s_cmp_lg_u32 s97, 2
    s_cbranch_scc1 L_hk51Y_1
    v_and_b32 v14, 1, v3
    v_lshlrev_b32 v14, 4, v14
    v_mov_b32 v15, 0x3f80
    v_lshlrev_b32 v14, v14, v15
    v_bfe_u32 v15, v3, 1, 2
    v_cmp_eq_u32 vcc, 0, v15
    s_nop 1
    v_cndmask_b32 v244, 0, v14, vcc
    v_cmp_eq_u32 vcc, 1, v15
    s_nop 1
    v_cndmask_b32 v245, 0, v14, vcc
    v_cmp_eq_u32 vcc, 2, v15
    s_nop 1
    v_cndmask_b32 v246, 0, v14, vcc
    v_cmp_eq_u32 vcc, 3, v15
    s_nop 1
    v_cndmask_b32 v247, 0, v14, vcc
    s_waitcnt vmcnt(20)
    s_nop 0
    v_mfma_f32_16x16x32_bf16 v[248:251], v[244:247], v[212:215], 0
    v_mfma_f32_16x16x32_bf16 v[248:251], v[244:247], v[216:219], v[248:251]
    v_mfma_f32_16x16x32_bf16 v[248:251], v[244:247], v[220:223], v[248:251]
    v_mfma_f32_16x16x32_bf16 v[248:251], v[244:247], v[224:227], v[248:251]
    v_mfma_f32_16x16x32_bf16 v[248:251], v[244:247], v[228:231], v[248:251]
    v_mfma_f32_16x16x32_bf16 v[248:251], v[244:247], v[232:235], v[248:251]
    v_mfma_f32_16x16x32_bf16 v[248:251], v[244:247], v[236:239], v[248:251]
    v_mfma_f32_16x16x32_bf16 v[248:251], v[244:247], v[240:243], v[248:251]
    buffer_store_dword v254, v255, s[56:59], s77 offen sc1
    s_nop 6
    v_add_f32_dpp v248, v248, v248 row_ror:8 row_mask:0xf bank_mask:0xf
    v_add_f32_dpp v249, v249, v249 row_ror:8 row_mask:0xf bank_mask:0xf
    v_add_f32_dpp v250, v250, v250 row_ror:8 row_mask:0xf bank_mask:0xf
    v_add_f32_dpp v251, v251, v251 row_ror:8 row_mask:0xf bank_mask:0xf
    v_cvt_pk_bf16_f32 v14, v248, v249
    v_cvt_pk_bf16_f32 v15, v250, v251
    buffer_store_dwordx2 v[14:15], v253, s[56:59], s78 offen sc1
    v_mov_b32 v248, -1
    v_mov_b32 v249, -1
    v_mov_b32 v250, -1
    v_mov_b32 v251, -1
    s_lshl_b32 s31, s26, 3
    s_and_b32 s32, s27, 7
    s_add_u32 s31, s31, s32
    s_mul_i32 s31, s31, 196608
    s_lshl_b32 s32, s28, 11
    s_add_u32 s31, s31, s32
    s_add_u32 s31, s31, 41943040
    s_lshr_b32 s32, s24, 1
    s_xor_b32 s32, s32, 3
    s_mul_i32 s32, s32, 49152
    s_add_u32 s32, s32, s31
    s_add_u32 s32, s32, 32768
    buffer_store_dwordx4 v[248:251], v11, s[56:59], s32 offen offset:0 sc1
    buffer_store_dwordx4 v[248:251], v11, s[56:59], s32 offen offset:1024 sc1
    s_lshl_b32 s31, s101, 17
    s_lshl_b32 s32, s26, 14
    s_add_u32 s31, s31, s32
    s_lshl_b32 s32, s28, 11
    s_add_u32 s31, s31, s32
    s_add_u32 s31, s31, 33554432
    s_cmp_eq_u32 s100, 1
    s_cselect_b32 s31, 0x40000000, s31
    buffer_store_dwordx4 v[248:251], v11, s[56:59], s31 offen offset:0 sc1
    buffer_store_dwordx4 v[248:251], v11, s[56:59], s31 offen offset:1024 sc1
    s_nop 1
    s_branch L_hr51Y
L_hk51Y_1:
    s_waitcnt vmcnt(8)
    v_cmp_gt_u32 vcc, 16, v244
    s_mov_b32 s31, 0
    s_cbranch_vccz L_h4okY
L_h4spinY:
    buffer_load_dword v244, v14, s[60:63], 0 offen sc1
    s_add_u32 s31, s31, 1
    s_waitcnt vmcnt(0)
    v_cmp_gt_u32 vcc, 16, v244
    s_cmp_gt_u32 s31, 200000
    s_cbranch_scc1 L_h4okY
    s_cbranch_vccnz L_h4spinY
L_h4okY:
    s_mov_b32 s54, 0
    s_lshl_b32 s31, s26, 12
    s_lshl_b32 s32, s28, 9
    s_add_u32 s31, s31, s32
    s_add_u32 s31, s31, 37748736
    v_and_b32 v15, 7, v1
    v_lshlrev_b32 v15, 2, v15
    buffer_load_dword v245, v15, s[56:59], s83 offen offset:64 sc1
    v_lshlrev_b32 v14, 4, v3
    buffer_load_dwordx4 v[216:219], v14, s[56:59], s31 offen offset:0 sc1
    buffer_load_dwordx4 v[220:223], v14, s[56:59], s31 offen offset:256 sc1
    s_nop 1
    s_branch L_hr51Y
L_grpX:
    s_waitcnt lgkmcnt(10)
    v_mfma_f32_16x16x32_bf16 v[24:27], v[128:131], v[180:183], v[24:27]
    ds_read_b64_tr_b16 v[152:153], v21 offset:4096
    v_mfma_f32_16x16x32_bf16 v[28:31], v[128:131], v[184:187], v[28:31]
    ds_read_b64_tr_b16 v[154:155], v21 offset:6144
    s_mov_b32 m0, s88
    s_nop 0
    buffer_load_dwordx4 v5, s[36:39], s64 offen sc1 lds
    s_add_u32 s64, s64, 393216
    s_waitcnt lgkmcnt(10)
    v_mfma_f32_16x16x32_bf16 v[32:35], v[132:135], v[180:183], v[32:35]
    ds_read_b64_tr_b16 v[156:157], v22 offset:4096
    v_mfma_f32_16x16x32_bf16 v[36:39], v[132:135], v[184:187], v[36:39]
    ds_read_b64_tr_b16 v[158:159], v22 offset:6144
    s_waitcnt vmcnt(3)
    ds_read_b128 v[196:199], v12 offset:4096
    v_add_u32 v23, s94, v23
    s_waitcnt lgkmcnt(11)
    v_mfma_f32_16x16x32_bf16 v[40:43], v[136:139], v[180:183], v[40:43]
    ds_read_b64_tr_b16 v[160:161], v23 offset:0
    v_mfma_f32_16x16x32_bf16 v[44:47], v[136:139], v[184:187], v[44:47]
    ds_read_b64_tr_b16 v[162:163], v23 offset:2560
    ds_read_b128 v[200:203], v12 offset:6144
    s_waitcnt lgkmcnt(12)
    v_mfma_f32_16x16x32_bf16 v[48:51], v[140:143], v[180:183], v[48:51]
    ds_read_b64_tr_b16 v[164:165], v23 offset:32
    v_mfma_f32_16x16x32_bf16 v[52:55], v[140:143], v[184:187], v[52:55]
    ds_read_b64_tr_b16 v[166:167], v23 offset:2592
    s_add_u32 m0, s88, 4096
    s_nop 0
    buffer_load_dwordx4 v6, s[40:43], s65 offen sc1 lds
    s_add_u32 s65, s65, s68
    s_waitcnt lgkmcnt(12)
    v_mfma_f32_16x16x32_bf16 v[56:59], v[144:147], v[180:183], v[56:59]
    ds_read_b64_tr_b16 v[168:169], v23 offset:64
    v_mfma_f32_16x16x32_bf16 v[60:63], v[144:147], v[184:187], v[60:63]
    ds_read_b64_tr_b16 v[170:171], v23 offset:2624
    ds_read_b128 v[204:207], v13 offset:4096
    s_add_u32 s93, s93, 1
    s_cmp_eq_u32 s93, 7
    s_cselect_b32 s94, 4294887424, s95
    s_cselect_b32 s93, 0, s93
    s_waitcnt lgkmcnt(13)
    v_mfma_f32_16x16x32_bf16 v[64:67], v[148:151], v[180:183], v[64:67]
    ds_read_b64_tr_b16 v[172:173], v23 offset:96
    v_mfma_f32_16x16x32_bf16 v[68:71], v[148:151], v[184:187], v[68:71]
    ds_read_b64_tr_b16 v[174:175], v23 offset:2656
    ds_read_b128 v[208:211], v13 offset:6144
    s_waitcnt lgkmcnt(14)
    v_mfma_f32_16x16x32_bf16 v[72:75], v[152:155], v[180:183], v[72:75]
    ds_read_b64_tr_b16 v[176:177], v23 offset:128
    v_mfma_f32_16x16x32_bf16 v[76:79], v[152:155], v[184:187], v[76:79]
    ds_read_b64_tr_b16 v[178:179], v23 offset:2688
    s_add_u32 m0, s88, 8192
    s_nop 0
    buffer_load_dwordx4 v7, s[44:47], s66 offen sc1 lds
    s_add_u32 s66, s66, 458752
    v_add_u32 v18, s94, v18
    s_waitcnt lgkmcnt(14)
    v_mfma_f32_16x16x32_bf16 v[80:83], v[156:159], v[180:183], v[80:83]
    ds_read_b64_tr_b16 v[128:129], v18 offset:0
    v_mfma_f32_16x16x32_bf16 v[84:87], v[156:159], v[184:187], v[84:87]
    ds_read_b64_tr_b16 v[130:131], v18 offset:2048
    s_add_u32 m0, s92, 0
    s_nop 0
    buffer_load_dwordx4 v9, s[52:55], s90 offen lds
    v_add_u32 v19, s94, v19
    s_waitcnt lgkmcnt(13)
    v_mfma_f32_16x16x32_bf16 v[88:91], v[160:163], v[180:183], v[88:91]
    ds_read_b64_tr_b16 v[132:133], v19 offset:0
    v_mfma_f32_16x16x32_bf16 v[92:95], v[160:163], v[184:187], v[92:95]
    ds_read_b64_tr_b16 v[134:135], v19 offset:2048
    s_add_u32 m0, s92, 1024
    s_nop 0
    buffer_load_dwordx4 v10, s[52:55], s90 offen lds
    s_add_u32 s90, s90, 128
    v_add_u32 v21, s94, v21
    s_waitcnt lgkmcnt(12)
    v_mfma_f32_16x16x32_bf16 v[96:99], v[164:167], v[180:183], v[96:99]
    ds_read_b64_tr_b16 v[136:137], v21 offset:0
    v_mfma_f32_16x16x32_bf16 v[100:103], v[164:167], v[184:187], v[100:103]
    ds_read_b64_tr_b16 v[138:139], v21 offset:2048
    s_add_u32 s89, s88, 12288
    s_cmp_eq_u32 s29, 0
    s_cselect_b32 m0, s89, 158720
    s_nop 0
    buffer_load_dwordx4 v8, s[48:51], s67 offen sc1 lds
    s_add_u32 s67, s67, s69
    s_add_u32 s88, s88, 26624
    s_sub_u32 s89, s88, 93184
    s_cmp_ge_u32 s88, s87
    s_cselect_b32 s88, s89, s88
    s_add_u32 m0, s92, 2048
    s_nop 0
    buffer_load_dwordx4 v9, s[52:55], s91 offen lds
    v_add_u32 v22, s94, v22
    s_waitcnt lgkmcnt(12)
    v_mfma_f32_16x16x32_bf16 v[104:107], v[168:171], v[180:183], v[104:107]
    ds_read_b64_tr_b16 v[140:141], v22 offset:0
    v_mfma_f32_16x16x32_bf16 v[108:111], v[168:171], v[184:187], v[108:111]
    ds_read_b64_tr_b16 v[142:143], v22 offset:2048
    s_add_u32 m0, s92, 3072
    s_nop 0
    buffer_load_dwordx4 v10, s[52:55], s91 offen lds
    s_add_u32 s91, s91, 128
    s_waitcnt lgkmcnt(11)
    v_mfma_f32_16x16x32_bf16 v[112:115], v[172:175], v[180:183], v[112:115]
    ds_read_b64_tr_b16 v[144:145], v18 offset:4096
    v_mfma_f32_16x16x32_bf16 v[116:119], v[172:175], v[184:187], v[116:119]
    ds_read_b64_tr_b16 v[146:147], v18 offset:6144
    s_add_u32 s31, s3, 2
    s_and_b32 s31, s31, 7
    s_mul_i32 s31, s79, s31
    s_add_u32 s31, s31, s86
    buffer_load_dwordx4 v[220:223], v252, s[60:63], s31 offen
    s_waitcnt lgkmcnt(10)
    v_mfma_f32_16x16x32_bf16 v[120:123], v[176:179], v[180:183], v[120:123]
    ds_read_b64_tr_b16 v[148:149], v19 offset:4096
    v_mfma_f32_16x16x32_bf16 v[124:127], v[176:179], v[184:187], v[124:127]
    ds_read_b64_tr_b16 v[150:151], v19 offset:6144
    s_add_u32 m0, s92, 4096
    s_nop 0
    buffer_load_dwordx4 v9, s[52:55], s90 offen lds
    s_waitcnt lgkmcnt(10)
    v_mfma_f32_16x16x32_bf16 v[24:27], v[128:131], v[188:191], v[24:27]
    ds_read_b64_tr_b16 v[152:153], v21 offset:4096
    v_mfma_f32_16x16x32_bf16 v[28:31], v[128:131], v[192:195], v[28:31]
    ds_read_b64_tr_b16 v[154:155], v21 offset:6144
    s_lshr_b32 s31, s27, 3
    s_lshl_b32 s31, s31, 3
    s_add_u32 s31, s31, s26
    s_lshl_b32 s31, s31, 3
    s_add_u32 s31, s31, s28
    s_lshl_b32 s31, s31, 7
    s_add_u32 s83, s31, 39845888
    s_and_b32 s32, s27, 7
    s_lshl_b32 s32, s32, 2
    s_add_u32 s81, s83, s32
    v_mov_b32 v14, v20
    v_writelane_b32 v14, s81, 0
    s_add_u32 s31, s81, 64
    v_writelane_b32 v14, s31, 2
    s_lshr_b32 s32, s32, 3
    s_lshl_b32 s32, s32, 2
    s_add_u32 s82, s83, s32
    s_add_u32 s82, s82, 32
    s_cmp_eq_u32 s100, 1
    s_cselect_b32 s31, s82, s81
    v_writelane_b32 v14, s31, 1
    s_getreg_b32 s31, hwreg(HW_REG_XCC_ID, 0, 16)
    v_mov_b32 v15, 0
    v_writelane_b32 v15, s31, 2
    buffer_store_dword v15, v14, s[56:59], 0 offen sc1
    s_waitcnt lgkmcnt(10)
    v_mfma_f32_16x16x32_bf16 v[32:35], v[132:135], v[188:191], v[32:35]
    ds_read_b64_tr_b16 v[156:157], v22 offset:4096
    v_mfma_f32_16x16x32_bf16 v[36:39], v[132:135], v[192:195], v[36:39]
    ds_read_b64_tr_b16 v[158:159], v22 offset:6144
    v_add_u32 v23, s94, v23
    s_waitcnt lgkmcnt(10)
    v_mfma_f32_16x16x32_bf16 v[40:43], v[136:139], v[188:191], v[40:43]
    ds_read_b64_tr_b16 v[160:161], v23 offset:0
    v_mfma_f32_16x16x32_bf16 v[44:47], v[136:139], v[192:195], v[44:47]
    ds_read_b64_tr_b16 v[162:163], v23 offset:2560
    s_add_u32 m0, s92, 5120
    s_nop 0
    buffer_load_dwordx4 v10, s[52:55], s90 offen lds
    s_add_u32 s90, s90, 128
    s_waitcnt lgkmcnt(10)
    v_mfma_f32_16x16x32_bf16 v[48:51], v[140:143], v[188:191], v[48:51]
    ds_read_b64_tr_b16 v[164:165], v23 offset:32
    v_mfma_f32_16x16x32_bf16 v[52:55], v[140:143], v[192:195], v[52:55]
    ds_read_b64_tr_b16 v[166:167], v23 offset:2592
    s_add_u32 s31, s3, 3
    s_and_b32 s31, s31, 7
    s_mul_i32 s31, s79, s31
    s_add_u32 s31, s31, s86
    buffer_load_dwordx4 v[224:227], v252, s[60:63], s31 offen
    s_waitcnt lgkmcnt(10)
    v_mfma_f32_16x16x32_bf16 v[56:59], v[144:147], v[188:191], v[56:59]
    ds_read_b64_tr_b16 v[168:169], v23 offset:64
    v_mfma_f32_16x16x32_bf16 v[60:63], v[144:147], v[192:195], v[60:63]
    ds_read_b64_tr_b16 v[170:171], v23 offset:2624
    s_add_u32 s93, s93, 1
    s_cmp_eq_u32 s93, 7
    s_cselect_b32 s94, 4294887424, s95
    s_cselect_b32 s93, 0, s93
    s_waitcnt lgkmcnt(10)
    v_mfma_f32_16x16x32_bf16 v[64:67], v[148:151], v[188:191], v[64:67]
    ds_read_b64_tr_b16 v[172:173], v23 offset:96
    v_mfma_f32_16x16x32_bf16 v[68:71], v[148:151], v[192:195], v[68:71]
    ds_read_b64_tr_b16 v[174:175], v23 offset:2656
    s_add_u32 m0, s92, 6144
    s_nop 0
    buffer_load_dwordx4 v9, s[52:55], s91 offen lds
    s_waitcnt lgkmcnt(10)
    v_mfma_f32_16x16x32_bf16 v[72:75], v[152:155], v[188:191], v[72:75]
    ds_read_b64_tr_b16 v[176:177], v23 offset:128
    v_mfma_f32_16x16x32_bf16 v[76:79], v[152:155], v[192:195], v[76:79]
    ds_read_b64_tr_b16 v[178:179], v23 offset:2688
    s_waitcnt vmcnt(20)
    s_barrier
    v_add_u32 v18, s94, v18
    s_waitcnt lgkmcnt(10)
    v_mfma_f32_16x16x32_bf16 v[80:83], v[156:159], v[188:191], v[80:83]
    ds_read_b64_tr_b16 v[128:129], v18 offset:0
    v_mfma_f32_16x16x32_bf16 v[84:87], v[156:159], v[192:195], v[84:87]
    ds_read_b64_tr_b16 v[130:131], v18 offset:2048
    v_add_u32 v19, s94, v19
    s_waitcnt lgkmcnt(10)
    v_mfma_f32_16x16x32_bf16 v[88:91], v[160:163], v[188:191], v[88:91]
    ds_read_b64_tr_b16 v[132:133], v19 offset:0
    v_mfma_f32_16x16x32_bf16 v[92:95], v[160:163], v[192:195], v[92:95]
    ds_read_b64_tr_b16 v[134:135], v19 offset:2048
    s_add_u32 s31, s3, 0
    s_and_b32 s31, s31, 7
    s_mul_i32 s31, s79, s31
    s_add_u32 s31, s31, s86
    buffer_load_dwordx4 v[212:215], v252, s[60:63], s31 offen
    v_add_u32 v21, s94, v21
    s_waitcnt lgkmcnt(10)
    v_mfma_f32_16x16x32_bf16 v[96:99], v[164:167], v[188:191], v[96:99]
    ds_read_b64_tr_b16 v[136:137], v21 offset:0
    v_mfma_f32_16x16x32_bf16 v[100:103], v[164:167], v[192:195], v[100:103]
    ds_read_b64_tr_b16 v[138:139], v21 offset:2048
    s_add_u32 m0, s92, 7168
    s_nop 0
    buffer_load_dwordx4 v10, s[52:55], s91 offen lds
    s_add_u32 s91, s91, 128
    v_add_u32 v22, s94, v22
    s_waitcnt lgkmcnt(10)
    v_mfma_f32_16x16x32_bf16 v[104:107], v[168:171], v[188:191], v[104:107]
    ds_read_b64_tr_b16 v[140:141], v22 offset:0
    v_mfma_f32_16x16x32_bf16 v[108:111], v[168:171], v[192:195], v[108:111]
    ds_read_b64_tr_b16 v[142:143], v22 offset:2048
    s_waitcnt lgkmcnt(10)
    v_mfma_f32_16x16x32_bf16 v[112:115], v[172:175], v[188:191], v[112:115]
    ds_read_b64_tr_b16 v[144:145], v18 offset:4096
    v_mfma_f32_16x16x32_bf16 v[116:119], v[172:175], v[192:195], v[116:119]
    ds_read_b64_tr_b16 v[146:147], v18 offset:6144
    s_cmp_eq_u32 s97, s76
    s_cselect_b32 s31, 2048, 0
    s_sub_u32 s90, s90, s31
    s_sub_u32 s91, s91, s31
    s_waitcnt vmcnt(16)
    v_lshlrev_b32 v16, 16, v244
    v_and_b32 v17, 0xffff0000, v244
    v_pk_mul_f32 v[254:255], v[16:17], v[16:17]
    v_add_f32 v14, v16, v17
    v_lshlrev_b32 v16, 16, v245
    s_waitcnt lgkmcnt(10)
    v_mfma_f32_16x16x32_bf16 v[120:123], v[176:179], v[188:191], v[120:123]
    ds_read_b64_tr_b16 v[148:149], v19 offset:4096
    v_mfma_f32_16x16x32_bf16 v[124:127], v[176:179], v[192:195], v[124:127]
    ds_read_b64_tr_b16 v[150:151], v19 offset:6144
    v_and_b32 v17, 0xffff0000, v245
    v_pk_fma_f32 v[254:255], v[16:17], v[16:17], v[254:255]
    v_add_f32 v14, v14, v16
    v_add_f32 v14, v14, v17
    v_lshlrev_b32 v16, 16, v246
    v_and_b32 v17, 0xffff0000, v246
    s_waitcnt lgkmcnt(10)
    v_mfma_f32_16x16x32_bf16 v[24:27], v[128:131], v[196:199], v[24:27]
    ds_read_b64_tr_b16 v[152:153], v21 offset:4096
    v_mfma_f32_16x16x32_bf16 v[28:31], v[128:131], v[200:203], v[28:31]
    ds_read_b64_tr_b16 v[154:155], v21 offset:6144
    s_mov_b32 m0, s88
    s_nop 0
    buffer_load_dwordx4 v5, s[36:39], s64 offen sc1 lds
    s_add_u32 s64, s64, 393216
    v_pk_fma_f32 v[254:255], v[16:17], v[16:17], v[254:255]
    v_add_f32 v14, v14, v16
    v_add_f32 v14, v14, v17
    v_lshlrev_b32 v16, 16, v247
    v_and_b32 v17, 0xffff0000, v247
    v_pk_fma_f32 v[254:255], v[16:17], v[16:17], v[254:255]
    s_waitcnt lgkmcnt(10)
    v_mfma_f32_16x16x32_bf16 v[32:35], v[132:135], v[196:199], v[32:35]
    ds_read_b64_tr_b16 v[156:157], v22 offset:4096
    v_mfma_f32_16x16x32_bf16 v[36:39], v[132:135], v[200:203], v[36:39]
    ds_read_b64_tr_b16 v[158:159], v22 offset:6144
    s_waitcnt vmcnt(9)
    ds_read_b128 v[180:183], v12 offset:0
    v_add_f32 v14, v14, v16
    v_add_f32 v14, v14, v17
    v_lshlrev_b32 v16, 16, v248
    v_and_b32 v17, 0xffff0000, v248
    v_pk_fma_f32 v[254:255], v[16:17], v[16:17], v[254:255]
    v_add_f32 v14, v14, v16
    v_add_u32 v23, s94, v23
    s_waitcnt lgkmcnt(11)
    v_mfma_f32_16x16x32_bf16 v[40:43], v[136:139], v[196:199], v[40:43]
    ds_read_b64_tr_b16 v[160:161], v23 offset:0
    v_mfma_f32_16x16x32_bf16 v[44:47], v[136:139], v[200:203], v[44:47]
    ds_read_b64_tr_b16 v[162:163], v23 offset:2560
    ds_read_b128 v[184:187], v12 offset:2048
    v_add_f32 v14, v14, v17
    v_lshlrev_b32 v16, 16, v249
    v_and_b32 v17, 0xffff0000, v249
    v_pk_fma_f32 v[254:255], v[16:17], v[16:17], v[254:255]
    v_add_f32 v14, v14, v16
    v_add_f32 v14, v14, v17
    s_waitcnt lgkmcnt(12)
    v_mfma_f32_16x16x32_bf16 v[48:51], v[140:143], v[196:199], v[48:51]
    ds_read_b64_tr_b16 v[164:165], v23 offset:32
    v_mfma_f32_16x16x32_bf16 v[52:55], v[140:143], v[200:203], v[52:55]
    ds_read_b64_tr_b16 v[166:167], v23 offset:2592
    s_add_u32 m0, s88, 4096
    s_nop 0
    buffer_load_dwordx4 v6, s[40:43], s65 offen sc1 lds
    s_add_u32 s65, s65, s68
    v_lshlrev_b32 v16, 16, v250
    v_and_b32 v17, 0xffff0000, v250
    v_pk_fma_f32 v[254:255], v[16:17], v[16:17], v[254:255]
    v_add_f32 v14, v14, v16
    v_add_f32 v14, v14, v17
    v_lshlrev_b32 v16, 16, v251
    s_waitcnt lgkmcnt(12)
    v_mfma_f32_16x16x32_bf16 v[56:59], v[144:147], v[196:199], v[56:59]
    ds_read_b64_tr_b16 v[168:169], v23 offset:64
    v_mfma_f32_16x16x32_bf16 v[60:63], v[144:147], v[200:203], v[60:63]
    ds_read_b64_tr_b16 v[170:171], v23 offset:2624
    ds_read_b128 v[188:191], v13 offset:0
    v_and_b32 v17, 0xffff0000, v251
    v_pk_fma_f32 v[254:255], v[16:17], v[16:17], v[254:255]
    v_add_f32 v14, v14, v16
    v_add_f32 v14, v14, v17
    v_add_f32 v15, v254, v255
    s_nop 1
    v_permlane32_swap_b32 v14, v15
    s_add_u32 s93, s93, 1
    s_cmp_eq_u32 s93, 7
    s_cselect_b32 s94, 4294887424, s95
    s_cselect_b32 s93, 0, s93
    s_waitcnt lgkmcnt(13)
    v_mfma_f32_16x16x32_bf16 v[64:67], v[148:151], v[196:199], v[64:67]
    ds_read_b64_tr_b16 v[172:173], v23 offset:96
    v_mfma_f32_16x16x32_bf16 v[68:71], v[148:151], v[200:203], v[68:71]
    ds_read_b64_tr_b16 v[174:175], v23 offset:2656
    ds_read_b128 v[192:195], v13 offset:2048
    v_add_f32 v14, v14, v15
    v_mov_b32 v15, v14
    s_nop 1
    v_permlane16_swap_b32 v14, v15
    v_add_f32 v14, v14, v15
    s_nop 1
    v_add_f32_dpp v14, v14, v14 row_ror:1 row_mask:0xf bank_mask:0xf
    s_nop 1
    v_add_f32_dpp v14, v14, v14 row_ror:2 row_mask:0xf bank_mask:0xf
    s_waitcnt lgkmcnt(14)
    v_mfma_f32_16x16x32_bf16 v[72:75], v[152:155], v[196:199], v[72:75]
    ds_read_b64_tr_b16 v[176:177], v23 offset:128
    v_mfma_f32_16x16x32_bf16 v[76:79], v[152:155], v[200:203], v[76:79]
    ds_read_b64_tr_b16 v[178:179], v23 offset:2688
    s_add_u32 m0, s88, 8192
    s_nop 0
    buffer_load_dwordx4 v7, s[44:47], s66 offen sc1 lds
    s_add_u32 s66, s66, 458752
    v_add_f32_dpp v14, v14, v14 row_ror:4 row_mask:0xf bank_mask:0xf
    s_nop 1
    v_add_f32_dpp v14, v14, v14 row_ror:8 row_mask:0xf bank_mask:0xf
    v_mul_f32 v14, 0x3a800000, v14
    s_nop 0
    v_readlane_b32 s31, v14, 32
    v_mul_f32 v15, v14, v14
    s_nop 0
    v_sub_f32 v15, s31, v15
    v_max_f32 v15, 0, v15
    v_cvt_pk_bf16_f32 v244, -v14, -v14
    v_add_f32 v15, 0x3727c5ac, v15
    v_sqrt_f32 v15, v15
    s_nop 0
    v_cvt_pk_bf16_f32 v15, 0, v15
    v_lshrrev_b32 v245, 16, v15
    v_rcp_f32 v246, v15
    v_mul_f32 v247, v15, v15
    v_cmp_eq_u32 vcc, 0, v1
    s_nop 1
    v_cndmask_b32 v14, v20, v1, vcc
    s_lshl_b32 s31, s80, 4
    s_add_u32 s31, s31, 37748736
    buffer_store_dwordx4 v[244:247], v14, s[56:59], s31 offen sc1
    v_add_u32 v18, s94, v18
    s_waitcnt lgkmcnt(14)
    v_mfma_f32_16x16x32_bf16 v[80:83], v[156:159], v[196:199], v[80:83]
    ds_read_b64_tr_b16 v[128:129], v18 offset:0
    v_mfma_f32_16x16x32_bf16 v[84:87], v[156:159], v[200:203], v[84:87]
    ds_read_b64_tr_b16 v[130:131], v18 offset:2048
    s_mov_b32 s72, s8
    s_mov_b32 s73, s9
    s_mov_b32 s74, 65536
    s_mov_b32 s75, 0x00020000
    s_lshl_b32 s31, s29, 10
    s_add_u32 m0, s31, 159744
    s_lshl_b32 s32, s101, 12
    s_add_u32 s32, s32, s31
    buffer_load_dwordx4 v11, s[72:75], s32 offen lds
    v_add_u32 v19, s94, v19
    s_waitcnt lgkmcnt(13)
    v_mfma_f32_16x16x32_bf16 v[88:91], v[160:163], v[196:199], v[88:91]
    ds_read_b64_tr_b16 v[132:133], v19 offset:0
    v_mfma_f32_16x16x32_bf16 v[92:95], v[160:163], v[200:203], v[92:95]
    ds_read_b64_tr_b16 v[134:135], v19 offset:2048
    v_add_u32 v21, s94, v21
    s_waitcnt lgkmcnt(12)
    v_mfma_f32_16x16x32_bf16 v[96:99], v[164:167], v[196:199], v[96:99]
    ds_read_b64_tr_b16 v[136:137], v21 offset:0
    v_mfma_f32_16x16x32_bf16 v[100:103], v[164:167], v[200:203], v[100:103]
    ds_read_b64_tr_b16 v[138:139], v21 offset:2048
    s_add_u32 s89, s88, 12288
    s_cmp_eq_u32 s29, 0
    s_cselect_b32 m0, s89, 158720
    s_nop 0
    buffer_load_dwordx4 v8, s[48:51], s67 offen sc1 lds
    s_add_u32 s67, s67, s69
    s_add_u32 s88, s88, 26624
    s_sub_u32 s89, s88, 93184
    s_cmp_ge_u32 s88, s87
    s_cselect_b32 s88, s89, s88
    s_add_u32 s31, s3, 1
    s_and_b32 s31, s31, 7
    s_mul_i32 s31, s79, s31
    s_add_u32 s31, s31, s86
    buffer_load_dwordx4 v[216:219], v252, s[60:63], s31 offen
    v_add_u32 v22, s94, v22
    s_waitcnt lgkmcnt(12)
    v_mfma_f32_16x16x32_bf16 v[104:107], v[168:171], v[196:199], v[104:107]
    ds_read_b64_tr_b16 v[140:141], v22 offset:0
    v_mfma_f32_16x16x32_bf16 v[108:111], v[168:171], v[200:203], v[108:111]
    ds_read_b64_tr_b16 v[142:143], v22 offset:2048
    s_waitcnt lgkmcnt(11)
    v_mfma_f32_16x16x32_bf16 v[112:115], v[172:175], v[196:199], v[112:115]
    ds_read_b64_tr_b16 v[144:145], v18 offset:4096
    v_mfma_f32_16x16x32_bf16 v[116:119], v[172:175], v[200:203], v[116:119]
    ds_read_b64_tr_b16 v[146:147], v18 offset:6144
    s_waitcnt lgkmcnt(10)
    v_mfma_f32_16x16x32_bf16 v[120:123], v[176:179], v[196:199], v[120:123]
    ds_read_b64_tr_b16 v[148:149], v19 offset:4096
    v_mfma_f32_16x16x32_bf16 v[124:127], v[176:179], v[200:203], v[124:127]
    ds_read_b64_tr_b16 v[150:151], v19 offset:6144
    s_add_u32 m0, s92, 0
    s_nop 0
    buffer_load_dwordx4 v9, s[52:55], s90 offen lds
    s_waitcnt lgkmcnt(10)
    v_mfma_f32_16x16x32_bf16 v[24:27], v[128:131], v[204:207], v[24:27]
    ds_read_b64_tr_b16 v[152:153], v21 offset:4096
    v_mfma_f32_16x16x32_bf16 v[28:31], v[128:131], v[208:211], v[28:31]
    ds_read_b64_tr_b16 v[154:155], v21 offset:6144
    s_waitcnt lgkmcnt(10)
    v_mfma_f32_16x16x32_bf16 v[32:35], v[132:135], v[204:207], v[32:35]
    ds_read_b64_tr_b16 v[156:157], v22 offset:4096
    v_mfma_f32_16x16x32_bf16 v[36:39], v[132:135], v[208:211], v[36:39]
    ds_read_b64_tr_b16 v[158:159], v22 offset:6144
    v_add_u32 v23, s94, v23
    s_waitcnt lgkmcnt(10)
    v_mfma_f32_16x16x32_bf16 v[40:43], v[136:139], v[204:207], v[40:43]
    ds_read_b64_tr_b16 v[160:161], v23 offset:0
    v_mfma_f32_16x16x32_bf16 v[44:47], v[136:139], v[208:211], v[44:47]
    ds_read_b64_tr_b16 v[162:163], v23 offset:2560
    s_add_u32 m0, s92, 1024
    s_nop 0
    buffer_load_dwordx4 v10, s[52:55], s90 offen lds
    s_add_u32 s90, s90, 128
    s_waitcnt lgkmcnt(10)
    v_mfma_f32_16x16x32_bf16 v[48:51], v[140:143], v[204:207], v[48:51]
    ds_read_b64_tr_b16 v[164:165], v23 offset:32
    v_mfma_f32_16x16x32_bf16 v[52:55], v[140:143], v[208:211], v[52:55]
    ds_read_b64_tr_b16 v[166:167], v23 offset:2592
    s_waitcnt lgkmcnt(10)
    v_mfma_f32_16x16x32_bf16 v[56:59], v[144:147], v[204:207], v[56:59]
    ds_read_b64_tr_b16 v[168:169], v23 offset:64
    v_mfma_f32_16x16x32_bf16 v[60:63], v[144:147], v[208:211], v[60:63]
    ds_read_b64_tr_b16 v[170:171], v23 offset:2624
    s_add_u32 s93, s93, 1
    s_cmp_eq_u32 s93, 7
    s_cselect_b32 s94, 4294887424, s95
    s_cselect_b32 s93, 0, s93
    s_waitcnt lgkmcnt(10)
    v_mfma_f32_16x16x32_bf16 v[64:67], v[148:151], v[204:207], v[64:67]
    ds_read_b64_tr_b16 v[172:173], v23 offset:96
    v_mfma_f32_16x16x32_bf16 v[68:71], v[148:151], v[208:211], v[68:71]
    ds_read_b64_tr_b16 v[174:175], v23 offset:2656
    s_add_u32 m0, s92, 2048
    s_nop 0
    buffer_load_dwordx4 v9, s[52:55], s91 offen lds
    s_waitcnt lgkmcnt(10)
    v_mfma_f32_16x16x32_bf16 v[72:75], v[152:155], v[204:207], v[72:75]
    ds_read_b64_tr_b16 v[176:177], v23 offset:128
    v_mfma_f32_16x16x32_bf16 v[76:79], v[152:155], v[208:211], v[76:79]
    ds_read_b64_tr_b16 v[178:179], v23 offset:2688
    s_mov_b32 s72, s14
    s_mov_b32 s73, s15
    s_mov_b32 s74, 7168
    s_mov_b32 s75, 0x00020000
    s_cmp_eq_u32 s28, 7
    s_cselect_b32 s33, 7, 0
    v_lshlrev_b32 v255, 2, v1
    v_cmp_gt_u32 vcc, s33, v1
    s_nop 1
    v_cndmask_b32 v255, v20, v255, vcc
    s_mul_i32 s31, s2, 28
    s_add_u32 s77, s31, 36945920
    buffer_load_dword v254, v255, s[72:75], s31 offen
    s_waitcnt vmcnt(21)
    s_barrier
    v_add_u32 v18, s94, v18
    s_waitcnt lgkmcnt(10)
    v_mfma_f32_16x16x32_bf16 v[80:83], v[156:159], v[204:207], v[80:83]
    ds_read_b64_tr_b16 v[128:129], v18 offset:0
    v_mfma_f32_16x16x32_bf16 v[84:87], v[156:159], v[208:211], v[84:87]
    ds_read_b64_tr_b16 v[130:131], v18 offset:2048
    s_lshl_b32 s32, s68, 4
    s_cmp_eq_u32 s97, s76
    s_cselect_b32 s31, 6291456, 0
    s_cselect_b32 s32, s32, 0
    s_cselect_b32 s33, 7340032, 0
    s_cselect_b32 s34, s96, 0
    s_sub_u32 s64, s64, s31
    s_sub_u32 s65, s65, s32
    s_sub_u32 s66, s66, s33
    s_sub_u32 s67, s67, s34
    v_add_u32 v19, s94, v19
    s_waitcnt lgkmcnt(10)
    v_mfma_f32_16x16x32_bf16 v[88:91], v[160:163], v[204:207], v[88:91]
    ds_read_b64_tr_b16 v[132:133], v19 offset:0
    v_mfma_f32_16x16x32_bf16 v[92:95], v[160:163], v[208:211], v[92:95]
    ds_read_b64_tr_b16 v[134:135], v19 offset:2048
    v_add_u32 v21, s94, v21
    s_waitcnt lgkmcnt(10)
    v_mfma_f32_16x16x32_bf16 v[96:99], v[164:167], v[204:207], v[96:99]
    ds_read_b64_tr_b16 v[136:137], v21 offset:0
    v_mfma_f32_16x16x32_bf16 v[100:103], v[164:167], v[208:211], v[100:103]
    ds_read_b64_tr_b16 v[138:139], v21 offset:2048
    s_add_u32 m0, s92, 3072
    s_nop 0
    buffer_load_dwordx4 v10, s[52:55], s91 offen lds
    s_add_u32 s91, s91, 128
    v_add_u32 v22, s94, v22
    s_waitcnt lgkmcnt(10)
    v_mfma_f32_16x16x32_bf16 v[104:107], v[168:171], v[204:207], v[104:107]
    ds_read_b64_tr_b16 v[140:141], v22 offset:0
    v_mfma_f32_16x16x32_bf16 v[108:111], v[168:171], v[208:211], v[108:111]
    ds_read_b64_tr_b16 v[142:143], v22 offset:2048
    s_waitcnt lgkmcnt(10)
    v_mfma_f32_16x16x32_bf16 v[112:115], v[172:175], v[204:207], v[112:115]
    ds_read_b64_tr_b16 v[144:145], v18 offset:4096
    v_mfma_f32_16x16x32_bf16 v[116:119], v[172:175], v[208:211], v[116:119]
    ds_read_b64_tr_b16 v[146:147], v18 offset:6144
    s_waitcnt lgkmcnt(10)
    v_mfma_f32_16x16x32_bf16 v[120:123], v[176:179], v[204:207], v[120:123]
    ds_read_b64_tr_b16 v[148:149], v19 offset:4096
    v_mfma_f32_16x16x32_bf16 v[124:127], v[176:179], v[208:211], v[124:127]
    ds_read_b64_tr_b16 v[150:151], v19 offset:6144
    s_mov_b32 s97, 1
.p2align 6
L_loopX:
    s_waitcnt lgkmcnt(10)
    v_mfma_f32_16x16x32_bf16 v[24:27], v[128:131], v[180:183], v[24:27]
    ds_read_b64_tr_b16 v[152:153], v21 offset:4096
    v_mfma_f32_16x16x32_bf16 v[28:31], v[128:131], v[184:187], v[28:31]
    ds_read_b64_tr_b16 v[154:155], v21 offset:6144
    s_mov_b32 m0, s88
    s_nop 0
    buffer_load_dwordx4 v5, s[36:39], s64 offen sc1 lds
    s_add_u32 s64, s64, 393216
    s_waitcnt lgkmcnt(10)
    v_mfma_f32_16x16x32_bf16 v[32:35], v[132:135], v[180:183], v[32:35]
    ds_read_b64_tr_b16 v[156:157], v22 offset:4096
    v_mfma_f32_16x16x32_bf16 v[36:39], v[132:135], v[184:187], v[36:39]
    ds_read_b64_tr_b16 v[158:159], v22 offset:6144
    s_waitcnt vmcnt(9)
    ds_read_b128 v[196:199], v12 offset:4096
    v_add_u32 v23, s94, v23
    s_waitcnt lgkmcnt(11)
    v_mfma_f32_16x16x32_bf16 v[40:43], v[136:139], v[180:183], v[40:43]
    ds_read_b64_tr_b16 v[160:161], v23 offset:0
    v_mfma_f32_16x16x32_bf16 v[44:47], v[136:139], v[184:187], v[44:47]
    ds_read_b64_tr_b16 v[162:163], v23 offset:2560
    ds_read_b128 v[200:203], v12 offset:6144
    s_waitcnt lgkmcnt(12)
    v_mfma_f32_16x16x32_bf16 v[48:51], v[140:143], v[180:183], v[48:51]
    ds_read_b64_tr_b16 v[164:165], v23 offset:32
    v_mfma_f32_16x16x32_bf16 v[52:55], v[140:143], v[184:187], v[52:55]
    ds_read_b64_tr_b16 v[166:167], v23 offset:2592
    s_add_u32 m0, s88, 4096
    s_nop 0
    buffer_load_dwordx4 v6, s[40:43], s65 offen sc1 lds
    s_add_u32 s65, s65, s68
    s_waitcnt lgkmcnt(12)
    v_mfma_f32_16x16x32_bf16 v[56:59], v[144:147], v[180:183], v[56:59]
    ds_read_b64_tr_b16 v[168:169], v23 offset:64
    v_mfma_f32_16x16x32_bf16 v[60:63], v[144:147], v[184:187], v[60:63]
    ds_read_b64_tr_b16 v[170:171], v23 offset:2624
    ds_read_b128 v[204:207], v13 offset:4096
    s_add_u32 s93, s93, 1
    s_cmp_eq_u32 s93, 7
    s_cselect_b32 s94, 4294887424, s95
    s_cselect_b32 s93, 0, s93
    s_waitcnt lgkmcnt(13)
    v_mfma_f32_16x16x32_bf16 v[64:67], v[148:151], v[180:183], v[64:67]
    ds_read_b64_tr_b16 v[172:173], v23 offset:96
    v_mfma_f32_16x16x32_bf16 v[68:71], v[148:151], v[184:187], v[68:71]
    ds_read_b64_tr_b16 v[174:175], v23 offset:2656
    ds_read_b128 v[208:211], v13 offset:6144
    s_waitcnt lgkmcnt(14)
    v_mfma_f32_16x16x32_bf16 v[72:75], v[152:155], v[180:183], v[72:75]
    ds_read_b64_tr_b16 v[176:177], v23 offset:128
    v_mfma_f32_16x16x32_bf16 v[76:79], v[152:155], v[184:187], v[76:79]
    ds_read_b64_tr_b16 v[178:179], v23 offset:2688
    s_add_u32 m0, s88, 8192
    s_nop 0
    buffer_load_dwordx4 v7, s[44:47], s66 offen sc1 lds
    s_add_u32 s66, s66, 458752
    v_add_u32 v18, s94, v18
    s_waitcnt lgkmcnt(14)
    v_mfma_f32_16x16x32_bf16 v[80:83], v[156:159], v[180:183], v[80:83]
    ds_read_b64_tr_b16 v[128:129], v18 offset:0
    v_mfma_f32_16x16x32_bf16 v[84:87], v[156:159], v[184:187], v[84:87]
    ds_read_b64_tr_b16 v[130:131], v18 offset:2048
    v_add_u32 v19, s94, v19
    s_waitcnt lgkmcnt(13)
    v_mfma_f32_16x16x32_bf16 v[88:91], v[160:163], v[180:183], v[88:91]
    ds_read_b64_tr_b16 v[132:133], v19 offset:0
    v_mfma_f32_16x16x32_bf16 v[92:95], v[160:163], v[184:187], v[92:95]
    ds_read_b64_tr_b16 v[134:135], v19 offset:2048
    v_add_u32 v21, s94, v21
    s_waitcnt lgkmcnt(12)
    v_mfma_f32_16x16x32_bf16 v[96:99], v[164:167], v[180:183], v[96:99]
    ds_read_b64_tr_b16 v[136:137], v21 offset:0
    v_mfma_f32_16x16x32_bf16 v[100:103], v[164:167], v[184:187], v[100:103]
    ds_read_b64_tr_b16 v[138:139], v21 offset:2048
    s_add_u32 s89, s88, 12288
    s_cmp_eq_u32 s29, 0
    s_cselect_b32 m0, s89, 158720
    s_nop 0
    buffer_load_dwordx4 v8, s[48:51], s67 offen sc1 lds
    s_add_u32 s67, s67, s69
    s_add_u32 s88, s88, 26624
    s_sub_u32 s89, s88, 93184
    s_cmp_ge_u32 s88, s87
    s_cselect_b32 s88, s89, s88
    v_add_u32 v22, s94, v22
    s_waitcnt lgkmcnt(12)
    v_mfma_f32_16x16x32_bf16 v[104:107], v[168:171], v[180:183], v[104:107]
    ds_read_b64_tr_b16 v[140:141], v22 offset:0
    v_mfma_f32_16x16x32_bf16 v[108:111], v[168:171], v[184:187], v[108:111]
    ds_read_b64_tr_b16 v[142:143], v22 offset:2048
    s_waitcnt lgkmcnt(11)
    v_mfma_f32_16x16x32_bf16 v[112:115], v[172:175], v[180:183], v[112:115]
    ds_read_b64_tr_b16 v[144:145], v18 offset:4096
    v_mfma_f32_16x16x32_bf16 v[116:119], v[172:175], v[184:187], v[116:119]
    ds_read_b64_tr_b16 v[146:147], v18 offset:6144
    s_waitcnt lgkmcnt(10)
    v_mfma_f32_16x16x32_bf16 v[120:123], v[176:179], v[180:183], v[120:123]
    ds_read_b64_tr_b16 v[148:149], v19 offset:4096
    v_mfma_f32_16x16x32_bf16 v[124:127], v[176:179], v[184:187], v[124:127]
    ds_read_b64_tr_b16 v[150:151], v19 offset:6144
    s_add_u32 m0, s92, 4096
    s_nop 0
    buffer_load_dwordx4 v9, s[52:55], s90 offen lds
    s_waitcnt lgkmcnt(10)
    v_mfma_f32_16x16x32_bf16 v[24:27], v[128:131], v[188:191], v[24:27]
    ds_read_b64_tr_b16 v[152:153], v21 offset:4096
    v_mfma_f32_16x16x32_bf16 v[28:31], v[128:131], v[192:195], v[28:31]
    ds_read_b64_tr_b16 v[154:155], v21 offset:6144
    s_waitcnt lgkmcnt(10)
    v_mfma_f32_16x16x32_bf16 v[32:35], v[132:135], v[188:191], v[32:35]
    ds_read_b64_tr_b16 v[156:157], v22 offset:4096
    v_mfma_f32_16x16x32_bf16 v[36:39], v[132:135], v[192:195], v[36:39]
    ds_read_b64_tr_b16 v[158:159], v22 offset:6144
    v_add_u32 v23, s94, v23
    s_waitcnt lgkmcnt(10)
    v_mfma_f32_16x16x32_bf16 v[40:43], v[136:139], v[188:191], v[40:43]
    ds_read_b64_tr_b16 v[160:161], v23 offset:0
    v_mfma_f32_16x16x32_bf16 v[44:47], v[136:139], v[192:195], v[44:47]
    ds_read_b64_tr_b16 v[162:163], v23 offset:2560
    s_add_u32 m0, s92, 5120
    s_nop 0
    buffer_load_dwordx4 v10, s[52:55], s90 offen lds
    s_add_u32 s90, s90, 128
    s_waitcnt lgkmcnt(10)
    v_mfma_f32_16x16x32_bf16 v[48:51], v[140:143], v[188:191], v[48:51]
    ds_read_b64_tr_b16 v[164:165], v23 offset:32
    v_mfma_f32_16x16x32_bf16 v[52:55], v[140:143], v[192:195], v[52:55]
    ds_read_b64_tr_b16 v[166:167], v23 offset:2592
    s_waitcnt lgkmcnt(10)
    v_mfma_f32_16x16x32_bf16 v[56:59], v[144:147], v[188:191], v[56:59]
    ds_read_b64_tr_b16 v[168:169], v23 offset:64
    v_mfma_f32_16x16x32_bf16 v[60:63], v[144:147], v[192:195], v[60:63]
    ds_read_b64_tr_b16 v[170:171], v23 offset:2624
    s_add_u32 s93, s93, 1
    s_cmp_eq_u32 s93, 7
    s_cselect_b32 s94, 4294887424, s95
    s_cselect_b32 s93, 0, s93
    s_waitcnt lgkmcnt(10)
    v_mfma_f32_16x16x32_bf16 v[64:67], v[148:151], v[188:191], v[64:67]
    ds_read_b64_tr_b16 v[172:173], v23 offset:96
    v_mfma_f32_16x16x32_bf16 v[68:71], v[148:151], v[192:195], v[68:71]
    ds_read_b64_tr_b16 v[174:175], v23 offset:2656
    s_add_u32 m0, s92, 6144
    s_nop 0
    buffer_load_dwordx4 v9, s[52:55], s91 offen lds
    s_waitcnt lgkmcnt(10)
    v_mfma_f32_16x16x32_bf16 v[72:75], v[152:155], v[188:191], v[72:75]
    ds_read_b64_tr_b16 v[176:177], v23 offset:128
    v_mfma_f32_16x16x32_bf16 v[76:79], v[152:155], v[192:195], v[76:79]
    ds_read_b64_tr_b16 v[178:179], v23 offset:2688
    s_waitcnt vmcnt(11)
    s_barrier
    v_add_u32 v18, s94, v18
    s_waitcnt lgkmcnt(10)
    v_mfma_f32_16x16x32_bf16 v[80:83], v[156:159], v[188:191], v[80:83]
    ds_read_b64_tr_b16 v[128:129], v18 offset:0
    v_mfma_f32_16x16x32_bf16 v[84:87], v[156:159], v[192:195], v[84:87]
    ds_read_b64_tr_b16 v[130:131], v18 offset:2048
    v_add_u32 v19, s94, v19
    s_waitcnt lgkmcnt(10)
    v_mfma_f32_16x16x32_bf16 v[88:91], v[160:163], v[188:191], v[88:91]
    ds_read_b64_tr_b16 v[132:133], v19 offset:0
    v_mfma_f32_16x16x32_bf16 v[92:95], v[160:163], v[192:195], v[92:95]
    ds_read_b64_tr_b16 v[134:135], v19 offset:2048
    v_add_u32 v21, s94, v21
    s_waitcnt lgkmcnt(10)
    v_mfma_f32_16x16x32_bf16 v[96:99], v[164:167], v[188:191], v[96:99]
    ds_read_b64_tr_b16 v[136:137], v21 offset:0
    v_mfma_f32_16x16x32_bf16 v[100:103], v[164:167], v[192:195], v[100:103]
    ds_read_b64_tr_b16 v[138:139], v21 offset:2048
    s_add_u32 m0, s92, 7168
    s_nop 0
    buffer_load_dwordx4 v10, s[52:55], s91 offen lds
    s_add_u32 s91, s91, 128
    v_add_u32 v22, s94, v22
    s_waitcnt lgkmcnt(10)
    v_mfma_f32_16x16x32_bf16 v[104:107], v[168:171], v[188:191], v[104:107]
    ds_read_b64_tr_b16 v[140:141], v22 offset:0
    v_mfma_f32_16x16x32_bf16 v[108:111], v[168:171], v[192:195], v[108:111]
    ds_read_b64_tr_b16 v[142:143], v22 offset:2048
    s_waitcnt lgkmcnt(10)
    v_mfma_f32_16x16x32_bf16 v[112:115], v[172:175], v[188:191], v[112:115]
    ds_read_b64_tr_b16 v[144:145], v18 offset:4096
    v_mfma_f32_16x16x32_bf16 v[116:119], v[172:175], v[192:195], v[116:119]
    ds_read_b64_tr_b16 v[146:147], v18 offset:6144
    s_cmp_eq_u32 s97, s76
    s_cselect_b32 s31, 2048, 0
    s_sub_u32 s90, s90, s31
    s_sub_u32 s91, s91, s31
    s_waitcnt lgkmcnt(10)
    v_mfma_f32_16x16x32_bf16 v[120:123], v[176:179], v[188:191], v[120:123]
    ds_read_b64_tr_b16 v[148:149], v19 offset:4096
    v_mfma_f32_16x16x32_bf16 v[124:127], v[176:179], v[192:195], v[124:127]
    ds_read_b64_tr_b16 v[150:151], v19 offset:6144
    s_bitcmp1_b32 0x56, s97
    s_cbranch_scc1 L_hk25X
L_hr25X:
    s_waitcnt lgkmcnt(10)
    v_mfma_f32_16x16x32_bf16 v[24:27], v[128:131], v[196:199], v[24:27]
    ds_read_b64_tr_b16 v[152:153], v21 offset:4096
    v_mfma_f32_16x16x32_bf16 v[28:31], v[128:131], v[200:203], v[28:31]
    ds_read_b64_tr_b16 v[154:155], v21 offset:6144
    s_mov_b32 m0, s88
    s_nop 0
    buffer_load_dwordx4 v5, s[36:39], s64 offen sc1 lds
    s_add_u32 s64, s64, 393216
    s_waitcnt lgkmcnt(10)
    v_mfma_f32_16x16x32_bf16 v[32:35], v[132:135], v[196:199], v[32:35]
    ds_read_b64_tr_b16 v[156:157], v22 offset:4096
    v_mfma_f32_16x16x32_bf16 v[36:39], v[132:135], v[200:203], v[36:39]
    ds_read_b64_tr_b16 v[158:159], v22 offset:6144
    s_waitcnt vmcnt(9)
    ds_read_b128 v[180:183], v12 offset:0
    v_add_u32 v23, s94, v23
    s_waitcnt lgkmcnt(11)
    v_mfma_f32_16x16x32_bf16 v[40:43], v[136:139], v[196:199], v[40:43]
    ds_read_b64_tr_b16 v[160:161], v23 offset:0
    v_mfma_f32_16x16x32_bf16 v[44:47], v[136:139], v[200:203], v[44:47]
    ds_read_b64_tr_b16 v[162:163], v23 offset:2560
    ds_read_b128 v[184:187], v12 offset:2048
    s_waitcnt lgkmcnt(12)
    v_mfma_f32_16x16x32_bf16 v[48:51], v[140:143], v[196:199], v[48:51]
    ds_read_b64_tr_b16 v[164:165], v23 offset:32
    v_mfma_f32_16x16x32_bf16 v[52:55], v[140:143], v[200:203], v[52:55]
    ds_read_b64_tr_b16 v[166:167], v23 offset:2592
    s_add_u32 m0, s88, 4096
    s_nop 0
    buffer_load_dwordx4 v6, s[40:43], s65 offen sc1 lds
    s_add_u32 s65, s65, s68
    s_waitcnt lgkmcnt(12)
    v_mfma_f32_16x16x32_bf16 v[56:59], v[144:147], v[196:199], v[56:59]
    ds_read_b64_tr_b16 v[168:169], v23 offset:64
    v_mfma_f32_16x16x32_bf16 v[60:63], v[144:147], v[200:203], v[60:63]
    ds_read_b64_tr_b16 v[170:171], v23 offset:2624
    ds_read_b128 v[188:191], v13 offset:0
    s_add_u32 s93, s93, 1
    s_cmp_eq_u32 s93, 7
    s_cselect_b32 s94, 4294887424, s95
    s_cselect_b32 s93, 0, s93
    s_waitcnt lgkmcnt(13)
    v_mfma_f32_16x16x32_bf16 v[64:67], v[148:151], v[196:199], v[64:67]
    ds_read_b64_tr_b16 v[172:173], v23 offset:96
    v_mfma_f32_16x16x32_bf16 v[68:71], v[148:151], v[200:203], v[68:71]
    ds_read_b64_tr_b16 v[174:175], v23 offset:2656
    ds_read_b128 v[192:195], v13 offset:2048
    s_waitcnt lgkmcnt(14)
    v_mfma_f32_16x16x32_bf16 v[72:75], v[152:155], v[196:199], v[72:75]
    ds_read_b64_tr_b16 v[176:177], v23 offset:128
    v_mfma_f32_16x16x32_bf16 v[76:79], v[152:155], v[200:203], v[76:79]
    ds_read_b64_tr_b16 v[178:179], v23 offset:2688
    s_add_u32 m0, s88, 8192
    s_nop 0
    buffer_load_dwordx4 v7, s[44:47], s66 offen sc1 lds
    s_add_u32 s66, s66, 458752
    v_add_u32 v18, s94, v18
    s_waitcnt lgkmcnt(14)
    v_mfma_f32_16x16x32_bf16 v[80:83], v[156:159], v[196:199], v[80:83]
    ds_read_b64_tr_b16 v[128:129], v18 offset:0
    v_mfma_f32_16x16x32_bf16 v[84:87], v[156:159], v[200:203], v[84:87]
    ds_read_b64_tr_b16 v[130:131], v18 offset:2048
    v_add_u32 v19, s94, v19
    s_waitcnt lgkmcnt(13)
    v_mfma_f32_16x16x32_bf16 v[88:91], v[160:163], v[196:199], v[88:91]
    ds_read_b64_tr_b16 v[132:133], v19 offset:0
    v_mfma_f32_16x16x32_bf16 v[92:95], v[160:163], v[200:203], v[92:95]
    ds_read_b64_tr_b16 v[134:135], v19 offset:2048
    v_add_u32 v21, s94, v21
    s_waitcnt lgkmcnt(12)
    v_mfma_f32_16x16x32_bf16 v[96:99], v[164:167], v[196:199], v[96:99]
    ds_read_b64_tr_b16 v[136:137], v21 offset:0
    v_mfma_f32_16x16x32_bf16 v[100:103], v[164:167], v[200:203], v[100:103]
    ds_read_b64_tr_b16 v[138:139], v21 offset:2048
    s_add_u32 s89, s88, 12288
    s_cmp_eq_u32 s29, 0
    s_cselect_b32 m0, s89, 158720
    s_nop 0
    buffer_load_dwordx4 v8, s[48:51], s67 offen sc1 lds
    s_add_u32 s67, s67, s69
    s_add_u32 s88, s88, 26624
    s_sub_u32 s89, s88, 93184
    s_cmp_ge_u32 s88, s87
    s_cselect_b32 s88, s89, s88
    v_add_u32 v22, s94, v22
    s_waitcnt lgkmcnt(12)
    v_mfma_f32_16x16x32_bf16 v[104:107], v[168:171], v[196:199], v[104:107]
    ds_read_b64_tr_b16 v[140:141], v22 offset:0
    v_mfma_f32_16x16x32_bf16 v[108:111], v[168:171], v[200:203], v[108:111]
    ds_read_b64_tr_b16 v[142:143], v22 offset:2048
    s_waitcnt lgkmcnt(11)
    v_mfma_f32_16x16x32_bf16 v[112:115], v[172:175], v[196:199], v[112:115]
    ds_read_b64_tr_b16 v[144:145], v18 offset:4096
    v_mfma_f32_16x16x32_bf16 v[116:119], v[172:175], v[200:203], v[116:119]
    ds_read_b64_tr_b16 v[146:147], v18 offset:6144
    s_waitcnt lgkmcnt(10)
    v_mfma_f32_16x16x32_bf16 v[120:123], v[176:179], v[196:199], v[120:123]
    ds_read_b64_tr_b16 v[148:149], v19 offset:4096
    v_mfma_f32_16x16x32_bf16 v[124:127], v[176:179], v[200:203], v[124:127]
    ds_read_b64_tr_b16 v[150:151], v19 offset:6144
    s_add_u32 m0, s92, 0
    s_nop 0
    buffer_load_dwordx4 v9, s[52:55], s90 offen lds
    s_waitcnt lgkmcnt(10)
    v_mfma_f32_16x16x32_bf16 v[24:27], v[128:131], v[204:207], v[24:27]
    ds_read_b64_tr_b16 v[152:153], v21 offset:4096
    v_mfma_f32_16x16x32_bf16 v[28:31], v[128:131], v[208:211], v[28:31]
    ds_read_b64_tr_b16 v[154:155], v21 offset:6144
    s_waitcnt lgkmcnt(10)
    v_mfma_f32_16x16x32_bf16 v[32:35], v[132:135], v[204:207], v[32:35]
    ds_read_b64_tr_b16 v[156:157], v22 offset:4096
    v_mfma_f32_16x16x32_bf16 v[36:39], v[132:135], v[208:211], v[36:39]
    ds_read_b64_tr_b16 v[158:159], v22 offset:6144
    v_add_u32 v23, s94, v23
    s_waitcnt lgkmcnt(10)
    v_mfma_f32_16x16x32_bf16 v[40:43], v[136:139], v[204:207], v[40:43]
    ds_read_b64_tr_b16 v[160:161], v23 offset:0
    v_mfma_f32_16x16x32_bf16 v[44:47], v[136:139], v[208:211], v[44:47]
    ds_read_b64_tr_b16 v[162:163], v23 offset:2560
    s_add_u32 m0, s92, 1024
    s_nop 0
    buffer_load_dwordx4 v10, s[52:55], s90 offen lds
    s_add_u32 s90, s90, 128
    s_waitcnt lgkmcnt(10)
    v_mfma_f32_16x16x32_bf16 v[48:51], v[140:143], v[204:207], v[48:51]
    ds_read_b64_tr_b16 v[164:165], v23 offset:32
    v_mfma_f32_16x16x32_bf16 v[52:55], v[140:143], v[208:211], v[52:55]
    ds_read_b64_tr_b16 v[166:167], v23 offset:2592
    s_waitcnt lgkmcnt(10)
    v_mfma_f32_16x16x32_bf16 v[56:59], v[144:147], v[204:207], v[56:59]
    ds_read_b64_tr_b16 v[168:169], v23 offset:64
    v_mfma_f32_16x16x32_bf16 v[60:63], v[144:147], v[208:211], v[60:63]
    ds_read_b64_tr_b16 v[170:171], v23 offset:2624
    s_add_u32 s93, s93, 1
    s_cmp_eq_u32 s93, 7
    s_cselect_b32 s94, 4294887424, s95
    s_cselect_b32 s93, 0, s93
    s_waitcnt lgkmcnt(10)
    v_mfma_f32_16x16x32_bf16 v[64:67], v[148:151], v[204:207], v[64:67]
    ds_read_b64_tr_b16 v[172:173], v23 offset:96
    v_mfma_f32_16x16x32_bf16 v[68:71], v[148:151], v[208:211], v[68:71]
    ds_read_b64_tr_b16 v[174:175], v23 offset:2656
    s_add_u32 m0, s92, 2048
    s_nop 0
    buffer_load_dwordx4 v9, s[52:55], s91 offen lds
    s_waitcnt lgkmcnt(10)
    v_mfma_f32_16x16x32_bf16 v[72:75], v[152:155], v[204:207], v[72:75]
    ds_read_b64_tr_b16 v[176:177], v23 offset:128
    v_mfma_f32_16x16x32_bf16 v[76:79], v[152:155], v[208:211], v[76:79]
    ds_read_b64_tr_b16 v[178:179], v23 offset:2688
    s_waitcnt vmcnt(11)
    s_barrier
    v_add_u32 v18, s94, v18
    s_waitcnt lgkmcnt(10)
    v_mfma_f32_16x16x32_bf16 v[80:83], v[156:159], v[204:207], v[80:83]
    ds_read_b64_tr_b16 v[128:129], v18 offset:0
    v_mfma_f32_16x16x32_bf16 v[84:87], v[156:159], v[208:211], v[84:87]
    ds_read_b64_tr_b16 v[130:131], v18 offset:2048
    s_lshl_b32 s32, s68, 4
    s_cmp_eq_u32 s97, s76
    s_cselect_b32 s31, 6291456, 0
    s_cselect_b32 s32, s32, 0
    s_cselect_b32 s33, 7340032, 0
    s_cselect_b32 s34, s96, 0
    s_sub_u32 s64, s64, s31
    s_sub_u32 s65, s65, s32
    s_sub_u32 s66, s66, s33
    s_sub_u32 s67, s67, s34
    v_add_u32 v19, s94, v19
    s_waitcnt lgkmcnt(10)
    v_mfma_f32_16x16x32_bf16 v[88:91], v[160:163], v[204:207], v[88:91]
    ds_read_b64_tr_b16 v[132:133], v19 offset:0
    v_mfma_f32_16x16x32_bf16 v[92:95], v[160:163], v[208:211], v[92:95]
    ds_read_b64_tr_b16 v[134:135], v19 offset:2048
    v_add_u32 v21, s94, v21
    s_waitcnt lgkmcnt(10)
    v_mfma_f32_16x16x32_bf16 v[96:99], v[164:167], v[204:207], v[96:99]
    ds_read_b64_tr_b16 v[136:137], v21 offset:0
    v_mfma_f32_16x16x32_bf16 v[100:103], v[164:167], v[208:211], v[100:103]
    ds_read_b64_tr_b16 v[138:139], v21 offset:2048
    s_add_u32 m0, s92, 3072
    s_nop 0
    buffer_load_dwordx4 v10, s[52:55], s91 offen lds
    s_add_u32 s91, s91, 128
    v_add_u32 v22, s94, v22
    s_waitcnt lgkmcnt(10)
    v_mfma_f32_16x16x32_bf16 v[104:107], v[168:171], v[204:207], v[104:107]
    ds_read_b64_tr_b16 v[140:141], v22 offset:0
    v_mfma_f32_16x16x32_bf16 v[108:111], v[168:171], v[208:211], v[108:111]
    ds_read_b64_tr_b16 v[142:143], v22 offset:2048
    s_waitcnt lgkmcnt(10)
    v_mfma_f32_16x16x32_bf16 v[112:115], v[172:175], v[204:207], v[112:115]
    ds_read_b64_tr_b16 v[144:145], v18 offset:4096
    v_mfma_f32_16x16x32_bf16 v[116:119], v[172:175], v[208:211], v[116:119]
    ds_read_b64_tr_b16 v[146:147], v18 offset:6144
    s_waitcnt lgkmcnt(10)
    v_mfma_f32_16x16x32_bf16 v[120:123], v[176:179], v[204:207], v[120:123]
    ds_read_b64_tr_b16 v[148:149], v19 offset:4096
    v_mfma_f32_16x16x32_bf16 v[124:127], v[176:179], v[208:211], v[124:127]
    ds_read_b64_tr_b16 v[150:151], v19 offset:6144
    s_bitcmp1_b32 0x46, s97
    s_cbranch_scc1 L_hk51X
L_hr51X:
    s_add_u32 s97, s97, 1
    s_cmp_lt_u32 s97, 8
    s_cbranch_scc1 L_loopX
    s_branch L_tail
L_hk25X:
    s_cmp_lg_u32 s97, 1
    s_cbranch_scc1 L_hk25X_0
    s_add_u32 s31, s3, 4
    s_and_b32 s31, s31, 7
    s_mul_i32 s31, s79, s31
    s_add_u32 s31, s31, s86
    buffer_load_dwordx4 v[228:231], v252, s[60:63], s31 offen
    s_add_u32 s31, s3, 5
    s_and_b32 s31, s31, 7
    s_mul_i32 s31, s79, s31
    s_add_u32 s31, s31, s86
    buffer_load_dwordx4 v[232:235], v252, s[60:63], s31 offen
    s_nop 1
    s_branch L_hr25X
L_hk25X_0:
    s_cmp_lg_u32 s97, 2
    s_cbranch_scc1 L_hk25X_1
    v_mov_b32 v248, -1
    v_mov_b32 v249, -1
    v_mov_b32 v250, -1
    v_mov_b32 v251, -1
    s_lshl_b32 s31, s26, 3
    s_and_b32 s32, s27, 7
    s_add_u32 s31, s31, s32
    s_mul_i32 s31, s31, 196608
    s_lshl_b32 s32, s28, 11
    s_add_u32 s31, s31, s32
    s_add_u32 s31, s31, 41943040
    s_lshr_b32 s32, s24, 1
    s_xor_b32 s32, s32, 1
    s_mul_i32 s32, s32, 49152
    s_add_u32 s32, s32, s31
    buffer_store_dwordx4 v[248:251], v11, s[56:59], s32 offen offset:0 sc1
    buffer_store_dwordx4 v[248:251], v11, s[56:59], s32 offen offset:1024 sc1
    s_lshr_b32 s32, s24, 1
    s_xor_b32 s32, s32, 2
    s_mul_i32 s32, s32, 49152
    s_add_u32 s32, s32, s31
    s_add_u32 s32, s32, 16384
    buffer_store_dwordx4 v[248:251], v11, s[56:59], s32 offen offset:0 sc1
    buffer_store_dwordx4 v[248:251], v11, s[56:59], s32 offen offset:1024 sc1
    s_nop 1
    s_branch L_hr25X
L_hk25X_1:
    s_cmp_lg_u32 s97, 4
    s_cbranch_scc1 L_hk25X_2
    s_mov_b32 s60, s20
    s_mov_b32 s61, s21
    s_cmp_eq_u32 s28, 0
    s_cselect_b32 s62, 64, 0
    s_and_b32 s31, s2, 15
    s_lshl_b32 s31, s31, 2
    v_lshlrev_b32 v14, 6, v1
    v_mov_b32 v15, 1
    buffer_atomic_add v15, v14, s[60:63], s31 offen sc1
    s_nop 1
    s_branch L_hr25X
L_hk25X_2:
    s_mov_b32 s60, s20
    s_mov_b32 s61, s21
    s_mov_b32 s62, 64
    s_mov_b32 s54, 0
    v_lshlrev_b32 v14, 2, v3
    buffer_load_dword v244, v14, s[60:63], 0 offen sc1
    s_nop 1
    s_branch L_hr25X
L_hk51X:
    s_cmp_lg_u32 s97, 1
    s_cbranch_scc1 L_hk51X_0
    s_add_u32 s31, s3, 6
    s_and_b32 s31, s31, 7
    s_mul_i32 s31, s79, s31
    s_add_u32 s31, s31, s86
    buffer_load_dwordx4 v[236:239], v252, s[60:63], s31 offen
    s_add_u32 s31, s3, 7
    s_and_b32 s31, s31, 7
    s_mul_i32 s31, s79, s31
    s_add_u32 s31, s31, s86
    buffer_load_dwordx4 v[240:243], v252, s[60:63], s31 offen
    s_nop 1
    s_branch L_hr51X
L_hk51X_0:
    s_cmp_lg_u32 s97, 2
    s_cbranch_scc1 L_hk51X_1
    v_and_b32 v14, 1, v3
    v_lshlrev_b32 v14, 4, v14
    v_mov_b32 v15, 0x3f80
    v_lshlrev_b32 v14, v14, v15
    v_bfe_u32 v15, v3, 1, 2
    v_cmp_eq_u32 vcc, 0, v15
    s_nop 1
    v_cndmask_b32 v244, 0, v14, vcc
    v_cmp_eq_u32 vcc, 1, v15
    s_nop 1
    v_cndmask_b32 v245, 0, v14, vcc
    v_cmp_eq_u32 vcc, 2, v15
    s_nop 1
    v_cndmask_b32 v246, 0, v14, vcc
    v_cmp_eq_u32 vcc, 3, v15
    s_nop 1
    v_cndmask_b32 v247, 0, v14, vcc
    s_waitcnt vmcnt(20)
    s_nop 0
    v_mfma_f32_16x16x32_bf16 v[248:251], v[244:247], v[212:215], 0
    v_mfma_f32_16x16x32_bf16 v[248:251], v[244:247], v[216:219], v[248:251]
    v_mfma_f32_16x16x32_bf16 v[248:251], v[244:247], v[220:223], v[248:251]
    v_mfma_f32_16x16x32_bf16 v[248:251], v[244:247], v[224:227], v[248:251]
    v_mfma_f32_16x16x32_bf16 v[248:251], v[244:247], v[228:231], v[248:251]
    v_mfma_f32_16x16x32_bf16 v[248:251], v[244:247], v[232:235], v[248:251]
    v_mfma_f32_16x16x32_bf16 v[248:251], v[244:247], v[236:239], v[248:251]
    v_mfma_f32_16x16x32_bf16 v[248:251], v[244:247], v[240:243], v[248:251]
    buffer_store_dword v254, v255, s[56:59], s77 offen sc1
    s_nop 6
    v_add_f32_dpp v248, v248, v248 row_ror:8 row_mask:0xf bank_mask:0xf
    v_add_f32_dpp v249, v249, v249 row_ror:8 row_mask:0xf bank_mask:0xf
    v_add_f32_dpp v250, v250, v250 row_ror:8 row_mask:0xf bank_mask:0xf
    v_add_f32_dpp v251, v251, v251 row_ror:8 row_mask:0xf bank_mask:0xf
    v_cvt_pk_bf16_f32 v14, v248, v249
    v_cvt_pk_bf16_f32 v15, v250, v251
    buffer_store_dwordx2 v[14:15], v253, s[56:59], s78 offen sc1
    v_mov_b32 v248, -1
    v_mov_b32 v249, -1
    v_mov_b32 v250, -1
    v_mov_b32 v251, -1
    s_lshl_b32 s31, s26, 3
    s_and_b32 s32, s27, 7
    s_add_u32 s31, s31, s32
    s_mul_i32 s31, s31, 196608
    s_lshl_b32 s32, s28, 11
    s_add_u32 s31, s31, s32
    s_add_u32 s31, s31, 41943040
    s_lshr_b32 s32, s24, 1
    s_xor_b32 s32, s32, 3
    s_mul_i32 s32, s32, 49152
    s_add_u32 s32, s32, s31
    s_add_u32 s32, s32, 32768
    buffer_store_dwordx4 v[248:251], v11, s[56:59], s32 offen offset:0 sc1
    buffer_store_dwordx4 v[248:251], v11, s[56:59], s32 offen offset:1024 sc1
    s_lshl_b32 s31, s101, 17
    s_lshl_b32 s32, s26, 14
    s_add_u32 s31, s31, s32
    s_lshl_b32 s32, s28, 11
    s_add_u32 s31, s31, s32
    s_add_u32 s31, s31, 33554432
    s_cmp_eq_u32 s100, 1
    s_cselect_b32 s31, 0x40000000, s31
    buffer_store_dwordx4 v[248:251], v11, s[56:59], s31 offen offset:0 sc1
    buffer_store_dwordx4 v[248:251], v11, s[56:59], s31 offen offset:1024 sc1
    s_nop 1
    s_branch L_hr51X
L_hk51X_1:
    s_waitcnt vmcnt(8)
    v_cmp_gt_u32 vcc, 16, v244
    s_mov_b32 s31, 0
    s_cbranch_vccz L_h4okX
L_h4spinX:
    buffer_load_dword v244, v14, s[60:63], 0 offen sc1
    s_add_u32 s31, s31, 1
    s_waitcnt vmcnt(0)
    v_cmp_gt_u32 vcc, 16, v244
    s_cmp_gt_u32 s31, 200000
    s_cbranch_scc1 L_h4okX
    s_cbranch_vccnz L_h4spinX
L_h4okX:
    s_add_u32 s36, s22, 36700160
    s_addc_u32 s37, s23, 0
    s_mov_b32 s38, 98304
    s_add_u32 s44, s22, 36831232
    s_addc_u32 s45, s23, 0
    s_mov_b32 s46, 121856
    s_cmp_eq_u32 s100, 1
    s_cselect_b32 s40, s44, s36
    s_cselect_b32 s41, s45, s37
    s_cselect_b32 s42, s46, s38
    s_mul_i32 s31, s3, 786432
    s_sub_u32 s64, s64, s31
    s_lshl_b32 s31, s68, 1
    s_mul_i32 s31, s31, s3
    s_sub_u32 s65, s65, s31
    s_mul_i32 s31, s3, 917504
    s_sub_u32 s66, s66, s31
    s_cmp_eq_u32 s29, 0
    s_cselect_b32 s48, s44, s48
    s_cselect_b32 s49, s45, s49
    s_cselect_b32 s50, s46, s50
    s_cselect_b32 s67, s66, s67
    s_lshl_b32 s31, s26, 12
    s_lshl_b32 s32, s28, 9
    s_add_u32 s31, s31, s32
    s_add_u32 s31, s31, 37748736
    v_and_b32 v15, 7, v1
    v_lshlrev_b32 v15, 2, v15
    buffer_load_dword v245, v15, s[56:59], s83 offen offset:64 sc1
    v_lshlrev_b32 v14, 4, v3
    buffer_load_dwordx4 v[216:219], v14, s[56:59], s31 offen offset:0 sc1
    buffer_load_dwordx4 v[220:223], v14, s[56:59], s31 offen offset:256 sc1
    s_nop 1
    s_branch L_hr51X
L_tail:
    s_waitcnt vmcnt(16)
    s_getreg_b32 s31, hwreg(HW_REG_XCC_ID, 0, 16)
    v_cmp_ne_u32 vcc, s31, v245
    s_nop 0
    s_cmp_eq_u64 vcc, 0
    s_cselect_b32 s76, 1, 0
    v_cmp_gt_u32 vcc, 2, v4
    v_cmp_eq_u32 s[32:33], 2, v4
    s_nop 0
    v_cndmask_b32 v233, 0, v216, vcc
    v_cndmask_b32 v234, 0, v216, vcc
    v_cndmask_b32 v235, 0, v216, vcc
    v_cndmask_b32 v232, v233, v217, s[32:33]
    v_cndmask_b32 v237, 0, v220, vcc
    v_cndmask_b32 v238, 0, v220, vcc
    v_cndmask_b32 v239, 0, v220, vcc
    v_cndmask_b32 v236, v237, v221, s[32:33]
    v_mov_b32 v240, v218
    v_mul_f32 v226, 0x3fb8aa3b, v218
    v_mul_f32 v230, 0xbfb8aa3b, v218
    v_mov_b32 v241, v218
    v_mul_f32 v227, 0x3fb8aa3b, v218
    v_mul_f32 v231, 0xbfb8aa3b, v218
    v_mov_b32 v242, v219
    v_mov_b32 v246, v222
    v_mul_f32 v228, 0x3fb8aa3b, v222
    v_mul_f32 v244, 0xbfb8aa3b, v222
    v_mov_b32 v247, v222
    v_mul_f32 v229, 0x3fb8aa3b, v222
    v_mul_f32 v245, 0xbfb8aa3b, v222
    v_mov_b32 v243, v223
    v_cndmask_b32 v225, v244, v230, vcc
    v_lshrrev_b32 v15, 2, v1
    v_lshlrev_b32 v15, 6, v15
    v_and_b32 v16, 3, v1
    v_lshl_add_u32 v15, v16, 3, v15
    v_add_u32 v15, 159744, v15
    s_lshl_b32 s80, s26, 14
    s_lshl_b32 s31, s28, 11
    s_add_u32 s80, s80, s31
    s_add_u32 s31, s80, 4194304
    s_lshl_b32 s42, s84, 11
    s_add_u32 s42, s42, s31
    s_lshl_b32 s41, s98, 11
    s_add_u32 s41, s41, s31
    s_lshl_b32 s40, s99, 11
    s_add_u32 s40, s40, s31
    s_lshl_b32 s33, s100, 3
    s_add_u32 s40, s40, s33
    s_waitcnt lgkmcnt(10)
    v_mfma_f32_16x16x32_bf16 v[24:27], v[128:131], v[232:235], v[24:27]
    ds_read_b64_tr_b16 v[152:153], v21 offset:4096
    v_mfma_f32_16x16x32_bf16 v[28:31], v[128:131], v[236:239], v[28:31]
    ds_read_b64_tr_b16 v[154:155], v21 offset:6144
    s_waitcnt lgkmcnt(10)
    v_mfma_f32_16x16x32_bf16 v[32:35], v[132:135], v[232:235], v[32:35]
    ds_read_b64_tr_b16 v[156:157], v22 offset:4096
    v_mfma_f32_16x16x32_bf16 v[36:39], v[132:135], v[236:239], v[36:39]
    ds_read_b64_tr_b16 v[158:159], v22 offset:6144
    v_add_u32 v23, s94, v23
    s_waitcnt lgkmcnt(10)
    v_mfma_f32_16x16x32_bf16 v[40:43], v[136:139], v[232:235], v[40:43]
    ds_read_b64_tr_b16 v[160:161], v23 offset:0
    v_mfma_f32_16x16x32_bf16 v[44:47], v[136:139], v[236:239], v[44:47]
    ds_read_b64_tr_b16 v[162:163], v23 offset:2560
    s_waitcnt lgkmcnt(10)
    v_mfma_f32_16x16x32_bf16 v[48:51], v[140:143], v[232:235], v[48:51]
    ds_read_b64_tr_b16 v[164:165], v23 offset:32
    v_mfma_f32_16x16x32_bf16 v[52:55], v[140:143], v[236:239], v[52:55]
    ds_read_b64_tr_b16 v[166:167], v23 offset:2592
    s_waitcnt lgkmcnt(10)
    v_mfma_f32_16x16x32_bf16 v[56:59], v[144:147], v[232:235], v[56:59]
    ds_read_b64_tr_b16 v[168:169], v23 offset:64
    v_mfma_f32_16x16x32_bf16 v[60:63], v[144:147], v[236:239], v[60:63]
    ds_read_b64_tr_b16 v[170:171], v23 offset:2624
    s_add_u32 s93, s93, 1
    s_cmp_eq_u32 s93, 7
    s_cselect_b32 s94, 4294887424, s95
    s_cselect_b32 s93, 0, s93
    s_waitcnt lgkmcnt(10)
    v_mfma_f32_16x16x32_bf16 v[64:67], v[148:151], v[232:235], v[64:67]
    ds_read_b64_tr_b16 v[172:173], v23 offset:96
    v_mfma_f32_16x16x32_bf16 v[68:71], v[148:151], v[236:239], v[68:71]
    ds_read_b64_tr_b16 v[174:175], v23 offset:2656
    s_waitcnt lgkmcnt(10)
    v_mfma_f32_16x16x32_bf16 v[72:75], v[152:155], v[232:235], v[72:75]
    ds_read_b64_tr_b16 v[176:177], v23 offset:128
    v_mfma_f32_16x16x32_bf16 v[76:79], v[152:155], v[236:239], v[76:79]
    ds_read_b64_tr_b16 v[178:179], v23 offset:2688
    s_waitcnt lgkmcnt(10)
    v_mfma_f32_16x16x32_bf16 v[80:83], v[156:159], v[232:235], v[80:83]
    v_mfma_f32_16x16x32_bf16 v[84:87], v[156:159], v[236:239], v[84:87]
    ds_read_b64_tr_b16 v[200:201], v15 offset:0
    ds_read_b64_tr_b16 v[202:203], v15 offset:1024
    s_waitcnt lgkmcnt(10)
    v_mfma_f32_16x16x32_bf16 v[88:91], v[160:163], v[232:235], v[88:91]
    v_mfma_f32_16x16x32_bf16 v[92:95], v[160:163], v[236:239], v[92:95]
    ds_read_b64_tr_b16 v[204:205], v15 offset:32
    ds_read_b64_tr_b16 v[206:207], v15 offset:1056
    s_waitcnt lgkmcnt(10)
    v_mfma_f32_16x16x32_bf16 v[96:99], v[164:167], v[232:235], v[96:99]
    v_mfma_f32_16x16x32_bf16 v[100:103], v[164:167], v[236:239], v[100:103]
    ds_read_b64_tr_b16 v[208:209], v15 offset:2048
    ds_read_b64_tr_b16 v[210:211], v15 offset:3072
    s_waitcnt lgkmcnt(10)
    v_mfma_f32_16x16x32_bf16 v[104:107], v[168:171], v[232:235], v[104:107]
    v_mfma_f32_16x16x32_bf16 v[108:111], v[168:171], v[236:239], v[108:111]
    ds_read_b64_tr_b16 v[212:213], v15 offset:2080
    ds_read_b64_tr_b16 v[214:215], v15 offset:3104
    s_waitcnt lgkmcnt(10)
    v_mfma_f32_16x16x32_bf16 v[112:115], v[172:175], v[232:235], v[112:115]
    v_mfma_f32_16x16x32_bf16 v[116:119], v[172:175], v[236:239], v[116:119]
    s_waitcnt lgkmcnt(8)
    v_mfma_f32_16x16x32_bf16 v[120:123], v[176:179], v[232:235], v[120:123]
    v_mfma_f32_16x16x32_bf16 v[124:127], v[176:179], v[236:239], v[124:127]
    v_max_f32 v88, 0, v88
    v_max_f32 v89, 0, v89
    v_max_f32 v90, 0, v90
    v_max_f32 v91, 0, v91
    v_max_f32 v92, 0, v92
    v_max_f32 v93, 0, v93
    v_max_f32 v94, 0, v94
    v_max_f32 v95, 0, v95
    v_pk_mul_f32 v[88:89], v[88:89], v[88:89]
    v_pk_mul_f32 v[90:91], v[90:91], v[90:91]
    v_pk_mul_f32 v[92:93], v[92:93], v[92:93]
    v_pk_mul_f32 v[94:95], v[94:95], v[94:95]
    v_cvt_pk_bf16_f32 v88, v88, v89
    v_cvt_pk_bf16_f32 v89, v90, v91
    v_cvt_pk_bf16_f32 v92, v92, v93
    v_cvt_pk_bf16_f32 v93, v94, v95
    v_max_f32 v96, 0, v96
    v_max_f32 v97, 0, v97
    v_max_f32 v98, 0, v98
    v_max_f32 v99, 0, v99
    v_max_f32 v100, 0, v100
    v_max_f32 v101, 0, v101
    v_max_f32 v102, 0, v102
    v_max_f32 v103, 0, v103
    v_pk_mul_f32 v[96:97], v[96:97], v[96:97]
    v_pk_mul_f32 v[98:99], v[98:99], v[98:99]
    v_pk_mul_f32 v[100:101], v[100:101], v[100:101]
    v_pk_mul_f32 v[102:103], v[102:103], v[102:103]
    v_cvt_pk_bf16_f32 v90, v96, v97
    v_cvt_pk_bf16_f32 v91, v98, v99
    s_cmp_eq_u32 s76, 1
    s_cbranch_scc0 L_ss0
    buffer_store_dwordx4 v[88:91], v11, s[56:59], s42 offen offset:0
L_sb0:
    v_cvt_pk_bf16_f32 v94, v100, v101
    v_cvt_pk_bf16_f32 v95, v102, v103
    s_cmp_eq_u32 s76, 1
    s_cbranch_scc0 L_ss1
    buffer_store_dwordx4 v[92:95], v11, s[56:59], s42 offen offset:1024
L_sb1:
    s_add_u32 s42, s42, 0x20000
    v_max_f32 v104, 0, v104
    v_max_f32 v105, 0, v105
    v_max_f32 v106, 0, v106
    v_max_f32 v107, 0, v107
    v_max_f32 v108, 0, v108
    v_max_f32 v109, 0, v109
    v_max_f32 v110, 0, v110
    v_max_f32 v111, 0, v111
    v_pk_mul_f32 v[104:105], v[104:105], v[104:105]
    v_pk_mul_f32 v[106:107], v[106:107], v[106:107]
    v_pk_mul_f32 v[108:109], v[108:109], v[108:109]
    v_pk_mul_f32 v[110:111], v[110:111], v[110:111]
    v_cvt_pk_bf16_f32 v104, v104, v105
    v_cvt_pk_bf16_f32 v105, v106, v107
    v_cvt_pk_bf16_f32 v108, v108, v109
    v_cvt_pk_bf16_f32 v109, v110, v111
    v_max_f32 v112, 0, v112
    v_max_f32 v113, 0, v113
    v_max_f32 v114, 0, v114
    v_max_f32 v115, 0, v115
    v_max_f32 v116, 0, v116
    v_max_f32 v117, 0, v117
    v_max_f32 v118, 0, v118
    v_max_f32 v119, 0, v119
    v_pk_mul_f32 v[112:113], v[112:113], v[112:113]
    v_pk_mul_f32 v[114:115], v[114:115], v[114:115]
    v_pk_mul_f32 v[116:117], v[116:117], v[116:117]
    v_pk_mul_f32 v[118:119], v[118:119], v[118:119]
    v_cvt_pk_bf16_f32 v106, v112, v113
    v_cvt_pk_bf16_f32 v107, v114, v115
    s_cmp_eq_u32 s76, 1
    s_cbranch_scc0 L_ss2
    buffer_store_dwordx4 v[104:107], v11, s[56:59], s42 offen offset:0
L_sb2:
    v_cvt_pk_bf16_f32 v110, v116, v117
    v_cvt_pk_bf16_f32 v111, v118, v119
    s_cmp_eq_u32 s76, 1
    s_cbranch_scc0 L_ss3
    buffer_store_dwordx4 v[108:111], v11, s[56:59], s42 offen offset:1024
L_sb3:
    v_max_f32 v120, 0, v120
    v_max_f32 v121, 0, v121
    v_max_f32 v122, 0, v122
    v_max_f32 v123, 0, v123
    v_max_f32 v124, 0, v124
    v_max_f32 v125, 0, v125
    v_max_f32 v126, 0, v126
    v_max_f32 v127, 0, v127
    v_pk_mul_f32 v[120:121], v[120:121], v[120:121]
    v_pk_mul_f32 v[122:123], v[122:123], v[122:123]
    v_pk_mul_f32 v[124:125], v[124:125], v[124:125]
    v_pk_mul_f32 v[126:127], v[126:127], v[126:127]
    v_cvt_pk_bf16_f32 v120, v120, v121
    v_cvt_pk_bf16_f32 v121, v122, v123
    s_cmp_eq_u32 s76, 1
    s_cbranch_scc0 L_ss4
    buffer_store_dwordx2 v[120:121], v11, s[56:59], s40 offen offset:0
L_sb4:
    v_cvt_pk_bf16_f32 v124, v124, v125
    v_cvt_pk_bf16_f32 v125, v126, v127
    s_cmp_eq_u32 s76, 1
    s_cbranch_scc0 L_ss5
    buffer_store_dwordx2 v[124:125], v11, s[56:59], s40 offen offset:1024
L_sb5:
    s_load_dwordx2 s[12:13], s[0:1], 72
    s_lshr_b32 s64, s24, 1
    s_and_b32 s65, s24, 1
    s_lshl_b32 s65, s65, 2
    s_and_b32 s31, s25, 3
    s_add_u32 s65, s65, s31
    s_lshr_b32 s66, s25, 2
    s_lshl_b32 s31, s28, 15
    s_lshl_b32 s67, s66, 8
    s_add_u32 s31, s31, s67
    s_lshl_b32 s32, s64, 1
    v_bfe_u32 v14, v1, 1, 3
    v_xor_b32 v14, v14, v4
    v_xor_b32 v14, s32, v14
    v_lshlrev_b32 v5, 11, v4
    v_and_b32 v15, 1, v1
    v_lshl_add_u32 v5, v15, 4, v5
    v_add_u32 v5, s31, v5
    v_xor_b32 v15, 4, v14
    v_lshl_add_u32 v6, v15, 5, v5
    v_add_u32 v6, 8192, v6
    v_lshl_add_u32 v5, v14, 5, v5
    v_add_u32 v7, 16384, v5
    v_add_u32 v8, 16384, v6
    s_mov_b32 s36, s16
    s_mov_b32 s37, s17
    s_mov_b32 s38, 7340032
    s_mov_b32 s39, 0x00020000
    s_mov_b32 s48, s10
    s_mov_b32 s49, s11
    s_mov_b32 s50, 2097152
    s_mov_b32 s51, 0x00020000
    s_mul_i32 s68, s64, 1835008
    s_lshl_b32 s69, s64, 19
    s_lshl_b32 s88, s28, 12
    s_mov_b32 s87, s83
    v_and_b32 v10, 7, v1
    v_lshlrev_b32 v10, 2, v10
    v_cmp_eq_u32 vcc, 0, v1
    s_nop 1
    v_cndmask_b32 v21, v20, v1, vcc
    v_mov_b32 v23, 1
    s_lshl_b32 s31, s65, 14
    s_lshl_b32 s33, s28, 11
    s_add_u32 s89, s31, s33
    v_add_u32 v9, s89, v11
    s_add_u32 s44, s22, 4194304
    s_addc_u32 s45, s23, 0
    s_mov_b32 s46, 18874368
    s_mov_b32 s47, 0x00020000
    s_mul_i32 s90, s64, 3670016
    s_lshl_b32 s91, s64, 20
    s_add_u32 s91, s91, 14680064
    s_lshl_b32 s84, s101, 17
    s_add_u32 s84, s84, s33
    s_add_u32 s84, s84, 33554432
    s_waitcnt vmcnt(6) lgkmcnt(0)
    s_barrier
    s_cmp_eq_u32 s100, 1
    s_cbranch_scc1 L_typeQ
    s_mul_i32 s31, s28, 12288
    v_lshlrev_b32 v12, 5, v3
    v_lshl_add_u32 v12, v4, 3, v12
    v_add_u32 v12, s31, v12
    v_pk_mul_f32 v[56:57], v[56:57], v[240:241]
    v_pk_mul_f32 v[58:59], v[58:59], v[240:241]
    v_cvt_pk_bf16_f32 v56, v56, v57
    v_cvt_pk_bf16_f32 v57, v58, v59
    ds_write_b64 v12, v[56:57] offset:8192
    v_pk_mul_f32 v[60:61], v[60:61], v[246:247]
    v_pk_mul_f32 v[62:63], v[62:63], v[246:247]
    v_cvt_pk_bf16_f32 v60, v60, v61
    v_cvt_pk_bf16_f32 v61, v62, v63
    ds_write_b64 v12, v[60:61] offset:8704
    v_pk_mul_f32 v[64:65], v[64:65], v[240:241]
    v_pk_mul_f32 v[66:67], v[66:67], v[240:241]
    v_cvt_pk_bf16_f32 v64, v64, v65
    v_cvt_pk_bf16_f32 v65, v66, v67
    ds_write_b64 v12, v[64:65] offset:9216
    v_pk_mul_f32 v[68:69], v[68:69], v[246:247]
    v_pk_mul_f32 v[70:71], v[70:71], v[246:247]
    v_cvt_pk_bf16_f32 v68, v68, v69
    v_cvt_pk_bf16_f32 v69, v70, v71
    ds_write_b64 v12, v[68:69] offset:9728
    v_pk_mul_f32 v[72:73], v[72:73], v[240:241]
    v_pk_mul_f32 v[74:75], v[74:75], v[240:241]
    v_cvt_pk_bf16_f32 v72, v72, v73
    v_cvt_pk_bf16_f32 v73, v74, v75
    ds_write_b64 v12, v[72:73] offset:10240
    v_pk_mul_f32 v[76:77], v[76:77], v[246:247]
    v_pk_mul_f32 v[78:79], v[78:79], v[246:247]
    v_cvt_pk_bf16_f32 v76, v76, v77
    v_cvt_pk_bf16_f32 v77, v78, v79
    ds_write_b64 v12, v[76:77] offset:10752
    v_pk_mul_f32 v[80:81], v[80:81], v[240:241]
    v_pk_mul_f32 v[82:83], v[82:83], v[240:241]
    v_cvt_pk_bf16_f32 v80, v80, v81
    v_cvt_pk_bf16_f32 v81, v82, v83
    ds_write_b64 v12, v[80:81] offset:11264
    v_pk_mul_f32 v[84:85], v[84:85], v[246:247]
    v_pk_mul_f32 v[86:87], v[86:87], v[246:247]
    v_cvt_pk_bf16_f32 v84, v84, v85
    v_cvt_pk_bf16_f32 v85, v86, v87
    ds_write_b64 v12, v[84:85] offset:11776
    v_cvt_pk_bf16_f32 v88, v24, v25
    v_cvt_pk_bf16_f32 v89, v26, v27
    v_cvt_pk_bf16_f32 v90, v32, v33
    v_cvt_pk_bf16_f32 v91, v34, v35
    v_cvt_pk_bf16_f32 v92, v28, v29
    v_cvt_pk_bf16_f32 v93, v30, v31
    v_cvt_pk_bf16_f32 v94, v36, v37
    v_cvt_pk_bf16_f32 v95, v38, v39
    v_mfma_f32_16x16x32_bf16 v[56:59], v[200:203], v[88:91], 0
    v_mfma_f32_16x16x32_bf16 v[60:63], v[204:207], v[88:91], 0
    v_mfma_f32_16x16x32_bf16 v[64:67], v[200:203], v[92:95], 0
    v_mfma_f32_16x16x32_bf16 v[68:71], v[204:207], v[92:95], 0
    s_add_u32 m0, s88, 98304
    s_nop 0
    buffer_load_dwordx4 v5, s[36:39], s68 offen lds
    s_add_u32 m0, s88, 99328
    s_nop 0
    buffer_load_dwordx4 v6, s[36:39], s68 offen lds
    s_add_u32 m0, s88, 100352
    s_nop 0
    buffer_load_dwordx4 v7, s[36:39], s68 offen lds
    s_add_u32 m0, s88, 101376
    s_nop 0
    buffer_load_dwordx4 v8, s[36:39], s68 offen lds
    s_add_u32 s68, s68, 0x40000
    v_max3_f32 v72, v56, v57, v58
    v_max3_f32 v73, -v56, -v57, -v58
    v_max3_f32 v74, v64, v65, v66
    v_max3_f32 v75, -v64, -v65, -v66
    v_max3_f32 v72, v72, v59, v60
    v_max3_f32 v73, v73, -v59, -v60
    v_max3_f32 v74, v74, v67, v68
    v_max3_f32 v75, v75, -v67, -v68
    v_max3_f32 v72, v72, v61, v62
    v_max3_f32 v73, v73, -v61, -v62
    v_max3_f32 v74, v74, v69, v70
    v_max3_f32 v75, v75, -v69, -v70
    v_max_f32 v88, v72, v63
    v_max_f32_e64 v90, v73, -v63
    v_max_f32 v92, v74, v71
    v_max_f32_e64 v94, v75, -v71
    s_nop 0
    v_permlane32_swap_b32 v88, v92
    v_permlane32_swap_b32 v90, v94
    v_max_f32 v88, v88, v92
    v_max_f32 v90, v90, v94
    s_nop 1
    v_permlane16_swap_b32 v88, v90
    v_max_f32 v88, v88, v90
    v_mul_f32 v88, v88, v225
    v_mov_b32 v90, v88
    s_add_u32 m0, s88, 131072
    s_nop 0
    buffer_load_dwordx4 v5, s[36:39], s68 offen lds
    v_permlane16_swap_b32 v88, v90
    v_mov_b32 v92, v88
    v_mov_b32 v94, v90
    s_nop 0
    v_permlane32_swap_b32 v88, v92
    v_permlane32_swap_b32 v90, v94
    v_mov_b32 v89, v88
    s_add_u32 m0, s88, 132096
    s_nop 0
    buffer_load_dwordx4 v6, s[36:39], s68 offen lds
    v_mov_b32 v93, v92
    v_mov_b32 v91, v90
    v_mov_b32 v95, v94
    v_pk_fma_f32 v[72:73], v[56:57], v[226:227], v[88:89]
    v_pk_fma_f32 v[80:81], v[64:65], v[228:229], v[92:93]
    v_pk_fma_f32 v[56:57], v[56:57], v[230:231], v[90:91]
    s_add_u32 m0, s88, 133120
    s_nop 0
    buffer_load_dwordx4 v7, s[36:39], s68 offen lds
    v_pk_fma_f32 v[64:65], v[64:65], v[244:245], v[94:95]
    v_pk_fma_f32 v[74:75], v[58:59], v[226:227], v[88:89]
    v_pk_fma_f32 v[82:83], v[66:67], v[228:229], v[92:93]
    v_pk_fma_f32 v[58:59], v[58:59], v[230:231], v[90:91]
    v_pk_fma_f32 v[66:67], v[66:67], v[244:245], v[94:95]
    v_pk_fma_f32 v[76:77], v[60:61], v[226:227], v[88:89]
    s_add_u32 m0, s88, 134144
    s_nop 0
    buffer_load_dwordx4 v8, s[36:39], s68 offen lds
    s_add_u32 s68, s68, 0x40000
    v_pk_fma_f32 v[84:85], v[68:69], v[228:229], v[92:93]
    v_pk_fma_f32 v[60:61], v[60:61], v[230:231], v[90:91]
    v_pk_fma_f32 v[68:69], v[68:69], v[244:245], v[94:95]
    v_pk_fma_f32 v[78:79], v[62:63], v[226:227], v[88:89]
    v_pk_fma_f32 v[86:87], v[70:71], v[228:229], v[92:93]
    v_pk_fma_f32 v[62:63], v[62:63], v[230:231], v[90:91]
    s_waitcnt vmcnt(8)
    s_cmp_eq_u32 s76, 1
    s_cbranch_scc0 L_ss6
    buffer_store_dword v23, v21, s[56:59], s81 offen
L_sb6:
    v_pk_fma_f32 v[70:71], v[70:71], v[244:245], v[94:95]
    v_exp_f32 v72, v72
    v_exp_f32 v56, v56
    v_exp_f32 v80, v80
    v_exp_f32 v64, v64
    v_exp_f32 v73, v73
    v_exp_f32 v57, v57
    v_exp_f32 v81, v81
    v_exp_f32 v65, v65
    v_exp_f32 v74, v74
    v_exp_f32 v58, v58
    v_exp_f32 v82, v82
    v_exp_f32 v66, v66
    v_add_f32 v88, v72, v73
    v_add_f32 v90, v56, v57
    v_add_f32 v92, v80, v81
    v_add_f32 v94, v64, v65
    v_exp_f32 v75, v75
    v_exp_f32 v59, v59
    v_exp_f32 v83, v83
    v_exp_f32 v67, v67
    v_add_f32 v88, v88, v74
    v_add_f32 v90, v90, v58
    v_add_f32 v92, v92, v82
    v_add_f32 v94, v94, v66
    v_exp_f32 v76, v76
    v_exp_f32 v60, v60
    v_exp_f32 v84, v84
    v_exp_f32 v68, v68
    v_add_f32 v88, v88, v75
    v_add_f32 v90, v90, v59
    v_add_f32 v92, v92, v83
    v_add_f32 v94, v94, v67
    v_exp_f32 v77, v77
    v_exp_f32 v61, v61
    v_exp_f32 v85, v85
    v_exp_f32 v69, v69
    v_add_f32 v88, v88, v76
    v_add_f32 v90, v90, v60
    v_add_f32 v92, v92, v84
    v_add_f32 v94, v94, v68
    v_exp_f32 v78, v78
    v_exp_f32 v62, v62
    v_exp_f32 v86, v86
    v_exp_f32 v70, v70
    v_add_f32 v88, v88, v77
    v_add_f32 v90, v90, v61
    v_add_f32 v92, v92, v85
    v_add_f32 v94, v94, v69
    v_exp_f32 v79, v79
    v_exp_f32 v63, v63
    v_exp_f32 v87, v87
    v_exp_f32 v71, v71
    v_add_f32 v88, v88, v78
    v_add_f32 v90, v90, v62
    v_add_f32 v92, v92, v86
    v_add_f32 v94, v94, v70
    v_add_f32 v88, v88, v79
    v_add_f32 v90, v90, v63
    v_add_f32 v92, v92, v87
    v_add_f32 v94, v94, v71
    s_nop 0
    v_permlane32_swap_b32 v88, v92
    v_permlane32_swap_b32 v90, v94
    v_add_f32 v88, v88, v92
    v_add_f32 v90, v90, v94
    s_nop 1
    v_permlane16_swap_b32 v88, v90
    v_add_f32 v88, v88, v90
    v_rcp_f32 v88, v88
    s_nop 0
    v_mov_b32 v90, v88
    s_nop 1
    v_permlane16_swap_b32 v88, v90
    v_mov_b32 v92, v88
    v_mov_b32 v94, v90
    s_nop 0
    v_permlane32_swap_b32 v88, v92
    v_permlane32_swap_b32 v90, v94
    v_mov_b32 v89, v88
    v_mov_b32 v93, v92
    v_mov_b32 v91, v90
    v_mov_b32 v95, v94
    v_pk_mul_f32 v[72:73], v[72:73], v[88:89]
    v_pk_mul_f32 v[80:81], v[80:81], v[92:93]
    v_pk_mul_f32 v[56:57], v[56:57], v[90:91]
    v_pk_mul_f32 v[64:65], v[64:65], v[94:95]
    v_cvt_pk_bf16_f32 v168, v72, v73
    v_cvt_pk_bf16_f32 v172, v56, v57
    v_cvt_pk_bf16_f32 v176, v80, v81
    v_cvt_pk_bf16_f32 v180, v64, v65
    v_pk_mul_f32 v[74:75], v[74:75], v[88:89]
    v_pk_mul_f32 v[82:83], v[82:83], v[92:93]
    v_pk_mul_f32 v[58:59], v[58:59], v[90:91]
    v_pk_mul_f32 v[66:67], v[66:67], v[94:95]
    v_cvt_pk_bf16_f32 v169, v74, v75
    v_cvt_pk_bf16_f32 v173, v58, v59
    v_cvt_pk_bf16_f32 v177, v82, v83
    v_cvt_pk_bf16_f32 v181, v66, v67
    ds_write_b64 v12, v[168:169] offset:0
    ds_write_b64 v12, v[172:173] offset:2048
    ds_write_b64 v12, v[176:177] offset:512
    ds_write_b64 v12, v[180:181] offset:2560
    v_pk_mul_f32 v[76:77], v[76:77], v[88:89]
    v_pk_mul_f32 v[84:85], v[84:85], v[92:93]
    v_pk_mul_f32 v[60:61], v[60:61], v[90:91]
    v_pk_mul_f32 v[68:69], v[68:69], v[94:95]
    v_cvt_pk_bf16_f32 v170, v76, v77
    v_cvt_pk_bf16_f32 v174, v60, v61
    v_cvt_pk_bf16_f32 v178, v84, v85
    v_cvt_pk_bf16_f32 v182, v68, v69
    v_pk_mul_f32 v[78:79], v[78:79], v[88:89]
    v_pk_mul_f32 v[86:87], v[86:87], v[92:93]
    v_pk_mul_f32 v[62:63], v[62:63], v[90:91]
    v_pk_mul_f32 v[70:71], v[70:71], v[94:95]
    v_cvt_pk_bf16_f32 v171, v78, v79
    v_cvt_pk_bf16_f32 v175, v62, v63
    v_cvt_pk_bf16_f32 v179, v86, v87
    v_cvt_pk_bf16_f32 v183, v70, v71
    ds_write_b64 v12, v[170:171] offset:1024
    ds_write_b64 v12, v[174:175] offset:3072
    ds_write_b64 v12, v[178:179] offset:1536
    ds_write_b64 v12, v[182:183] offset:3584
    v_cvt_pk_bf16_f32 v88, v40, v41
    v_cvt_pk_bf16_f32 v89, v42, v43
    v_cvt_pk_bf16_f32 v90, v48, v49
    v_cvt_pk_bf16_f32 v91, v50, v51
    v_cvt_pk_bf16_f32 v92, v44, v45
    v_cvt_pk_bf16_f32 v93, v46, v47
    v_cvt_pk_bf16_f32 v94, v52, v53
    v_cvt_pk_bf16_f32 v95, v54, v55
    v_mfma_f32_16x16x32_bf16 v[56:59], v[208:211], v[88:91], 0
    v_mfma_f32_16x16x32_bf16 v[60:63], v[212:215], v[88:91], 0
    v_mfma_f32_16x16x32_bf16 v[64:67], v[208:211], v[92:95], 0
    v_mfma_f32_16x16x32_bf16 v[68:71], v[212:215], v[92:95], 0
    s_nop 4
    v_max3_f32 v72, v56, v57, v58
    v_max3_f32 v73, -v56, -v57, -v58
    v_max3_f32 v74, v64, v65, v66
    v_max3_f32 v75, -v64, -v65, -v66
    v_max3_f32 v72, v72, v59, v60
    v_max3_f32 v73, v73, -v59, -v60
    v_max3_f32 v74, v74, v67, v68
    v_max3_f32 v75, v75, -v67, -v68
    v_max3_f32 v72, v72, v61, v62
    v_max3_f32 v73, v73, -v61, -v62
    v_max3_f32 v74, v74, v69, v70
    v_max3_f32 v75, v75, -v69, -v70
    v_max_f32 v88, v72, v63
    v_max_f32_e64 v90, v73, -v63
    v_max_f32 v92, v74, v71
    v_max_f32_e64 v94, v75, -v71
    s_nop 0
    v_permlane32_swap_b32 v88, v92
    v_permlane32_swap_b32 v90, v94
    v_max_f32 v88, v88, v92
    v_max_f32 v90, v90, v94
    s_nop 1
    v_permlane16_swap_b32 v88, v90
    v_max_f32 v88, v88, v90
    v_mul_f32 v88, v88, v225
    v_mov_b32 v90, v88
    s_nop 1
    v_permlane16_swap_b32 v88, v90
    v_mov_b32 v92, v88
    v_mov_b32 v94, v90
    s_nop 0
    v_permlane32_swap_b32 v88, v92
    buffer_load_dword v22, v10, s[56:59], s87 offen sc1
    v_permlane32_swap_b32 v90, v94
    v_mov_b32 v89, v88
    v_mov_b32 v93, v92
    v_mov_b32 v91, v90
    v_mov_b32 v95, v94
    v_pk_fma_f32 v[72:73], v[56:57], v[226:227], v[88:89]
    v_pk_fma_f32 v[80:81], v[64:65], v[228:229], v[92:93]
    v_pk_fma_f32 v[56:57], v[56:57], v[230:231], v[90:91]
    v_pk_fma_f32 v[64:65], v[64:65], v[244:245], v[94:95]
    v_pk_fma_f32 v[74:75], v[58:59], v[226:227], v[88:89]
    v_pk_fma_f32 v[82:83], v[66:67], v[228:229], v[92:93]
    v_pk_fma_f32 v[58:59], v[58:59], v[230:231], v[90:91]
    v_pk_fma_f32 v[66:67], v[66:67], v[244:245], v[94:95]
    v_pk_fma_f32 v[76:77], v[60:61], v[226:227], v[88:89]
    v_pk_fma_f32 v[84:85], v[68:69], v[228:229], v[92:93]
    v_pk_fma_f32 v[60:61], v[60:61], v[230:231], v[90:91]
    v_pk_fma_f32 v[68:69], v[68:69], v[244:245], v[94:95]
    v_pk_fma_f32 v[78:79], v[62:63], v[226:227], v[88:89]
    v_pk_fma_f32 v[86:87], v[70:71], v[228:229], v[92:93]
    v_pk_fma_f32 v[62:63], v[62:63], v[230:231], v[90:91]
    v_pk_fma_f32 v[70:71], v[70:71], v[244:245], v[94:95]
    v_exp_f32 v72, v72
    v_exp_f32 v56, v56
    v_exp_f32 v80, v80
    v_exp_f32 v64, v64
    v_exp_f32 v73, v73
    v_exp_f32 v57, v57
    v_exp_f32 v81, v81
    v_exp_f32 v65, v65
    v_exp_f32 v74, v74
    v_exp_f32 v58, v58
    v_exp_f32 v82, v82
    v_exp_f32 v66, v66
    v_add_f32 v88, v72, v73
    v_add_f32 v90, v56, v57
    v_add_f32 v92, v80, v81
    v_add_f32 v94, v64, v65
    v_exp_f32 v75, v75
    v_exp_f32 v59, v59
    v_exp_f32 v83, v83
    v_exp_f32 v67, v67
    v_add_f32 v88, v88, v74
    v_add_f32 v90, v90, v58
    v_add_f32 v92, v92, v82
    v_add_f32 v94, v94, v66
    v_exp_f32 v76, v76
    v_exp_f32 v60, v60
    v_exp_f32 v84, v84
    v_exp_f32 v68, v68
    v_add_f32 v88, v88, v75
    v_add_f32 v90, v90, v59
    v_add_f32 v92, v92, v83
    v_add_f32 v94, v94, v67
    v_exp_f32 v77, v77
    v_exp_f32 v61, v61
    v_exp_f32 v85, v85
    v_exp_f32 v69, v69
    v_add_f32 v88, v88, v76
    v_add_f32 v90, v90, v60
    v_add_f32 v92, v92, v84
    v_add_f32 v94, v94, v68
    v_exp_f32 v78, v78
    v_exp_f32 v62, v62
    v_exp_f32 v86, v86
    v_exp_f32 v70, v70
    v_add_f32 v88, v88, v77
    v_add_f32 v90, v90, v61
    v_add_f32 v92, v92, v85
    v_add_f32 v94, v94, v69
    v_exp_f32 v79, v79
    v_exp_f32 v63, v63
    v_exp_f32 v87, v87
    v_exp_f32 v71, v71
    v_add_f32 v88, v88, v78
    v_add_f32 v90, v90, v62
    v_add_f32 v92, v92, v86
    v_add_f32 v94, v94, v70
    v_add_f32 v88, v88, v79
    v_add_f32 v90, v90, v63
    v_add_f32 v92, v92, v87
    v_add_f32 v94, v94, v71
    s_nop 0
    v_permlane32_swap_b32 v88, v92
    v_permlane32_swap_b32 v90, v94
    v_add_f32 v88, v88, v92
    v_add_f32 v90, v90, v94
    s_nop 1
    v_permlane16_swap_b32 v88, v90
    v_add_f32 v88, v88, v90
    v_rcp_f32 v88, v88
    s_nop 0
    v_mov_b32 v90, v88
    s_nop 1
    v_permlane16_swap_b32 v88, v90
    v_mov_b32 v92, v88
    v_mov_b32 v94, v90
    s_nop 0
    v_permlane32_swap_b32 v88, v92
    v_permlane32_swap_b32 v90, v94
    v_mov_b32 v89, v88
    v_mov_b32 v93, v92
    v_mov_b32 v91, v90
    v_mov_b32 v95, v94
    v_pk_mul_f32 v[72:73], v[72:73], v[88:89]
    v_pk_mul_f32 v[80:81], v[80:81], v[92:93]
    v_pk_mul_f32 v[56:57], v[56:57], v[90:91]
    v_pk_mul_f32 v[64:65], v[64:65], v[94:95]
    v_cvt_pk_bf16_f32 v184, v72, v73
    v_cvt_pk_bf16_f32 v188, v56, v57
    v_cvt_pk_bf16_f32 v192, v80, v81
    v_cvt_pk_bf16_f32 v196, v64, v65
    v_pk_mul_f32 v[74:75], v[74:75], v[88:89]
    v_pk_mul_f32 v[82:83], v[82:83], v[92:93]
    v_pk_mul_f32 v[58:59], v[58:59], v[90:91]
    v_pk_mul_f32 v[66:67], v[66:67], v[94:95]
    v_cvt_pk_bf16_f32 v185, v74, v75
    v_cvt_pk_bf16_f32 v189, v58, v59
    v_cvt_pk_bf16_f32 v193, v82, v83
    v_cvt_pk_bf16_f32 v197, v66, v67
    ds_write_b64 v12, v[184:185] offset:4096
    ds_write_b64 v12, v[188:189] offset:6144
    ds_write_b64 v12, v[192:193] offset:4608
    ds_write_b64 v12, v[196:197] offset:6656
    v_pk_mul_f32 v[76:77], v[76:77], v[88:89]
    v_pk_mul_f32 v[84:85], v[84:85], v[92:93]
    v_pk_mul_f32 v[60:61], v[60:61], v[90:91]
    v_pk_mul_f32 v[68:69], v[68:69], v[94:95]
    v_cvt_pk_bf16_f32 v186, v76, v77
    v_cvt_pk_bf16_f32 v190, v60, v61
    v_cvt_pk_bf16_f32 v194, v84, v85
    v_cvt_pk_bf16_f32 v198, v68, v69
    v_pk_mul_f32 v[78:79], v[78:79], v[88:89]
    v_pk_mul_f32 v[86:87], v[86:87], v[92:93]
    v_pk_mul_f32 v[62:63], v[62:63], v[90:91]
    v_pk_mul_f32 v[70:71], v[70:71], v[94:95]
    v_cvt_pk_bf16_f32 v187, v78, v79
    v_cvt_pk_bf16_f32 v191, v62, v63
    v_cvt_pk_bf16_f32 v195, v86, v87
    v_cvt_pk_bf16_f32 v199, v70, v71
    ds_write_b64 v12, v[186:187] offset:5120
    ds_write_b64 v12, v[190:191] offset:7168
    ds_write_b64 v12, v[194:195] offset:5632
    ds_write_b64 v12, v[198:199] offset:7680
    s_waitcnt vmcnt(0)
    v_cmp_eq_u32 vcc, 0, v22
    s_mov_b32 s34, 0
    s_cbranch_vccz L_go1K
L_poll1K:
    buffer_load_dword v22, v10, s[56:59], s87 offen offset:0 sc1
    s_add_u32 s34, s34, 1
    s_waitcnt vmcnt(0)
    v_cmp_eq_u32 vcc, 0, v22
    s_cmp_gt_u32 s34, 200000
    s_cbranch_scc1 L_go1K
    s_cbranch_vccnz L_poll1K
L_go1K:
    buffer_load_dwordx4 v[120:123], v9, s[44:47], s90 offen offset:0 sc1
    buffer_load_dwordx4 v[124:127], v9, s[44:47], s90 offen offset:1024 sc1
    s_add_u32 s90, s90, 0x20000
    buffer_load_dwordx4 v[128:131], v9, s[44:47], s90 offen offset:0 sc1
    buffer_load_dwordx4 v[132:135], v9, s[44:47], s90 offen offset:1024 sc1
    s_add_u32 s90, s90, 0x20000
    buffer_load_dwordx4 v[136:139], v9, s[44:47], s90 offen offset:0 sc1
    buffer_load_dwordx4 v[140:143], v9, s[44:47], s90 offen offset:1024 sc1
    s_add_u32 s90, s90, 0x20000
    buffer_load_dwordx4 v[144:147], v9, s[44:47], s90 offen offset:0 sc1
    buffer_load_dwordx4 v[148:151], v9, s[44:47], s90 offen offset:1024 sc1
    s_add_u32 s90, s90, 0x20000
    buffer_load_dwordx4 v[152:155], v9, s[44:47], s90 offen offset:0 sc1
    buffer_load_dwordx4 v[156:159], v9, s[44:47], s90 offen offset:1024 sc1
    s_add_u32 s90, s90, 0x20000
    s_lshl_b32 s31, s28, 10
    v_lshlrev_b32 v12, 3, v1
    s_lshl_b32 s32, s30, 11
    s_add_u32 s32, s32, 8192
    v_add_u32 v13, s32, v12
    v_add_u32 v12, s31, v12
    v_add_u32 v14, 49152, v12
    v_add_u32 v15, 49152, v13
    v_mov_b32 v36, 0x3f803f80
    v_mov_b32 v37, 0x3f803f80
    v_mov_b32 v38, 0x3f803f80
    v_mov_b32 v39, 0x3f803f80
    s_lshl_b32 s31, s26, 14
    s_add_u32 s85, s84, s31
    v_lshlrev_b32 v16, 3, v1
    s_waitcnt lgkmcnt(0)
    s_barrier
    ds_read_b64_tr_b16 v[40:41], v12 offset:0
    ds_read_b64_tr_b16 v[42:43], v12 offset:512
    ds_read_b64_tr_b16 v[44:45], v13 offset:0
    ds_read_b64_tr_b16 v[46:47], v13 offset:512
    ds_read_b64_tr_b16 v[48:49], v13 offset:1024
    ds_read_b64_tr_b16 v[50:51], v13 offset:1536
    ds_read_b64_tr_b16 v[52:53], v12 offset:12288
    ds_read_b64_tr_b16 v[54:55], v12 offset:12800
    ds_read_b64_tr_b16 v[56:57], v13 offset:12288
    ds_read_b64_tr_b16 v[58:59], v13 offset:12800
    ds_read_b64_tr_b16 v[60:61], v13 offset:13312
    ds_read_b64_tr_b16 v[62:63], v13 offset:13824
    s_waitcnt lgkmcnt(6)
    ds_read_b64_tr_b16 v[64:65], v12 offset:24576
    ds_read_b64_tr_b16 v[66:67], v12 offset:25088
    ds_read_b64_tr_b16 v[68:69], v13 offset:24576
    ds_read_b64_tr_b16 v[70:71], v13 offset:25088
    ds_read_b64_tr_b16 v[72:73], v13 offset:25600
    ds_read_b64_tr_b16 v[74:75], v13 offset:26112
    v_mfma_f32_16x16x32_bf16 v[24:27], v[40:43], v[44:47], 0
    v_mfma_f32_16x16x32_bf16 v[28:31], v[40:43], v[48:51], 0
    v_mfma_f32_16x16x32_bf16 v[32:35], v[40:43], v[36:39], 0
    s_waitcnt lgkmcnt(6)
    ds_read_b64_tr_b16 v[76:77], v12 offset:36864
    ds_read_b64_tr_b16 v[78:79], v12 offset:37376
    ds_read_b64_tr_b16 v[80:81], v13 offset:36864
    ds_read_b64_tr_b16 v[82:83], v13 offset:37376
    ds_read_b64_tr_b16 v[84:85], v13 offset:37888
    ds_read_b64_tr_b16 v[86:87], v13 offset:38400
    v_mfma_f32_16x16x32_bf16 v[24:27], v[52:55], v[56:59], v[24:27]
    v_mfma_f32_16x16x32_bf16 v[28:31], v[52:55], v[60:63], v[28:31]
    v_mfma_f32_16x16x32_bf16 v[32:35], v[52:55], v[36:39], v[32:35]
    s_waitcnt lgkmcnt(6)
    ds_read_b64_tr_b16 v[40:41], v14 offset:0
    ds_read_b64_tr_b16 v[42:43], v14 offset:512
    ds_read_b64_tr_b16 v[44:45], v15 offset:0
    ds_read_b64_tr_b16 v[46:47], v15 offset:512
    ds_read_b64_tr_b16 v[48:49], v15 offset:1024
    ds_read_b64_tr_b16 v[50:51], v15 offset:1536
    v_mfma_f32_16x16x32_bf16 v[24:27], v[64:67], v[68:71], v[24:27]
    v_mfma_f32_16x16x32_bf16 v[28:31], v[64:67], v[72:75], v[28:31]
    v_mfma_f32_16x16x32_bf16 v[32:35], v[64:67], v[36:39], v[32:35]
    s_waitcnt lgkmcnt(6)
    ds_read_b64_tr_b16 v[52:53], v14 offset:12288
    ds_read_b64_tr_b16 v[54:55], v14 offset:12800
    ds_read_b64_tr_b16 v[56:57], v15 offset:12288
    ds_read_b64_tr_b16 v[58:59], v15 offset:12800
    ds_read_b64_tr_b16 v[60:61], v15 offset:13312
    ds_read_b64_tr_b16 v[62:63], v15 offset:13824
    v_mfma_f32_16x16x32_bf16 v[24:27], v[76:79], v[80:83], v[24:27]
    v_mfma_f32_16x16x32_bf16 v[28:31], v[76:79], v[84:87], v[28:31]
    v_mfma_f32_16x16x32_bf16 v[32:35], v[76:79], v[36:39], v[32:35]
    s_waitcnt lgkmcnt(6)
    ds_read_b64_tr_b16 v[64:65], v14 offset:24576
    ds_read_b64_tr_b16 v[66:67], v14 offset:25088
    ds_read_b64_tr_b16 v[68:69], v15 offset:24576
    ds_read_b64_tr_b16 v[70:71], v15 offset:25088
    ds_read_b64_tr_b16 v[72:73], v15 offset:25600
    ds_read_b64_tr_b16 v[74:75], v15 offset:26112
    v_mfma_f32_16x16x32_bf16 v[24:27], v[40:43], v[44:47], v[24:27]
    v_mfma_f32_16x16x32_bf16 v[28:31], v[40:43], v[48:51], v[28:31]
    v_mfma_f32_16x16x32_bf16 v[32:35], v[40:43], v[36:39], v[32:35]
    s_waitcnt lgkmcnt(6)
    ds_read_b64_tr_b16 v[76:77], v14 offset:36864
    ds_read_b64_tr_b16 v[78:79], v14 offset:37376
    ds_read_b64_tr_b16 v[80:81], v15 offset:36864
    ds_read_b64_tr_b16 v[82:83], v15 offset:37376
    ds_read_b64_tr_b16 v[84:85], v15 offset:37888
    ds_read_b64_tr_b16 v[86:87], v15 offset:38400
    v_mfma_f32_16x16x32_bf16 v[24:27], v[52:55], v[56:59], v[24:27]
    v_mfma_f32_16x16x32_bf16 v[28:31], v[52:55], v[60:63], v[28:31]
    v_mfma_f32_16x16x32_bf16 v[32:35], v[52:55], v[36:39], v[32:35]
    s_waitcnt lgkmcnt(6)
    v_mfma_f32_16x16x32_bf16 v[24:27], v[64:67], v[68:71], v[24:27]
    v_mfma_f32_16x16x32_bf16 v[28:31], v[64:67], v[72:75], v[28:31]
    v_mfma_f32_16x16x32_bf16 v[32:35], v[64:67], v[36:39], v[32:35]
    s_waitcnt lgkmcnt(0)
    v_mfma_f32_16x16x32_bf16 v[24:27], v[76:79], v[80:83], v[24:27]
    v_mfma_f32_16x16x32_bf16 v[28:31], v[76:79], v[84:87], v[28:31]
    v_mfma_f32_16x16x32_bf16 v[32:35], v[76:79], v[36:39], v[32:35]
    v_lshrrev_b32 v0, 2, v1
    v_lshlrev_b32 v12, 8, v0
    v_and_b32 v15, 3, v1
    v_lshl_add_u32 v12, v15, 3, v12
    v_and_b32 v0, 7, v0
    v_lshl_add_u32 v12, v0, 5, v12
    v_add_u32 v12, 98304, v12
    v_cvt_pk_bf16_f32 v168, v24, v25
    v_cvt_pk_bf16_f32 v169, v26, v27
    v_cvt_pk_bf16_f32 v170, v28, v29
    v_cvt_pk_bf16_f32 v171, v30, v31
    v_cvt_pk_bf16_f32 v172, v32, v33
    v_cvt_pk_bf16_f32 v173, v34, v35
    buffer_store_dwordx4 v[168:171], v11, s[56:59], s85 offen sc1
    buffer_store_dwordx2 v[172:173], v16, s[56:59], s85 offen offset:1024 sc1
    v_xor_b32 v13, 32, v12
    v_xor_b32 v14, 64, v12
    v_xor_b32 v15, 96, v12
    v_xor_b32 v16, 128, v12
    v_xor_b32 v17, 160, v12
    v_xor_b32 v18, 192, v12
    v_xor_b32 v19, 224, v12
    s_waitcnt vmcnt(18)
    s_barrier
    ds_read_b64_tr_b16 v[88:89], v12 offset:0
    ds_read_b64_tr_b16 v[90:91], v12 offset:4096
    ds_read_b64_tr_b16 v[92:93], v13 offset:0
    ds_read_b64_tr_b16 v[94:95], v13 offset:4096
    ds_read_b64_tr_b16 v[96:97], v14 offset:0
    ds_read_b64_tr_b16 v[98:99], v14 offset:4096
    ds_read_b64_tr_b16 v[100:101], v15 offset:0
    ds_read_b64_tr_b16 v[102:103], v15 offset:4096
    s_waitcnt vmcnt(10) lgkmcnt(6)
    v_mfma_f32_16x16x32_bf16 v[24:27], v[88:91], v[120:123], 0
    ds_read_b64_tr_b16 v[104:105], v16 offset:0
    v_mfma_f32_16x16x32_bf16 v[28:31], v[88:91], v[124:127], 0
    ds_read_b64_tr_b16 v[106:107], v16 offset:4096
    s_add_u32 m0, s88, 32768
    s_nop 0
    buffer_load_dwordx4 v5, s[36:39], s68 offen lds
    s_waitcnt lgkmcnt(6)
    v_mfma_f32_16x16x32_bf16 v[32:35], v[92:95], v[120:123], 0
    ds_read_b64_tr_b16 v[108:109], v17 offset:0
    v_mfma_f32_16x16x32_bf16 v[36:39], v[92:95], v[124:127], 0
    ds_read_b64_tr_b16 v[110:111], v17 offset:4096
    buffer_load_dwordx4 v[160:163], v9, s[44:47], s90 offen offset:0 sc1
    s_waitcnt lgkmcnt(6)
    v_mfma_f32_16x16x32_bf16 v[40:43], v[96:99], v[120:123], 0
    ds_read_b64_tr_b16 v[112:113], v18 offset:0
    v_mfma_f32_16x16x32_bf16 v[44:47], v[96:99], v[124:127], 0
    ds_read_b64_tr_b16 v[114:115], v18 offset:4096
    s_add_u32 m0, s88, 33792
    s_nop 0
    buffer_load_dwordx4 v6, s[36:39], s68 offen lds
    s_waitcnt lgkmcnt(6)
    v_mfma_f32_16x16x32_bf16 v[48:51], v[100:103], v[120:123], 0
    ds_read_b64_tr_b16 v[116:117], v19 offset:0
    v_mfma_f32_16x16x32_bf16 v[52:55], v[100:103], v[124:127], 0
    ds_read_b64_tr_b16 v[118:119], v19 offset:4096
    s_waitcnt lgkmcnt(6)
    v_mfma_f32_16x16x32_bf16 v[56:59], v[104:107], v[120:123], 0
    ds_read_b64_tr_b16 v[88:89], v12 offset:8192
    v_mfma_f32_16x16x32_bf16 v[60:63], v[104:107], v[124:127], 0
    ds_read_b64_tr_b16 v[90:91], v12 offset:12288
    s_add_u32 m0, s88, 34816
    s_nop 0
    buffer_load_dwordx4 v7, s[36:39], s68 offen lds
    buffer_load_dwordx4 v[164:167], v9, s[44:47], s90 offen offset:1024 sc1
    s_add_u32 s90, s90, 0x20000
    s_waitcnt lgkmcnt(6)
    v_mfma_f32_16x16x32_bf16 v[64:67], v[108:111], v[120:123], 0
    ds_read_b64_tr_b16 v[92:93], v13 offset:8192
    v_mfma_f32_16x16x32_bf16 v[68:71], v[108:111], v[124:127], 0
    ds_read_b64_tr_b16 v[94:95], v13 offset:12288
    s_waitcnt lgkmcnt(6)
    v_mfma_f32_16x16x32_bf16 v[72:75], v[112:115], v[120:123], 0
    ds_read_b64_tr_b16 v[96:97], v14 offset:8192
    v_mfma_f32_16x16x32_bf16 v[76:79], v[112:115], v[124:127], 0
    ds_read_b64_tr_b16 v[98:99], v14 offset:12288
    s_add_u32 m0, s88, 35840
    s_nop 0
    buffer_load_dwordx4 v8, s[36:39], s68 offen lds
    s_add_u32 s68, s68, 0x40000
    s_waitcnt lgkmcnt(6)
    v_mfma_f32_16x16x32_bf16 v[80:83], v[116:119], v[120:123], 0
    ds_read_b64_tr_b16 v[100:101], v15 offset:8192
    v_mfma_f32_16x16x32_bf16 v[84:87], v[116:119], v[124:127], 0
    ds_read_b64_tr_b16 v[102:103], v15 offset:12288
    s_waitcnt vmcnt(14) lgkmcnt(6)
    v_mfma_f32_16x16x32_bf16 v[24:27], v[88:91], v[128:131], v[24:27]
    ds_read_b64_tr_b16 v[104:105], v16 offset:8192
    v_mfma_f32_16x16x32_bf16 v[28:31], v[88:91], v[132:135], v[28:31]
    ds_read_b64_tr_b16 v[106:107], v16 offset:12288
    s_add_u32 m0, s88, 65536
    s_nop 0
    buffer_load_dwordx4 v5, s[36:39], s68 offen lds
    s_waitcnt lgkmcnt(6)
    v_mfma_f32_16x16x32_bf16 v[32:35], v[92:95], v[128:131], v[32:35]
    ds_read_b64_tr_b16 v[108:109], v17 offset:8192
    v_mfma_f32_16x16x32_bf16 v[36:39], v[92:95], v[132:135], v[36:39]
    ds_read_b64_tr_b16 v[110:111], v17 offset:12288
    buffer_load_dwordx4 v[120:123], v9, s[44:47], s90 offen offset:0 sc1
    s_waitcnt lgkmcnt(6)
    v_mfma_f32_16x16x32_bf16 v[40:43], v[96:99], v[128:131], v[40:43]
    ds_read_b64_tr_b16 v[112:113], v18 offset:8192
    v_mfma_f32_16x16x32_bf16 v[44:47], v[96:99], v[132:135], v[44:47]
    ds_read_b64_tr_b16 v[114:115], v18 offset:12288
    s_add_u32 m0, s88, 66560
    s_nop 0
    buffer_load_dwordx4 v6, s[36:39], s68 offen lds
    s_waitcnt lgkmcnt(6)
    v_mfma_f32_16x16x32_bf16 v[48:51], v[100:103], v[128:131], v[48:51]
    ds_read_b64_tr_b16 v[116:117], v19 offset:8192
    v_mfma_f32_16x16x32_bf16 v[52:55], v[100:103], v[132:135], v[52:55]
    ds_read_b64_tr_b16 v[118:119], v19 offset:12288
    s_waitcnt lgkmcnt(6)
    v_mfma_f32_16x16x32_bf16 v[56:59], v[104:107], v[128:131], v[56:59]
    ds_read_b64_tr_b16 v[88:89], v12 offset:16384
    v_mfma_f32_16x16x32_bf16 v[60:63], v[104:107], v[132:135], v[60:63]
    ds_read_b64_tr_b16 v[90:91], v12 offset:20480
    s_add_u32 m0, s88, 67584
    s_nop 0
    buffer_load_dwordx4 v7, s[36:39], s68 offen lds
    buffer_load_dwordx4 v[124:127], v9, s[44:47], s90 offen offset:1024 sc1
    s_add_u32 s90, s90, 0x20000
    s_waitcnt lgkmcnt(6)
    v_mfma_f32_16x16x32_bf16 v[64:67], v[108:111], v[128:131], v[64:67]
    ds_read_b64_tr_b16 v[92:93], v13 offset:16384
    v_mfma_f32_16x16x32_bf16 v[68:71], v[108:111], v[132:135], v[68:71]
    ds_read_b64_tr_b16 v[94:95], v13 offset:20480
    s_waitcnt lgkmcnt(6)
    v_mfma_f32_16x16x32_bf16 v[72:75], v[112:115], v[128:131], v[72:75]
    ds_read_b64_tr_b16 v[96:97], v14 offset:16384
    v_mfma_f32_16x16x32_bf16 v[76:79], v[112:115], v[132:135], v[76:79]
    ds_read_b64_tr_b16 v[98:99], v14 offset:20480
    s_add_u32 m0, s88, 68608
    s_nop 0
    buffer_load_dwordx4 v8, s[36:39], s68 offen lds
    s_add_u32 s68, s68, 0x40000
    s_waitcnt lgkmcnt(6)
    v_mfma_f32_16x16x32_bf16 v[80:83], v[116:119], v[128:131], v[80:83]
    ds_read_b64_tr_b16 v[100:101], v15 offset:16384
    v_mfma_f32_16x16x32_bf16 v[84:87], v[116:119], v[132:135], v[84:87]
    ds_read_b64_tr_b16 v[102:103], v15 offset:20480
    s_waitcnt vmcnt(18) lgkmcnt(6)
    v_mfma_f32_16x16x32_bf16 v[24:27], v[88:91], v[136:139], v[24:27]
    ds_read_b64_tr_b16 v[104:105], v16 offset:16384
    v_mfma_f32_16x16x32_bf16 v[28:31], v[88:91], v[140:143], v[28:31]
    ds_read_b64_tr_b16 v[106:107], v16 offset:20480
    s_waitcnt lgkmcnt(6)
    v_mfma_f32_16x16x32_bf16 v[32:35], v[92:95], v[136:139], v[32:35]
    ds_read_b64_tr_b16 v[108:109], v17 offset:16384
    v_mfma_f32_16x16x32_bf16 v[36:39], v[92:95], v[140:143], v[36:39]
    ds_read_b64_tr_b16 v[110:111], v17 offset:20480
    buffer_load_dwordx4 v[128:131], v9, s[44:47], s90 offen offset:0 sc1
    s_waitcnt lgkmcnt(6)
    v_mfma_f32_16x16x32_bf16 v[40:43], v[96:99], v[136:139], v[40:43]
    ds_read_b64_tr_b16 v[112:113], v18 offset:16384
    v_mfma_f32_16x16x32_bf16 v[44:47], v[96:99], v[140:143], v[44:47]
    ds_read_b64_tr_b16 v[114:115], v18 offset:20480
    s_waitcnt lgkmcnt(6)
    v_mfma_f32_16x16x32_bf16 v[48:51], v[100:103], v[136:139], v[48:51]
    ds_read_b64_tr_b16 v[116:117], v19 offset:16384
    v_mfma_f32_16x16x32_bf16 v[52:55], v[100:103], v[140:143], v[52:55]
    ds_read_b64_tr_b16 v[118:119], v19 offset:20480
    s_cmp_lt_u32 s28, 4
    s_cbranch_scc1 L_skKY32
    s_waitcnt vmcnt(27)
    s_barrier
L_skKY32:
    s_waitcnt lgkmcnt(6)
    v_mfma_f32_16x16x32_bf16 v[56:59], v[104:107], v[136:139], v[56:59]
    ds_read_b64_tr_b16 v[88:89], v12 offset:24576
    v_mfma_f32_16x16x32_bf16 v[60:63], v[104:107], v[140:143], v[60:63]
    ds_read_b64_tr_b16 v[90:91], v12 offset:28672
    buffer_load_dwordx4 v[132:135], v9, s[44:47], s90 offen offset:1024 sc1
    s_add_u32 s90, s90, 0x20000
    s_waitcnt lgkmcnt(6)
    v_mfma_f32_16x16x32_bf16 v[64:67], v[108:111], v[136:139], v[64:67]
    ds_read_b64_tr_b16 v[92:93], v13 offset:24576
    v_mfma_f32_16x16x32_bf16 v[68:71], v[108:111], v[140:143], v[68:71]
    ds_read_b64_tr_b16 v[94:95], v13 offset:28672
    s_waitcnt lgkmcnt(6)
    v_mfma_f32_16x16x32_bf16 v[72:75], v[112:115], v[136:139], v[72:75]
    ds_read_b64_tr_b16 v[96:97], v14 offset:24576
    v_mfma_f32_16x16x32_bf16 v[76:79], v[112:115], v[140:143], v[76:79]
    ds_read_b64_tr_b16 v[98:99], v14 offset:28672
    s_waitcnt lgkmcnt(6)
    v_mfma_f32_16x16x32_bf16 v[80:83], v[116:119], v[136:139], v[80:83]
    ds_read_b64_tr_b16 v[100:101], v15 offset:24576
    v_mfma_f32_16x16x32_bf16 v[84:87], v[116:119], v[140:143], v[84:87]
    ds_read_b64_tr_b16 v[102:103], v15 offset:28672
    s_waitcnt vmcnt(18) lgkmcnt(6)
    v_mfma_f32_16x16x32_bf16 v[24:27], v[88:91], v[144:147], v[24:27]
    ds_read_b64_tr_b16 v[104:105], v16 offset:24576
    v_mfma_f32_16x16x32_bf16 v[28:31], v[88:91], v[148:151], v[28:31]
    ds_read_b64_tr_b16 v[106:107], v16 offset:28672
    s_waitcnt lgkmcnt(6)
    v_mfma_f32_16x16x32_bf16 v[32:35], v[92:95], v[144:147], v[32:35]
    ds_read_b64_tr_b16 v[108:109], v17 offset:24576
    v_mfma_f32_16x16x32_bf16 v[36:39], v[92:95], v[148:151], v[36:39]
    ds_read_b64_tr_b16 v[110:111], v17 offset:28672
    buffer_load_dwordx4 v[136:139], v9, s[44:47], s90 offen offset:0 sc1
    s_waitcnt lgkmcnt(6)
    v_mfma_f32_16x16x32_bf16 v[40:43], v[96:99], v[144:147], v[40:43]
    ds_read_b64_tr_b16 v[112:113], v18 offset:24576
    v_mfma_f32_16x16x32_bf16 v[44:47], v[96:99], v[148:151], v[44:47]
    ds_read_b64_tr_b16 v[114:115], v18 offset:28672
    s_waitcnt lgkmcnt(6)
    v_mfma_f32_16x16x32_bf16 v[48:51], v[100:103], v[144:147], v[48:51]
    ds_read_b64_tr_b16 v[116:117], v19 offset:24576
    v_mfma_f32_16x16x32_bf16 v[52:55], v[100:103], v[148:151], v[52:55]
    ds_read_b64_tr_b16 v[118:119], v19 offset:28672
    s_cmp_lt_u32 s28, 4
    s_cbranch_scc0 L_skKX32
    s_waitcnt vmcnt(29)
    s_barrier
L_skKX32:
    v_add_u32 v12, 32768, v12
    s_waitcnt lgkmcnt(6)
    v_mfma_f32_16x16x32_bf16 v[56:59], v[104:107], v[144:147], v[56:59]
    ds_read_b64_tr_b16 v[88:89], v12 offset:0
    v_mfma_f32_16x16x32_bf16 v[60:63], v[104:107], v[148:151], v[60:63]
    ds_read_b64_tr_b16 v[90:91], v12 offset:4096
    buffer_load_dwordx4 v[140:143], v9, s[44:47], s90 offen offset:1024 sc1
    s_add_u32 s90, s90, 0x20000
    v_add_u32 v13, 32768, v13
    s_waitcnt lgkmcnt(6)
    v_mfma_f32_16x16x32_bf16 v[64:67], v[108:111], v[144:147], v[64:67]
    ds_read_b64_tr_b16 v[92:93], v13 offset:0
    v_mfma_f32_16x16x32_bf16 v[68:71], v[108:111], v[148:151], v[68:71]
    ds_read_b64_tr_b16 v[94:95], v13 offset:4096
    v_add_u32 v14, 32768, v14
    s_waitcnt lgkmcnt(6)
    v_mfma_f32_16x16x32_bf16 v[72:75], v[112:115], v[144:147], v[72:75]
    ds_read_b64_tr_b16 v[96:97], v14 offset:0
    v_mfma_f32_16x16x32_bf16 v[76:79], v[112:115], v[148:151], v[76:79]
    ds_read_b64_tr_b16 v[98:99], v14 offset:4096
    v_add_u32 v15, 32768, v15
    s_waitcnt lgkmcnt(6)
    v_mfma_f32_16x16x32_bf16 v[80:83], v[116:119], v[144:147], v[80:83]
    ds_read_b64_tr_b16 v[100:101], v15 offset:0
    v_mfma_f32_16x16x32_bf16 v[84:87], v[116:119], v[148:151], v[84:87]
    ds_read_b64_tr_b16 v[102:103], v15 offset:4096
    v_add_u32 v16, 32768, v16
    s_waitcnt vmcnt(18) lgkmcnt(6)
    v_mfma_f32_16x16x32_bf16 v[24:27], v[88:91], v[152:155], v[24:27]
    ds_read_b64_tr_b16 v[104:105], v16 offset:0
    v_mfma_f32_16x16x32_bf16 v[28:31], v[88:91], v[156:159], v[28:31]
    ds_read_b64_tr_b16 v[106:107], v16 offset:4096
    v_add_u32 v17, 32768, v17
    s_waitcnt lgkmcnt(6)
    v_mfma_f32_16x16x32_bf16 v[32:35], v[92:95], v[152:155], v[32:35]
    ds_read_b64_tr_b16 v[108:109], v17 offset:0
    v_mfma_f32_16x16x32_bf16 v[36:39], v[92:95], v[156:159], v[36:39]
    ds_read_b64_tr_b16 v[110:111], v17 offset:4096
    buffer_load_dwordx4 v[144:147], v9, s[44:47], s90 offen offset:0 sc1
    v_add_u32 v18, 32768, v18
    s_waitcnt lgkmcnt(6)
    v_mfma_f32_16x16x32_bf16 v[40:43], v[96:99], v[152:155], v[40:43]
    ds_read_b64_tr_b16 v[112:113], v18 offset:0
    v_mfma_f32_16x16x32_bf16 v[44:47], v[96:99], v[156:159], v[44:47]
    ds_read_b64_tr_b16 v[114:115], v18 offset:4096
    v_add_u32 v19, 32768, v19
    s_waitcnt lgkmcnt(6)
    v_mfma_f32_16x16x32_bf16 v[48:51], v[100:103], v[152:155], v[48:51]
    ds_read_b64_tr_b16 v[116:117], v19 offset:0
    v_mfma_f32_16x16x32_bf16 v[52:55], v[100:103], v[156:159], v[52:55]
    ds_read_b64_tr_b16 v[118:119], v19 offset:4096
    s_waitcnt lgkmcnt(6)
    v_mfma_f32_16x16x32_bf16 v[56:59], v[104:107], v[152:155], v[56:59]
    ds_read_b64_tr_b16 v[88:89], v12 offset:8192
    v_mfma_f32_16x16x32_bf16 v[60:63], v[104:107], v[156:159], v[60:63]
    ds_read_b64_tr_b16 v[90:91], v12 offset:12288
    buffer_load_dwordx4 v[148:151], v9, s[44:47], s90 offen offset:1024 sc1
    s_add_u32 s90, s90, 0x20000
    s_waitcnt lgkmcnt(6)
    v_mfma_f32_16x16x32_bf16 v[64:67], v[108:111], v[152:155], v[64:67]
    ds_read_b64_tr_b16 v[92:93], v13 offset:8192
    v_mfma_f32_16x16x32_bf16 v[68:71], v[108:111], v[156:159], v[68:71]
    ds_read_b64_tr_b16 v[94:95], v13 offset:12288
    s_waitcnt lgkmcnt(6)
    v_mfma_f32_16x16x32_bf16 v[72:75], v[112:115], v[152:155], v[72:75]
    ds_read_b64_tr_b16 v[96:97], v14 offset:8192
    v_mfma_f32_16x16x32_bf16 v[76:79], v[112:115], v[156:159], v[76:79]
    ds_read_b64_tr_b16 v[98:99], v14 offset:12288
    s_waitcnt lgkmcnt(6)
    v_mfma_f32_16x16x32_bf16 v[80:83], v[116:119], v[152:155], v[80:83]
    ds_read_b64_tr_b16 v[100:101], v15 offset:8192
    v_mfma_f32_16x16x32_bf16 v[84:87], v[116:119], v[156:159], v[84:87]
    ds_read_b64_tr_b16 v[102:103], v15 offset:12288
    s_waitcnt vmcnt(13) lgkmcnt(6)
    v_mfma_f32_16x16x32_bf16 v[24:27], v[88:91], v[160:163], v[24:27]
    ds_read_b64_tr_b16 v[104:105], v16 offset:8192
    v_mfma_f32_16x16x32_bf16 v[28:31], v[88:91], v[164:167], v[28:31]
    ds_read_b64_tr_b16 v[106:107], v16 offset:12288
    s_waitcnt lgkmcnt(6)
    v_mfma_f32_16x16x32_bf16 v[32:35], v[92:95], v[160:163], v[32:35]
    ds_read_b64_tr_b16 v[108:109], v17 offset:8192
    v_mfma_f32_16x16x32_bf16 v[36:39], v[92:95], v[164:167], v[36:39]
    ds_read_b64_tr_b16 v[110:111], v17 offset:12288
    buffer_load_dwordx4 v[152:155], v9, s[44:47], s90 offen offset:0 sc1
    s_waitcnt lgkmcnt(6)
    v_mfma_f32_16x16x32_bf16 v[40:43], v[96:99], v[160:163], v[40:43]
    ds_read_b64_tr_b16 v[112:113], v18 offset:8192
    v_mfma_f32_16x16x32_bf16 v[44:47], v[96:99], v[164:167], v[44:47]
    ds_read_b64_tr_b16 v[114:115], v18 offset:12288
    s_waitcnt lgkmcnt(6)
    v_mfma_f32_16x16x32_bf16 v[48:51], v[100:103], v[160:163], v[48:51]
    ds_read_b64_tr_b16 v[116:117], v19 offset:8192
    v_mfma_f32_16x16x32_bf16 v[52:55], v[100:103], v[164:167], v[52:55]
    ds_read_b64_tr_b16 v[118:119], v19 offset:12288
    s_waitcnt lgkmcnt(6)
    v_mfma_f32_16x16x32_bf16 v[56:59], v[104:107], v[160:163], v[56:59]
    ds_read_b64_tr_b16 v[88:89], v12 offset:16384
    v_mfma_f32_16x16x32_bf16 v[60:63], v[104:107], v[164:167], v[60:63]
    ds_read_b64_tr_b16 v[90:91], v12 offset:20480
    buffer_load_dwordx4 v[156:159], v9, s[44:47], s90 offen offset:1024 sc1
    s_add_u32 s90, s90, 0x20000
    s_waitcnt lgkmcnt(6)
    v_mfma_f32_16x16x32_bf16 v[64:67], v[108:111], v[160:163], v[64:67]
    ds_read_b64_tr_b16 v[92:93], v13 offset:16384
    v_mfma_f32_16x16x32_bf16 v[68:71], v[108:111], v[164:167], v[68:71]
    ds_read_b64_tr_b16 v[94:95], v13 offset:20480
    s_waitcnt lgkmcnt(6)
    v_mfma_f32_16x16x32_bf16 v[72:75], v[112:115], v[160:163], v[72:75]
    ds_read_b64_tr_b16 v[96:97], v14 offset:16384
    v_mfma_f32_16x16x32_bf16 v[76:79], v[112:115], v[164:167], v[76:79]
    ds_read_b64_tr_b16 v[98:99], v14 offset:20480
    s_waitcnt lgkmcnt(6)
    v_mfma_f32_16x16x32_bf16 v[80:83], v[116:119], v[160:163], v[80:83]
    ds_read_b64_tr_b16 v[100:101], v15 offset:16384
    v_mfma_f32_16x16x32_bf16 v[84:87], v[116:119], v[164:167], v[84:87]
    ds_read_b64_tr_b16 v[102:103], v15 offset:20480
    s_waitcnt vmcnt(9) lgkmcnt(6)
    v_mfma_f32_16x16x32_bf16 v[24:27], v[88:91], v[120:123], v[24:27]
    ds_read_b64_tr_b16 v[104:105], v16 offset:16384
    v_mfma_f32_16x16x32_bf16 v[28:31], v[88:91], v[124:127], v[28:31]
    ds_read_b64_tr_b16 v[106:107], v16 offset:20480
    s_waitcnt lgkmcnt(6)
    v_mfma_f32_16x16x32_bf16 v[32:35], v[92:95], v[120:123], v[32:35]
    ds_read_b64_tr_b16 v[108:109], v17 offset:16384
    v_mfma_f32_16x16x32_bf16 v[36:39], v[92:95], v[124:127], v[36:39]
    ds_read_b64_tr_b16 v[110:111], v17 offset:20480
    buffer_load_dwordx4 v[160:163], v9, s[44:47], s90 offen offset:0 sc1
    s_waitcnt lgkmcnt(6)
    v_mfma_f32_16x16x32_bf16 v[40:43], v[96:99], v[120:123], v[40:43]
    ds_read_b64_tr_b16 v[112:113], v18 offset:16384
    v_mfma_f32_16x16x32_bf16 v[44:47], v[96:99], v[124:127], v[44:47]
    ds_read_b64_tr_b16 v[114:115], v18 offset:20480
    s_waitcnt lgkmcnt(6)
    v_mfma_f32_16x16x32_bf16 v[48:51], v[100:103], v[120:123], v[48:51]
    ds_read_b64_tr_b16 v[116:117], v19 offset:16384
    v_mfma_f32_16x16x32_bf16 v[52:55], v[100:103], v[124:127], v[52:55]
    ds_read_b64_tr_b16 v[118:119], v19 offset:20480
    s_cmp_lt_u32 s28, 4
    s_cbranch_scc1 L_skKY64
    s_waitcnt vmcnt(15)
    s_barrier
L_skKY64:
    s_waitcnt lgkmcnt(6)
    v_mfma_f32_16x16x32_bf16 v[56:59], v[104:107], v[120:123], v[56:59]
    ds_read_b64_tr_b16 v[88:89], v12 offset:24576
    v_mfma_f32_16x16x32_bf16 v[60:63], v[104:107], v[124:127], v[60:63]
    ds_read_b64_tr_b16 v[90:91], v12 offset:28672
    buffer_load_dwordx4 v[164:167], v9, s[44:47], s90 offen offset:1024 sc1
    s_add_u32 s90, s90, 0x20000
    s_waitcnt lgkmcnt(6)
    v_mfma_f32_16x16x32_bf16 v[64:67], v[108:111], v[120:123], v[64:67]
    ds_read_b64_tr_b16 v[92:93], v13 offset:24576
    v_mfma_f32_16x16x32_bf16 v[68:71], v[108:111], v[124:127], v[68:71]
    ds_read_b64_tr_b16 v[94:95], v13 offset:28672
    s_waitcnt lgkmcnt(6)
    v_mfma_f32_16x16x32_bf16 v[72:75], v[112:115], v[120:123], v[72:75]
    ds_read_b64_tr_b16 v[96:97], v14 offset:24576
    v_mfma_f32_16x16x32_bf16 v[76:79], v[112:115], v[124:127], v[76:79]
    ds_read_b64_tr_b16 v[98:99], v14 offset:28672
    s_waitcnt lgkmcnt(6)
    v_mfma_f32_16x16x32_bf16 v[80:83], v[116:119], v[120:123], v[80:83]
    ds_read_b64_tr_b16 v[100:101], v15 offset:24576
    v_mfma_f32_16x16x32_bf16 v[84:87], v[116:119], v[124:127], v[84:87]
    ds_read_b64_tr_b16 v[102:103], v15 offset:28672
    s_waitcnt vmcnt(8) lgkmcnt(6)
    v_mfma_f32_16x16x32_bf16 v[24:27], v[88:91], v[128:131], v[24:27]
    ds_read_b64_tr_b16 v[104:105], v16 offset:24576
    v_mfma_f32_16x16x32_bf16 v[28:31], v[88:91], v[132:135], v[28:31]
    ds_read_b64_tr_b16 v[106:107], v16 offset:28672
    s_waitcnt lgkmcnt(6)
    v_mfma_f32_16x16x32_bf16 v[32:35], v[92:95], v[128:131], v[32:35]
    ds_read_b64_tr_b16 v[108:109], v17 offset:24576
    v_mfma_f32_16x16x32_bf16 v[36:39], v[92:95], v[132:135], v[36:39]
    ds_read_b64_tr_b16 v[110:111], v17 offset:28672
    buffer_load_dwordx4 v[120:123], v9, s[44:47], s90 offen offset:0 sc1
    s_waitcnt lgkmcnt(6)
    v_mfma_f32_16x16x32_bf16 v[40:43], v[96:99], v[128:131], v[40:43]
    ds_read_b64_tr_b16 v[112:113], v18 offset:24576
    v_mfma_f32_16x16x32_bf16 v[44:47], v[96:99], v[132:135], v[44:47]
    ds_read_b64_tr_b16 v[114:115], v18 offset:28672
    s_waitcnt lgkmcnt(6)
    v_mfma_f32_16x16x32_bf16 v[48:51], v[100:103], v[128:131], v[48:51]
    ds_read_b64_tr_b16 v[116:117], v19 offset:24576
    v_mfma_f32_16x16x32_bf16 v[52:55], v[100:103], v[132:135], v[52:55]
    ds_read_b64_tr_b16 v[118:119], v19 offset:28672
    s_cmp_lt_u32 s28, 4
    s_cbranch_scc0 L_skKX64
    s_waitcnt vmcnt(17)
    s_barrier
L_skKX64:
    v_add_u32 v12, 4294868992, v12
    s_waitcnt lgkmcnt(6)
    v_mfma_f32_16x16x32_bf16 v[56:59], v[104:107], v[128:131], v[56:59]
    ds_read_b64_tr_b16 v[88:89], v12 offset:0
    v_mfma_f32_16x16x32_bf16 v[60:63], v[104:107], v[132:135], v[60:63]
    ds_read_b64_tr_b16 v[90:91], v12 offset:4096
    buffer_load_dwordx4 v[124:127], v9, s[44:47], s90 offen offset:1024 sc1
    s_add_u32 s90, s90, 0x20000
    v_add_u32 v13, 4294868992, v13
    s_waitcnt lgkmcnt(6)
    v_mfma_f32_16x16x32_bf16 v[64:67], v[108:111], v[128:131], v[64:67]
    ds_read_b64_tr_b16 v[92:93], v13 offset:0
    v_mfma_f32_16x16x32_bf16 v[68:71], v[108:111], v[132:135], v[68:71]
    ds_read_b64_tr_b16 v[94:95], v13 offset:4096
    v_add_u32 v14, 4294868992, v14
    s_waitcnt lgkmcnt(6)
    v_mfma_f32_16x16x32_bf16 v[72:75], v[112:115], v[128:131], v[72:75]
    ds_read_b64_tr_b16 v[96:97], v14 offset:0
    v_mfma_f32_16x16x32_bf16 v[76:79], v[112:115], v[132:135], v[76:79]
    ds_read_b64_tr_b16 v[98:99], v14 offset:4096
    s_add_u32 m0, s88, 98304
    s_nop 0
    buffer_load_dwordx4 v5, s[36:39], s68 offen lds
    v_add_u32 v15, 4294868992, v15
    s_waitcnt lgkmcnt(6)
    v_mfma_f32_16x16x32_bf16 v[80:83], v[116:119], v[128:131], v[80:83]
    ds_read_b64_tr_b16 v[100:101], v15 offset:0
    v_mfma_f32_16x16x32_bf16 v[84:87], v[116:119], v[132:135], v[84:87]
    ds_read_b64_tr_b16 v[102:103], v15 offset:4096
    v_add_u32 v16, 4294868992, v16
    s_waitcnt vmcnt(9) lgkmcnt(6)
    v_mfma_f32_16x16x32_bf16 v[24:27], v[88:91], v[136:139], v[24:27]
    ds_read_b64_tr_b16 v[104:105], v16 offset:0
    v_mfma_f32_16x16x32_bf16 v[28:31], v[88:91], v[140:143], v[28:31]
    ds_read_b64_tr_b16 v[106:107], v16 offset:4096
    v_add_u32 v17, 4294868992, v17
    s_waitcnt lgkmcnt(6)
    v_mfma_f32_16x16x32_bf16 v[32:35], v[92:95], v[136:139], v[32:35]
    ds_read_b64_tr_b16 v[108:109], v17 offset:0
    v_mfma_f32_16x16x32_bf16 v[36:39], v[92:95], v[140:143], v[36:39]
    ds_read_b64_tr_b16 v[110:111], v17 offset:4096
    buffer_load_dwordx4 v[128:131], v9, s[44:47], s90 offen offset:0 sc1
    v_add_u32 v18, 4294868992, v18
    s_waitcnt lgkmcnt(6)
    v_mfma_f32_16x16x32_bf16 v[40:43], v[96:99], v[136:139], v[40:43]
    ds_read_b64_tr_b16 v[112:113], v18 offset:0
    v_mfma_f32_16x16x32_bf16 v[44:47], v[96:99], v[140:143], v[44:47]
    ds_read_b64_tr_b16 v[114:115], v18 offset:4096
    s_add_u32 m0, s88, 99328
    s_nop 0
    buffer_load_dwordx4 v6, s[36:39], s68 offen lds
    v_add_u32 v19, 4294868992, v19
    s_waitcnt lgkmcnt(6)
    v_mfma_f32_16x16x32_bf16 v[48:51], v[100:103], v[136:139], v[48:51]
    ds_read_b64_tr_b16 v[116:117], v19 offset:0
    v_mfma_f32_16x16x32_bf16 v[52:55], v[100:103], v[140:143], v[52:55]
    ds_read_b64_tr_b16 v[118:119], v19 offset:4096
    s_waitcnt lgkmcnt(6)
    v_mfma_f32_16x16x32_bf16 v[56:59], v[104:107], v[136:139], v[56:59]
    ds_read_b64_tr_b16 v[88:89], v12 offset:8192
    v_mfma_f32_16x16x32_bf16 v[60:63], v[104:107], v[140:143], v[60:63]
    ds_read_b64_tr_b16 v[90:91], v12 offset:12288
    buffer_load_dwordx4 v[132:135], v9, s[44:47], s90 offen offset:1024 sc1
    s_add_u32 s90, s90, 0x20000
    s_waitcnt lgkmcnt(6)
    v_mfma_f32_16x16x32_bf16 v[64:67], v[108:111], v[136:139], v[64:67]
    ds_read_b64_tr_b16 v[92:93], v13 offset:8192
    v_mfma_f32_16x16x32_bf16 v[68:71], v[108:111], v[140:143], v[68:71]
    ds_read_b64_tr_b16 v[94:95], v13 offset:12288
    s_waitcnt lgkmcnt(6)
    v_mfma_f32_16x16x32_bf16 v[72:75], v[112:115], v[136:139], v[72:75]
    ds_read_b64_tr_b16 v[96:97], v14 offset:8192
    v_mfma_f32_16x16x32_bf16 v[76:79], v[112:115], v[140:143], v[76:79]
    ds_read_b64_tr_b16 v[98:99], v14 offset:12288
    s_add_u32 m0, s88, 100352
    s_nop 0
    buffer_load_dwordx4 v7, s[36:39], s68 offen lds
    s_waitcnt lgkmcnt(6)
    v_mfma_f32_16x16x32_bf16 v[80:83], v[116:119], v[136:139], v[80:83]
    ds_read_b64_tr_b16 v[100:101], v15 offset:8192
    v_mfma_f32_16x16x32_bf16 v[84:87], v[116:119], v[140:143], v[84:87]
    ds_read_b64_tr_b16 v[102:103], v15 offset:12288
    s_waitcnt vmcnt(11) lgkmcnt(6)
    v_mfma_f32_16x16x32_bf16 v[24:27], v[88:91], v[144:147], v[24:27]
    ds_read_b64_tr_b16 v[104:105], v16 offset:8192
    v_mfma_f32_16x16x32_bf16 v[28:31], v[88:91], v[148:151], v[28:31]
    ds_read_b64_tr_b16 v[106:107], v16 offset:12288
    s_waitcnt lgkmcnt(6)
    v_mfma_f32_16x16x32_bf16 v[32:35], v[92:95], v[144:147], v[32:35]
    ds_read_b64_tr_b16 v[108:109], v17 offset:8192
    v_mfma_f32_16x16x32_bf16 v[36:39], v[92:95], v[148:151], v[36:39]
    ds_read_b64_tr_b16 v[110:111], v17 offset:12288
    buffer_load_dwordx4 v[136:139], v9, s[44:47], s90 offen offset:0 sc1
    s_waitcnt lgkmcnt(6)
    v_mfma_f32_16x16x32_bf16 v[40:43], v[96:99], v[144:147], v[40:43]
    ds_read_b64_tr_b16 v[112:113], v18 offset:8192
    v_mfma_f32_16x16x32_bf16 v[44:47], v[96:99], v[148:151], v[44:47]
    ds_read_b64_tr_b16 v[114:115], v18 offset:12288
    s_add_u32 m0, s88, 101376
    s_nop 0
    buffer_load_dwordx4 v8, s[36:39], s68 offen lds
    s_add_u32 s68, s68, 0x40000
    s_waitcnt lgkmcnt(6)
    v_mfma_f32_16x16x32_bf16 v[48:51], v[100:103], v[144:147], v[48:51]
    ds_read_b64_tr_b16 v[116:117], v19 offset:8192
    v_mfma_f32_16x16x32_bf16 v[52:55], v[100:103], v[148:151], v[52:55]
    ds_read_b64_tr_b16 v[118:119], v19 offset:12288
    s_waitcnt lgkmcnt(6)
    v_mfma_f32_16x16x32_bf16 v[56:59], v[104:107], v[144:147], v[56:59]
    ds_read_b64_tr_b16 v[88:89], v12 offset:16384
    v_mfma_f32_16x16x32_bf16 v[60:63], v[104:107], v[148:151], v[60:63]
    ds_read_b64_tr_b16 v[90:91], v12 offset:20480
    buffer_load_dwordx4 v[140:143], v9, s[44:47], s90 offen offset:1024 sc1
    s_add_u32 s90, s90, 0x20000
    s_waitcnt lgkmcnt(6)
    v_mfma_f32_16x16x32_bf16 v[64:67], v[108:111], v[144:147], v[64:67]
    ds_read_b64_tr_b16 v[92:93], v13 offset:16384
    v_mfma_f32_16x16x32_bf16 v[68:71], v[108:111], v[148:151], v[68:71]
    ds_read_b64_tr_b16 v[94:95], v13 offset:20480
    s_waitcnt lgkmcnt(6)
    v_mfma_f32_16x16x32_bf16 v[72:75], v[112:115], v[144:147], v[72:75]
    ds_read_b64_tr_b16 v[96:97], v14 offset:16384
    v_mfma_f32_16x16x32_bf16 v[76:79], v[112:115], v[148:151], v[76:79]
    ds_read_b64_tr_b16 v[98:99], v14 offset:20480
    s_waitcnt lgkmcnt(6)
    v_mfma_f32_16x16x32_bf16 v[80:83], v[116:119], v[144:147], v[80:83]
    ds_read_b64_tr_b16 v[100:101], v15 offset:16384
    v_mfma_f32_16x16x32_bf16 v[84:87], v[116:119], v[148:151], v[84:87]
    ds_read_b64_tr_b16 v[102:103], v15 offset:20480
    s_waitcnt vmcnt(12) lgkmcnt(6)
    v_mfma_f32_16x16x32_bf16 v[24:27], v[88:91], v[152:155], v[24:27]
    ds_read_b64_tr_b16 v[104:105], v16 offset:16384
    v_mfma_f32_16x16x32_bf16 v[28:31], v[88:91], v[156:159], v[28:31]
    ds_read_b64_tr_b16 v[106:107], v16 offset:20480
    s_waitcnt lgkmcnt(6)
    v_mfma_f32_16x16x32_bf16 v[32:35], v[92:95], v[152:155], v[32:35]
    ds_read_b64_tr_b16 v[108:109], v17 offset:16384
    v_mfma_f32_16x16x32_bf16 v[36:39], v[92:95], v[156:159], v[36:39]
    ds_read_b64_tr_b16 v[110:111], v17 offset:20480
    buffer_load_dwordx4 v[144:147], v9, s[44:47], s90 offen offset:0 sc1
    s_waitcnt lgkmcnt(6)
    v_mfma_f32_16x16x32_bf16 v[40:43], v[96:99], v[152:155], v[40:43]
    ds_read_b64_tr_b16 v[112:113], v18 offset:16384
    v_mfma_f32_16x16x32_bf16 v[44:47], v[96:99], v[156:159], v[44:47]
    ds_read_b64_tr_b16 v[114:115], v18 offset:20480
    s_waitcnt lgkmcnt(6)
    v_mfma_f32_16x16x32_bf16 v[48:51], v[100:103], v[152:155], v[48:51]
    ds_read_b64_tr_b16 v[116:117], v19 offset:16384
    v_mfma_f32_16x16x32_bf16 v[52:55], v[100:103], v[156:159], v[52:55]
    ds_read_b64_tr_b16 v[118:119], v19 offset:20480
    s_cmp_lt_u32 s28, 4
    s_cbranch_scc1 L_skKY96
    s_waitcnt vmcnt(21)
    s_barrier
L_skKY96:
    s_waitcnt lgkmcnt(6)
    v_mfma_f32_16x16x32_bf16 v[56:59], v[104:107], v[152:155], v[56:59]
    ds_read_b64_tr_b16 v[88:89], v12 offset:24576
    v_mfma_f32_16x16x32_bf16 v[60:63], v[104:107], v[156:159], v[60:63]
    ds_read_b64_tr_b16 v[90:91], v12 offset:28672
    buffer_load_dwordx4 v[148:151], v9, s[44:47], s90 offen offset:1024 sc1
    s_add_u32 s90, s90, 0x20000
    s_waitcnt lgkmcnt(6)
    v_mfma_f32_16x16x32_bf16 v[64:67], v[108:111], v[152:155], v[64:67]
    ds_read_b64_tr_b16 v[92:93], v13 offset:24576
    v_mfma_f32_16x16x32_bf16 v[68:71], v[108:111], v[156:159], v[68:71]
    ds_read_b64_tr_b16 v[94:95], v13 offset:28672
    s_waitcnt lgkmcnt(6)
    v_mfma_f32_16x16x32_bf16 v[72:75], v[112:115], v[152:155], v[72:75]
    ds_read_b64_tr_b16 v[96:97], v14 offset:24576
    v_mfma_f32_16x16x32_bf16 v[76:79], v[112:115], v[156:159], v[76:79]
    ds_read_b64_tr_b16 v[98:99], v14 offset:28672
    s_waitcnt lgkmcnt(6)
    v_mfma_f32_16x16x32_bf16 v[80:83], v[116:119], v[152:155], v[80:83]
    ds_read_b64_tr_b16 v[100:101], v15 offset:24576
    v_mfma_f32_16x16x32_bf16 v[84:87], v[116:119], v[156:159], v[84:87]
    ds_read_b64_tr_b16 v[102:103], v15 offset:28672
    s_waitcnt vmcnt(12) lgkmcnt(6)
    v_mfma_f32_16x16x32_bf16 v[24:27], v[88:91], v[160:163], v[24:27]
    ds_read_b64_tr_b16 v[104:105], v16 offset:24576
    v_mfma_f32_16x16x32_bf16 v[28:31], v[88:91], v[164:167], v[28:31]
    ds_read_b64_tr_b16 v[106:107], v16 offset:28672
    s_waitcnt lgkmcnt(6)
    v_mfma_f32_16x16x32_bf16 v[32:35], v[92:95], v[160:163], v[32:35]
    ds_read_b64_tr_b16 v[108:109], v17 offset:24576
    v_mfma_f32_16x16x32_bf16 v[36:39], v[92:95], v[164:167], v[36:39]
    ds_read_b64_tr_b16 v[110:111], v17 offset:28672
    buffer_load_dwordx4 v[152:155], v9, s[44:47], s90 offen offset:0 sc1
    s_waitcnt lgkmcnt(6)
    v_mfma_f32_16x16x32_bf16 v[40:43], v[96:99], v[160:163], v[40:43]
    ds_read_b64_tr_b16 v[112:113], v18 offset:24576
    v_mfma_f32_16x16x32_bf16 v[44:47], v[96:99], v[164:167], v[44:47]
    ds_read_b64_tr_b16 v[114:115], v18 offset:28672
    s_waitcnt lgkmcnt(6)
    v_mfma_f32_16x16x32_bf16 v[48:51], v[100:103], v[160:163], v[48:51]
    ds_read_b64_tr_b16 v[116:117], v19 offset:24576
    v_mfma_f32_16x16x32_bf16 v[52:55], v[100:103], v[164:167], v[52:55]
    ds_read_b64_tr_b16 v[118:119], v19 offset:28672
    s_cmp_lt_u32 s28, 4
    s_cbranch_scc0 L_skKX96
    s_waitcnt vmcnt(23)
    s_barrier
L_skKX96:
    v_add_u32 v12, 32768, v12
    s_waitcnt lgkmcnt(6)
    v_mfma_f32_16x16x32_bf16 v[56:59], v[104:107], v[160:163], v[56:59]
    ds_read_b64_tr_b16 v[88:89], v12 offset:0
    v_mfma_f32_16x16x32_bf16 v[60:63], v[104:107], v[164:167], v[60:63]
    ds_read_b64_tr_b16 v[90:91], v12 offset:4096
    buffer_load_dwordx4 v[156:159], v9, s[44:47], s90 offen offset:1024 sc1
    s_add_u32 s90, s90, 0x20000
    v_add_u32 v13, 32768, v13
    s_waitcnt lgkmcnt(6)
    v_mfma_f32_16x16x32_bf16 v[64:67], v[108:111], v[160:163], v[64:67]
    ds_read_b64_tr_b16 v[92:93], v13 offset:0
    v_mfma_f32_16x16x32_bf16 v[68:71], v[108:111], v[164:167], v[68:71]
    ds_read_b64_tr_b16 v[94:95], v13 offset:4096
    v_add_u32 v14, 32768, v14
    s_waitcnt lgkmcnt(6)
    v_mfma_f32_16x16x32_bf16 v[72:75], v[112:115], v[160:163], v[72:75]
    ds_read_b64_tr_b16 v[96:97], v14 offset:0
    v_mfma_f32_16x16x32_bf16 v[76:79], v[112:115], v[164:167], v[76:79]
    ds_read_b64_tr_b16 v[98:99], v14 offset:4096
    s_add_u32 m0, s88, 131072
    s_nop 0
    buffer_load_dwordx4 v5, s[36:39], s68 offen lds
    v_add_u32 v15, 32768, v15
    s_waitcnt lgkmcnt(6)
    v_mfma_f32_16x16x32_bf16 v[80:83], v[116:119], v[160:163], v[80:83]
    ds_read_b64_tr_b16 v[100:101], v15 offset:0
    v_mfma_f32_16x16x32_bf16 v[84:87], v[116:119], v[164:167], v[84:87]
    ds_read_b64_tr_b16 v[102:103], v15 offset:4096
    v_add_u32 v16, 32768, v16
    s_waitcnt vmcnt(13) lgkmcnt(6)
    v_mfma_f32_16x16x32_bf16 v[24:27], v[88:91], v[120:123], v[24:27]
    ds_read_b64_tr_b16 v[104:105], v16 offset:0
    v_mfma_f32_16x16x32_bf16 v[28:31], v[88:91], v[124:127], v[28:31]
    ds_read_b64_tr_b16 v[106:107], v16 offset:4096
    v_add_u32 v17, 32768, v17
    s_waitcnt lgkmcnt(6)
    v_mfma_f32_16x16x32_bf16 v[32:35], v[92:95], v[120:123], v[32:35]
    ds_read_b64_tr_b16 v[108:109], v17 offset:0
    v_mfma_f32_16x16x32_bf16 v[36:39], v[92:95], v[124:127], v[36:39]
    ds_read_b64_tr_b16 v[110:111], v17 offset:4096
    buffer_load_dwordx4 v[160:163], v9, s[44:47], s90 offen offset:0 sc1
    v_add_u32 v18, 32768, v18
    s_waitcnt lgkmcnt(6)
    v_mfma_f32_16x16x32_bf16 v[40:43], v[96:99], v[120:123], v[40:43]
    ds_read_b64_tr_b16 v[112:113], v18 offset:0
    v_mfma_f32_16x16x32_bf16 v[44:47], v[96:99], v[124:127], v[44:47]
    ds_read_b64_tr_b16 v[114:115], v18 offset:4096
    s_add_u32 m0, s88, 132096
    s_nop 0
    buffer_load_dwordx4 v6, s[36:39], s68 offen lds
    v_add_u32 v19, 32768, v19
    s_waitcnt lgkmcnt(6)
    v_mfma_f32_16x16x32_bf16 v[48:51], v[100:103], v[120:123], v[48:51]
    ds_read_b64_tr_b16 v[116:117], v19 offset:0
    v_mfma_f32_16x16x32_bf16 v[52:55], v[100:103], v[124:127], v[52:55]
    ds_read_b64_tr_b16 v[118:119], v19 offset:4096
    s_waitcnt lgkmcnt(6)
    v_mfma_f32_16x16x32_bf16 v[56:59], v[104:107], v[120:123], v[56:59]
    ds_read_b64_tr_b16 v[88:89], v12 offset:8192
    v_mfma_f32_16x16x32_bf16 v[60:63], v[104:107], v[124:127], v[60:63]
    ds_read_b64_tr_b16 v[90:91], v12 offset:12288
    buffer_load_dwordx4 v[164:167], v9, s[44:47], s90 offen offset:1024 sc1
    s_add_u32 s90, s90, 0x20000
    s_waitcnt lgkmcnt(6)
    v_mfma_f32_16x16x32_bf16 v[64:67], v[108:111], v[120:123], v[64:67]
    ds_read_b64_tr_b16 v[92:93], v13 offset:8192
    v_mfma_f32_16x16x32_bf16 v[68:71], v[108:111], v[124:127], v[68:71]
    ds_read_b64_tr_b16 v[94:95], v13 offset:12288
    s_waitcnt lgkmcnt(6)
    v_mfma_f32_16x16x32_bf16 v[72:75], v[112:115], v[120:123], v[72:75]
    ds_read_b64_tr_b16 v[96:97], v14 offset:8192
    v_mfma_f32_16x16x32_bf16 v[76:79], v[112:115], v[124:127], v[76:79]
    ds_read_b64_tr_b16 v[98:99], v14 offset:12288
    s_add_u32 m0, s88, 133120
    s_nop 0
    buffer_load_dwordx4 v7, s[36:39], s68 offen lds
    s_waitcnt lgkmcnt(6)
    v_mfma_f32_16x16x32_bf16 v[80:83], v[116:119], v[120:123], v[80:83]
    ds_read_b64_tr_b16 v[100:101], v15 offset:8192
    v_mfma_f32_16x16x32_bf16 v[84:87], v[116:119], v[124:127], v[84:87]
    ds_read_b64_tr_b16 v[102:103], v15 offset:12288
    s_waitcnt vmcnt(13) lgkmcnt(6)
    v_mfma_f32_16x16x32_bf16 v[24:27], v[88:91], v[128:131], v[24:27]
    ds_read_b64_tr_b16 v[104:105], v16 offset:8192
    v_mfma_f32_16x16x32_bf16 v[28:31], v[88:91], v[132:135], v[28:31]
    ds_read_b64_tr_b16 v[106:107], v16 offset:12288
    s_waitcnt lgkmcnt(6)
    v_mfma_f32_16x16x32_bf16 v[32:35], v[92:95], v[128:131], v[32:35]
    ds_read_b64_tr_b16 v[108:109], v17 offset:8192
    v_mfma_f32_16x16x32_bf16 v[36:39], v[92:95], v[132:135], v[36:39]
    ds_read_b64_tr_b16 v[110:111], v17 offset:12288
    buffer_load_dwordx4 v[120:123], v9, s[44:47], s90 offen offset:0 sc1
    s_waitcnt lgkmcnt(6)
    v_mfma_f32_16x16x32_bf16 v[40:43], v[96:99], v[128:131], v[40:43]
    ds_read_b64_tr_b16 v[112:113], v18 offset:8192
    v_mfma_f32_16x16x32_bf16 v[44:47], v[96:99], v[132:135], v[44:47]
    ds_read_b64_tr_b16 v[114:115], v18 offset:12288
    s_add_u32 m0, s88, 134144
    s_nop 0
    buffer_load_dwordx4 v8, s[36:39], s68 offen lds
    s_add_u32 s68, s68, 0x40000
    s_waitcnt lgkmcnt(6)
    v_mfma_f32_16x16x32_bf16 v[48:51], v[100:103], v[128:131], v[48:51]
    ds_read_b64_tr_b16 v[116:117], v19 offset:8192
    v_mfma_f32_16x16x32_bf16 v[52:55], v[100:103], v[132:135], v[52:55]
    ds_read_b64_tr_b16 v[118:119], v19 offset:12288
    s_waitcnt lgkmcnt(6)
    v_mfma_f32_16x16x32_bf16 v[56:59], v[104:107], v[128:131], v[56:59]
    ds_read_b64_tr_b16 v[88:89], v12 offset:16384
    v_mfma_f32_16x16x32_bf16 v[60:63], v[104:107], v[132:135], v[60:63]
    ds_read_b64_tr_b16 v[90:91], v12 offset:20480
    buffer_load_dwordx4 v[124:127], v9, s[44:47], s90 offen offset:1024 sc1
    s_add_u32 s90, s90, 0x20000
    s_waitcnt lgkmcnt(6)
    v_mfma_f32_16x16x32_bf16 v[64:67], v[108:111], v[128:131], v[64:67]
    ds_read_b64_tr_b16 v[92:93], v13 offset:16384
    v_mfma_f32_16x16x32_bf16 v[68:71], v[108:111], v[132:135], v[68:71]
    ds_read_b64_tr_b16 v[94:95], v13 offset:20480
    s_waitcnt lgkmcnt(6)
    v_mfma_f32_16x16x32_bf16 v[72:75], v[112:115], v[128:131], v[72:75]
    ds_read_b64_tr_b16 v[96:97], v14 offset:16384
    v_mfma_f32_16x16x32_bf16 v[76:79], v[112:115], v[132:135], v[76:79]
    ds_read_b64_tr_b16 v[98:99], v14 offset:20480
    s_waitcnt lgkmcnt(6)
    v_mfma_f32_16x16x32_bf16 v[80:83], v[116:119], v[128:131], v[80:83]
    ds_read_b64_tr_b16 v[100:101], v15 offset:16384
    v_mfma_f32_16x16x32_bf16 v[84:87], v[116:119], v[132:135], v[84:87]
    ds_read_b64_tr_b16 v[102:103], v15 offset:20480
    s_waitcnt vmcnt(12) lgkmcnt(6)
    v_mfma_f32_16x16x32_bf16 v[24:27], v[88:91], v[136:139], v[24:27]
    ds_read_b64_tr_b16 v[104:105], v16 offset:16384
    v_mfma_f32_16x16x32_bf16 v[28:31], v[88:91], v[140:143], v[28:31]
    ds_read_b64_tr_b16 v[106:107], v16 offset:20480
    s_waitcnt lgkmcnt(6)
    v_mfma_f32_16x16x32_bf16 v[32:35], v[92:95], v[136:139], v[32:35]
    ds_read_b64_tr_b16 v[108:109], v17 offset:16384
    v_mfma_f32_16x16x32_bf16 v[36:39], v[92:95], v[140:143], v[36:39]
    ds_read_b64_tr_b16 v[110:111], v17 offset:20480
    buffer_load_dwordx4 v[128:131], v9, s[44:47], s90 offen offset:0 sc1
    s_waitcnt lgkmcnt(6)
    v_mfma_f32_16x16x32_bf16 v[40:43], v[96:99], v[136:139], v[40:43]
    ds_read_b64_tr_b16 v[112:113], v18 offset:16384
    v_mfma_f32_16x16x32_bf16 v[44:47], v[96:99], v[140:143], v[44:47]
    ds_read_b64_tr_b16 v[114:115], v18 offset:20480
    s_waitcnt lgkmcnt(6)
    v_mfma_f32_16x16x32_bf16 v[48:51], v[100:103], v[136:139], v[48:51]
    ds_read_b64_tr_b16 v[116:117], v19 offset:16384
    v_mfma_f32_16x16x32_bf16 v[52:55], v[100:103], v[140:143], v[52:55]
    ds_read_b64_tr_b16 v[118:119], v19 offset:20480
    s_cmp_lt_u32 s28, 4
    s_cbranch_scc1 L_skKY128
    s_waitcnt vmcnt(14)
    s_barrier
L_skKY128:
    s_waitcnt lgkmcnt(6)
    v_mfma_f32_16x16x32_bf16 v[56:59], v[104:107], v[136:139], v[56:59]
    ds_read_b64_tr_b16 v[88:89], v12 offset:24576
    v_mfma_f32_16x16x32_bf16 v[60:63], v[104:107], v[140:143], v[60:63]
    ds_read_b64_tr_b16 v[90:91], v12 offset:28672
    buffer_load_dwordx4 v[132:135], v9, s[44:47], s90 offen offset:1024 sc1
    s_add_u32 s90, s90, 0x20000
    s_waitcnt lgkmcnt(6)
    v_mfma_f32_16x16x32_bf16 v[64:67], v[108:111], v[136:139], v[64:67]
    ds_read_b64_tr_b16 v[92:93], v13 offset:24576
    v_mfma_f32_16x16x32_bf16 v[68:71], v[108:111], v[140:143], v[68:71]
    ds_read_b64_tr_b16 v[94:95], v13 offset:28672
    s_waitcnt lgkmcnt(6)
    v_mfma_f32_16x16x32_bf16 v[72:75], v[112:115], v[136:139], v[72:75]
    ds_read_b64_tr_b16 v[96:97], v14 offset:24576
    v_mfma_f32_16x16x32_bf16 v[76:79], v[112:115], v[140:143], v[76:79]
    ds_read_b64_tr_b16 v[98:99], v14 offset:28672
    s_waitcnt lgkmcnt(6)
    v_mfma_f32_16x16x32_bf16 v[80:83], v[116:119], v[136:139], v[80:83]
    ds_read_b64_tr_b16 v[100:101], v15 offset:24576
    v_mfma_f32_16x16x32_bf16 v[84:87], v[116:119], v[140:143], v[84:87]
    ds_read_b64_tr_b16 v[102:103], v15 offset:28672
    s_waitcnt vmcnt(12) lgkmcnt(6)
    v_mfma_f32_16x16x32_bf16 v[24:27], v[88:91], v[144:147], v[24:27]
    ds_read_b64_tr_b16 v[104:105], v16 offset:24576
    v_mfma_f32_16x16x32_bf16 v[28:31], v[88:91], v[148:151], v[28:31]
    ds_read_b64_tr_b16 v[106:107], v16 offset:28672
    s_waitcnt lgkmcnt(6)
    v_mfma_f32_16x16x32_bf16 v[32:35], v[92:95], v[144:147], v[32:35]
    ds_read_b64_tr_b16 v[108:109], v17 offset:24576
    v_mfma_f32_16x16x32_bf16 v[36:39], v[92:95], v[148:151], v[36:39]
    ds_read_b64_tr_b16 v[110:111], v17 offset:28672
    buffer_load_dwordx4 v[136:139], v9, s[44:47], s90 offen offset:0 sc1
    s_waitcnt lgkmcnt(6)
    v_mfma_f32_16x16x32_bf16 v[40:43], v[96:99], v[144:147], v[40:43]
    ds_read_b64_tr_b16 v[112:113], v18 offset:24576
    v_mfma_f32_16x16x32_bf16 v[44:47], v[96:99], v[148:151], v[44:47]
    ds_read_b64_tr_b16 v[114:115], v18 offset:28672
    s_waitcnt lgkmcnt(6)
    v_mfma_f32_16x16x32_bf16 v[48:51], v[100:103], v[144:147], v[48:51]
    ds_read_b64_tr_b16 v[116:117], v19 offset:24576
    v_mfma_f32_16x16x32_bf16 v[52:55], v[100:103], v[148:151], v[52:55]
    ds_read_b64_tr_b16 v[118:119], v19 offset:28672
    s_cmp_lt_u32 s28, 4
    s_cbranch_scc0 L_skKX128
    s_waitcnt vmcnt(16)
    s_barrier
L_skKX128:
    v_add_u32 v12, 32768, v12
    s_waitcnt lgkmcnt(6)
    v_mfma_f32_16x16x32_bf16 v[56:59], v[104:107], v[144:147], v[56:59]
    ds_read_b64_tr_b16 v[88:89], v12 offset:0
    v_mfma_f32_16x16x32_bf16 v[60:63], v[104:107], v[148:151], v[60:63]
    ds_read_b64_tr_b16 v[90:91], v12 offset:4096
    buffer_load_dwordx4 v[140:143], v9, s[44:47], s90 offen offset:1024 sc1
    s_add_u32 s90, s90, 0x20000
    v_add_u32 v13, 32768, v13
    s_waitcnt lgkmcnt(6)
    v_mfma_f32_16x16x32_bf16 v[64:67], v[108:111], v[144:147], v[64:67]
    ds_read_b64_tr_b16 v[92:93], v13 offset:0
    v_mfma_f32_16x16x32_bf16 v[68:71], v[108:111], v[148:151], v[68:71]
    ds_read_b64_tr_b16 v[94:95], v13 offset:4096
    v_add_u32 v14, 32768, v14
    s_waitcnt lgkmcnt(6)
    v_mfma_f32_16x16x32_bf16 v[72:75], v[112:115], v[144:147], v[72:75]
    ds_read_b64_tr_b16 v[96:97], v14 offset:0
    v_mfma_f32_16x16x32_bf16 v[76:79], v[112:115], v[148:151], v[76:79]
    ds_read_b64_tr_b16 v[98:99], v14 offset:4096
    s_add_u32 m0, s88, 32768
    s_nop 0
    buffer_load_dwordx4 v5, s[36:39], s68 offen lds
    v_add_u32 v15, 32768, v15
    s_waitcnt lgkmcnt(6)
    v_mfma_f32_16x16x32_bf16 v[80:83], v[116:119], v[144:147], v[80:83]
    ds_read_b64_tr_b16 v[100:101], v15 offset:0
    v_mfma_f32_16x16x32_bf16 v[84:87], v[116:119], v[148:151], v[84:87]
    ds_read_b64_tr_b16 v[102:103], v15 offset:4096
    v_add_u32 v16, 32768, v16
    s_waitcnt vmcnt(13) lgkmcnt(6)
    v_mfma_f32_16x16x32_bf16 v[24:27], v[88:91], v[152:155], v[24:27]
    ds_read_b64_tr_b16 v[104:105], v16 offset:0
    v_mfma_f32_16x16x32_bf16 v[28:31], v[88:91], v[156:159], v[28:31]
    ds_read_b64_tr_b16 v[106:107], v16 offset:4096
    v_add_u32 v17, 32768, v17
    s_waitcnt lgkmcnt(6)
    v_mfma_f32_16x16x32_bf16 v[32:35], v[92:95], v[152:155], v[32:35]
    ds_read_b64_tr_b16 v[108:109], v17 offset:0
    v_mfma_f32_16x16x32_bf16 v[36:39], v[92:95], v[156:159], v[36:39]
    ds_read_b64_tr_b16 v[110:111], v17 offset:4096
    buffer_load_dwordx4 v[144:147], v9, s[44:47], s90 offen offset:0 sc1
    v_add_u32 v18, 32768, v18
    s_waitcnt lgkmcnt(6)
    v_mfma_f32_16x16x32_bf16 v[40:43], v[96:99], v[152:155], v[40:43]
    ds_read_b64_tr_b16 v[112:113], v18 offset:0
    v_mfma_f32_16x16x32_bf16 v[44:47], v[96:99], v[156:159], v[44:47]
    ds_read_b64_tr_b16 v[114:115], v18 offset:4096
    s_add_u32 m0, s88, 33792
    s_nop 0
    buffer_load_dwordx4 v6, s[36:39], s68 offen lds
    v_add_u32 v19, 32768, v19
    s_waitcnt lgkmcnt(6)
    v_mfma_f32_16x16x32_bf16 v[48:51], v[100:103], v[152:155], v[48:51]
    ds_read_b64_tr_b16 v[116:117], v19 offset:0
    v_mfma_f32_16x16x32_bf16 v[52:55], v[100:103], v[156:159], v[52:55]
    ds_read_b64_tr_b16 v[118:119], v19 offset:4096
    s_waitcnt lgkmcnt(6)
    v_mfma_f32_16x16x32_bf16 v[56:59], v[104:107], v[152:155], v[56:59]
    ds_read_b64_tr_b16 v[88:89], v12 offset:8192
    v_mfma_f32_16x16x32_bf16 v[60:63], v[104:107], v[156:159], v[60:63]
    ds_read_b64_tr_b16 v[90:91], v12 offset:12288
    buffer_load_dwordx4 v[148:151], v9, s[44:47], s90 offen offset:1024 sc1
    s_add_u32 s90, s90, 0x20000
    s_waitcnt lgkmcnt(6)
    v_mfma_f32_16x16x32_bf16 v[64:67], v[108:111], v[152:155], v[64:67]
    ds_read_b64_tr_b16 v[92:93], v13 offset:8192
    v_mfma_f32_16x16x32_bf16 v[68:71], v[108:111], v[156:159], v[68:71]
    ds_read_b64_tr_b16 v[94:95], v13 offset:12288
    s_waitcnt lgkmcnt(6)
    v_mfma_f32_16x16x32_bf16 v[72:75], v[112:115], v[152:155], v[72:75]
    ds_read_b64_tr_b16 v[96:97], v14 offset:8192
    v_mfma_f32_16x16x32_bf16 v[76:79], v[112:115], v[156:159], v[76:79]
    ds_read_b64_tr_b16 v[98:99], v14 offset:12288
    s_add_u32 m0, s88, 34816
    s_nop 0
    buffer_load_dwordx4 v7, s[36:39], s68 offen lds
    s_waitcnt lgkmcnt(6)
    v_mfma_f32_16x16x32_bf16 v[80:83], v[116:119], v[152:155], v[80:83]
    ds_read_b64_tr_b16 v[100:101], v15 offset:8192
    v_mfma_f32_16x16x32_bf16 v[84:87], v[116:119], v[156:159], v[84:87]
    ds_read_b64_tr_b16 v[102:103], v15 offset:12288
    s_waitcnt vmcnt(13) lgkmcnt(6)
    v_mfma_f32_16x16x32_bf16 v[24:27], v[88:91], v[160:163], v[24:27]
    ds_read_b64_tr_b16 v[104:105], v16 offset:8192
    v_mfma_f32_16x16x32_bf16 v[28:31], v[88:91], v[164:167], v[28:31]
    ds_read_b64_tr_b16 v[106:107], v16 offset:12288
    s_waitcnt lgkmcnt(6)
    v_mfma_f32_16x16x32_bf16 v[32:35], v[92:95], v[160:163], v[32:35]
    ds_read_b64_tr_b16 v[108:109], v17 offset:8192
    v_mfma_f32_16x16x32_bf16 v[36:39], v[92:95], v[164:167], v[36:39]
    ds_read_b64_tr_b16 v[110:111], v17 offset:12288
    buffer_load_dwordx4 v[152:155], v9, s[44:47], s90 offen offset:0 sc1
    s_waitcnt lgkmcnt(6)
    v_mfma_f32_16x16x32_bf16 v[40:43], v[96:99], v[160:163], v[40:43]
    ds_read_b64_tr_b16 v[112:113], v18 offset:8192
    v_mfma_f32_16x16x32_bf16 v[44:47], v[96:99], v[164:167], v[44:47]
    ds_read_b64_tr_b16 v[114:115], v18 offset:12288
    s_add_u32 m0, s88, 35840
    s_nop 0
    buffer_load_dwordx4 v8, s[36:39], s68 offen lds
    s_add_u32 s68, s68, 0x40000
    s_waitcnt lgkmcnt(6)
    v_mfma_f32_16x16x32_bf16 v[48:51], v[100:103], v[160:163], v[48:51]
    ds_read_b64_tr_b16 v[116:117], v19 offset:8192
    v_mfma_f32_16x16x32_bf16 v[52:55], v[100:103], v[164:167], v[52:55]
    ds_read_b64_tr_b16 v[118:119], v19 offset:12288
    s_waitcnt lgkmcnt(6)
    v_mfma_f32_16x16x32_bf16 v[56:59], v[104:107], v[160:163], v[56:59]
    ds_read_b64_tr_b16 v[88:89], v12 offset:16384
    v_mfma_f32_16x16x32_bf16 v[60:63], v[104:107], v[164:167], v[60:63]
    ds_read_b64_tr_b16 v[90:91], v12 offset:20480
    buffer_load_dwordx4 v[156:159], v9, s[44:47], s90 offen offset:1024 sc1
    s_add_u32 s90, s90, 0x20000
    s_waitcnt lgkmcnt(6)
    v_mfma_f32_16x16x32_bf16 v[64:67], v[108:111], v[160:163], v[64:67]
    ds_read_b64_tr_b16 v[92:93], v13 offset:16384
    v_mfma_f32_16x16x32_bf16 v[68:71], v[108:111], v[164:167], v[68:71]
    ds_read_b64_tr_b16 v[94:95], v13 offset:20480
    s_waitcnt lgkmcnt(6)
    v_mfma_f32_16x16x32_bf16 v[72:75], v[112:115], v[160:163], v[72:75]
    ds_read_b64_tr_b16 v[96:97], v14 offset:16384
    v_mfma_f32_16x16x32_bf16 v[76:79], v[112:115], v[164:167], v[76:79]
    ds_read_b64_tr_b16 v[98:99], v14 offset:20480
    s_waitcnt lgkmcnt(6)
    v_mfma_f32_16x16x32_bf16 v[80:83], v[116:119], v[160:163], v[80:83]
    ds_read_b64_tr_b16 v[100:101], v15 offset:16384
    v_mfma_f32_16x16x32_bf16 v[84:87], v[116:119], v[164:167], v[84:87]
    ds_read_b64_tr_b16 v[102:103], v15 offset:20480
    s_waitcnt vmcnt(12) lgkmcnt(6)
    v_mfma_f32_16x16x32_bf16 v[24:27], v[88:91], v[120:123], v[24:27]
    ds_read_b64_tr_b16 v[104:105], v16 offset:16384
    v_mfma_f32_16x16x32_bf16 v[28:31], v[88:91], v[124:127], v[28:31]
    ds_read_b64_tr_b16 v[106:107], v16 offset:20480
    s_waitcnt lgkmcnt(6)
    v_mfma_f32_16x16x32_bf16 v[32:35], v[92:95], v[120:123], v[32:35]
    ds_read_b64_tr_b16 v[108:109], v17 offset:16384
    v_mfma_f32_16x16x32_bf16 v[36:39], v[92:95], v[124:127], v[36:39]
    ds_read_b64_tr_b16 v[110:111], v17 offset:20480
    buffer_load_dwordx4 v[160:163], v9, s[44:47], s90 offen offset:0 sc1
    s_waitcnt lgkmcnt(6)
    v_mfma_f32_16x16x32_bf16 v[40:43], v[96:99], v[120:123], v[40:43]
    ds_read_b64_tr_b16 v[112:113], v18 offset:16384
    v_mfma_f32_16x16x32_bf16 v[44:47], v[96:99], v[124:127], v[44:47]
    ds_read_b64_tr_b16 v[114:115], v18 offset:20480
    s_waitcnt lgkmcnt(6)
    v_mfma_f32_16x16x32_bf16 v[48:51], v[100:103], v[120:123], v[48:51]
    ds_read_b64_tr_b16 v[116:117], v19 offset:16384
    v_mfma_f32_16x16x32_bf16 v[52:55], v[100:103], v[124:127], v[52:55]
    ds_read_b64_tr_b16 v[118:119], v19 offset:20480
    s_cmp_lt_u32 s28, 4
    s_cbranch_scc1 L_skKY160
    s_waitcnt vmcnt(14)
    s_barrier
L_skKY160:
    s_waitcnt lgkmcnt(6)
    v_mfma_f32_16x16x32_bf16 v[56:59], v[104:107], v[120:123], v[56:59]
    ds_read_b64_tr_b16 v[88:89], v12 offset:24576
    v_mfma_f32_16x16x32_bf16 v[60:63], v[104:107], v[124:127], v[60:63]
    ds_read_b64_tr_b16 v[90:91], v12 offset:28672
    buffer_load_dwordx4 v[164:167], v9, s[44:47], s90 offen offset:1024 sc1
    s_add_u32 s90, s90, 0x20000
    s_waitcnt lgkmcnt(6)
    v_mfma_f32_16x16x32_bf16 v[64:67], v[108:111], v[120:123], v[64:67]
    ds_read_b64_tr_b16 v[92:93], v13 offset:24576
    v_mfma_f32_16x16x32_bf16 v[68:71], v[108:111], v[124:127], v[68:71]
    ds_read_b64_tr_b16 v[94:95], v13 offset:28672
    s_waitcnt lgkmcnt(6)
    v_mfma_f32_16x16x32_bf16 v[72:75], v[112:115], v[120:123], v[72:75]
    ds_read_b64_tr_b16 v[96:97], v14 offset:24576
    v_mfma_f32_16x16x32_bf16 v[76:79], v[112:115], v[124:127], v[76:79]
    ds_read_b64_tr_b16 v[98:99], v14 offset:28672
    s_mov_b32 s52, s4
    s_mov_b32 s53, s5
    s_mov_b32 s54, 4194304
    s_mov_b32 s55, 0x00020000
    s_mov_b32 s72, s18
    s_mov_b32 s73, s19
    s_mov_b32 s74, 2048
    s_mov_b32 s75, 0x00020000
    s_lshl_b32 s31, s89, 5
    s_lshl_b32 s95, s64, 6
    s_add_u32 s95, s95, s67
    s_add_u32 s31, s31, s95
    v_and_b32 v246, 1, v4
    v_lshlrev_b32 v246, 5, v246
    v_lshrrev_b32 v248, 1, v4
    v_lshl_add_u32 v248, v248, 4, v246
    v_lshl_add_u32 v246, v3, 11, v248
    v_add_u32 v246, s31, v246
    v_add_u32 v247, 0x8000, v246
    s_lshr_b32 s96, s89, 2
    s_add_u32 s96, s96, 37748736
    v_lshlrev_b32 v249, 4, v3
    s_lshl_b32 s31, s26, 3
    s_and_b32 s32, s27, 7
    s_add_u32 s31, s31, s32
    s_mul_i32 s31, s31, 196608
    s_lshl_b32 s32, s28, 11
    s_add_u32 s31, s31, s32
    s_add_u32 s31, s31, 41943040
    s_mov_b32 s92, s31
    s_mul_i32 s94, s64, 49152
    s_add_u32 s94, s94, s31
    buffer_load_dwordx4 v[232:235], v246, s[52:55], 0 offen
    s_waitcnt lgkmcnt(6)
    v_mfma_f32_16x16x32_bf16 v[80:83], v[116:119], v[120:123], v[80:83]
    ds_read_b64_tr_b16 v[100:101], v15 offset:24576
    v_mfma_f32_16x16x32_bf16 v[84:87], v[116:119], v[124:127], v[84:87]
    ds_read_b64_tr_b16 v[102:103], v15 offset:28672
    buffer_load_dwordx4 v[236:239], v247, s[52:55], 0 offen
    buffer_load_dwordx4 v[240:243], v248, s[72:75], s95 offen
    s_waitcnt vmcnt(15) lgkmcnt(6)
    v_mfma_f32_16x16x32_bf16 v[24:27], v[88:91], v[128:131], v[24:27]
    ds_read_b64_tr_b16 v[104:105], v16 offset:24576
    v_mfma_f32_16x16x32_bf16 v[28:31], v[88:91], v[132:135], v[28:31]
    ds_read_b64_tr_b16 v[106:107], v16 offset:28672
    buffer_load_dword v244, v249, s[56:59], s96 offen offset:8 sc1
    buffer_load_dword v245, v249, s[56:59], s96 offen offset:264 sc1
    s_waitcnt lgkmcnt(6)
    v_mfma_f32_16x16x32_bf16 v[32:35], v[92:95], v[128:131], v[32:35]
    ds_read_b64_tr_b16 v[108:109], v17 offset:24576
    v_mfma_f32_16x16x32_bf16 v[36:39], v[92:95], v[132:135], v[36:39]
    ds_read_b64_tr_b16 v[110:111], v17 offset:28672
    buffer_load_dwordx4 v[120:123], v9, s[44:47], s90 offen offset:0 sc1
    s_waitcnt lgkmcnt(6)
    v_mfma_f32_16x16x32_bf16 v[40:43], v[96:99], v[128:131], v[40:43]
    ds_read_b64_tr_b16 v[112:113], v18 offset:24576
    v_mfma_f32_16x16x32_bf16 v[44:47], v[96:99], v[132:135], v[44:47]
    ds_read_b64_tr_b16 v[114:115], v18 offset:28672
    s_waitcnt lgkmcnt(6)
    v_mfma_f32_16x16x32_bf16 v[48:51], v[100:103], v[128:131], v[48:51]
    ds_read_b64_tr_b16 v[116:117], v19 offset:24576
    v_mfma_f32_16x16x32_bf16 v[52:55], v[100:103], v[132:135], v[52:55]
    ds_read_b64_tr_b16 v[118:119], v19 offset:28672
    s_cmp_lt_u32 s28, 4
    s_cbranch_scc0 L_skKX160
    s_waitcnt vmcnt(21)
    s_barrier
L_skKX160:
    v_add_u32 v12, 32768, v12
    s_waitcnt lgkmcnt(6)
    v_mfma_f32_16x16x32_bf16 v[56:59], v[104:107], v[128:131], v[56:59]
    ds_read_b64_tr_b16 v[88:89], v12 offset:0
    v_mfma_f32_16x16x32_bf16 v[60:63], v[104:107], v[132:135], v[60:63]
    ds_read_b64_tr_b16 v[90:91], v12 offset:4096
    buffer_load_dwordx4 v[124:127], v9, s[44:47], s90 offen offset:1024 sc1
    s_add_u32 s90, s90, 0x20000
    v_add_u32 v13, 32768, v13
    s_waitcnt lgkmcnt(6)
    v_mfma_f32_16x16x32_bf16 v[64:67], v[108:111], v[128:131], v[64:67]
    ds_read_b64_tr_b16 v[92:93], v13 offset:0
    v_mfma_f32_16x16x32_bf16 v[68:71], v[108:111], v[132:135], v[68:71]
    ds_read_b64_tr_b16 v[94:95], v13 offset:4096
    v_add_u32 v14, 32768, v14
    s_waitcnt lgkmcnt(6)
    v_mfma_f32_16x16x32_bf16 v[72:75], v[112:115], v[128:131], v[72:75]
    ds_read_b64_tr_b16 v[96:97], v14 offset:0
    v_mfma_f32_16x16x32_bf16 v[76:79], v[112:115], v[132:135], v[76:79]
    ds_read_b64_tr_b16 v[98:99], v14 offset:4096
    s_add_u32 m0, s88, 65536
    s_nop 0
    buffer_load_dwordx4 v5, s[48:51], s69 offen lds
    v_add_u32 v15, 32768, v15
    s_waitcnt lgkmcnt(6)
    v_mfma_f32_16x16x32_bf16 v[80:83], v[116:119], v[128:131], v[80:83]
    ds_read_b64_tr_b16 v[100:101], v15 offset:0
    v_mfma_f32_16x16x32_bf16 v[84:87], v[116:119], v[132:135], v[84:87]
    ds_read_b64_tr_b16 v[102:103], v15 offset:4096
    v_add_u32 v16, 32768, v16
    s_waitcnt vmcnt(18) lgkmcnt(6)
    v_mfma_f32_16x16x32_bf16 v[24:27], v[88:91], v[136:139], v[24:27]
    ds_read_b64_tr_b16 v[104:105], v16 offset:0
    v_mfma_f32_16x16x32_bf16 v[28:31], v[88:91], v[140:143], v[28:31]
    ds_read_b64_tr_b16 v[106:107], v16 offset:4096
    v_add_u32 v17, 32768, v17
    s_waitcnt lgkmcnt(6)
    v_mfma_f32_16x16x32_bf16 v[32:35], v[92:95], v[136:139], v[32:35]
    ds_read_b64_tr_b16 v[108:109], v17 offset:0
    v_mfma_f32_16x16x32_bf16 v[36:39], v[92:95], v[140:143], v[36:39]
    ds_read_b64_tr_b16 v[110:111], v17 offset:4096
    buffer_load_dwordx4 v[128:131], v9, s[44:47], s90 offen offset:0 sc1
    v_add_u32 v18, 32768, v18
    s_waitcnt lgkmcnt(6)
    v_mfma_f32_16x16x32_bf16 v[40:43], v[96:99], v[136:139], v[40:43]
    ds_read_b64_tr_b16 v[112:113], v18 offset:0
    v_mfma_f32_16x16x32_bf16 v[44:47], v[96:99], v[140:143], v[44:47]
    ds_read_b64_tr_b16 v[114:115], v18 offset:4096
    s_add_u32 m0, s88, 66560
    s_nop 0
    buffer_load_dwordx4 v6, s[48:51], s69 offen lds
    v_add_u32 v19, 32768, v19
    s_waitcnt lgkmcnt(6)
    v_mfma_f32_16x16x32_bf16 v[48:51], v[100:103], v[136:139], v[48:51]
    ds_read_b64_tr_b16 v[116:117], v19 offset:0
    v_mfma_f32_16x16x32_bf16 v[52:55], v[100:103], v[140:143], v[52:55]
    ds_read_b64_tr_b16 v[118:119], v19 offset:4096
    s_waitcnt lgkmcnt(6)
    v_mfma_f32_16x16x32_bf16 v[56:59], v[104:107], v[136:139], v[56:59]
    ds_read_b64_tr_b16 v[88:89], v12 offset:8192
    v_mfma_f32_16x16x32_bf16 v[60:63], v[104:107], v[140:143], v[60:63]
    ds_read_b64_tr_b16 v[90:91], v12 offset:12288
    buffer_load_dwordx4 v[132:135], v9, s[44:47], s90 offen offset:1024 sc1
    s_add_u32 s90, s90, 0x20000
    s_waitcnt lgkmcnt(6)
    v_mfma_f32_16x16x32_bf16 v[64:67], v[108:111], v[136:139], v[64:67]
    ds_read_b64_tr_b16 v[92:93], v13 offset:8192
    v_mfma_f32_16x16x32_bf16 v[68:71], v[108:111], v[140:143], v[68:71]
    ds_read_b64_tr_b16 v[94:95], v13 offset:12288
    s_waitcnt lgkmcnt(6)
    v_mfma_f32_16x16x32_bf16 v[72:75], v[112:115], v[136:139], v[72:75]
    ds_read_b64_tr_b16 v[96:97], v14 offset:8192
    v_mfma_f32_16x16x32_bf16 v[76:79], v[112:115], v[140:143], v[76:79]
    ds_read_b64_tr_b16 v[98:99], v14 offset:12288
    s_add_u32 m0, s88, 67584
    s_nop 0
    buffer_load_dwordx4 v7, s[48:51], s69 offen lds
    s_waitcnt lgkmcnt(6)
    v_mfma_f32_16x16x32_bf16 v[80:83], v[116:119], v[136:139], v[80:83]
    ds_read_b64_tr_b16 v[100:101], v15 offset:8192
    v_mfma_f32_16x16x32_bf16 v[84:87], v[116:119], v[140:143], v[84:87]
    ds_read_b64_tr_b16 v[102:103], v15 offset:12288
    s_waitcnt vmcnt(18) lgkmcnt(6)
    v_mfma_f32_16x16x32_bf16 v[24:27], v[88:91], v[144:147], v[24:27]
    ds_read_b64_tr_b16 v[104:105], v16 offset:8192
    v_mfma_f32_16x16x32_bf16 v[28:31], v[88:91], v[148:151], v[28:31]
    ds_read_b64_tr_b16 v[106:107], v16 offset:12288
    s_waitcnt lgkmcnt(6)
    v_mfma_f32_16x16x32_bf16 v[32:35], v[92:95], v[144:147], v[32:35]
    ds_read_b64_tr_b16 v[108:109], v17 offset:8192
    v_mfma_f32_16x16x32_bf16 v[36:39], v[92:95], v[148:151], v[36:39]
    ds_read_b64_tr_b16 v[110:111], v17 offset:12288
    buffer_load_dwordx4 v[136:139], v9, s[44:47], s90 offen offset:0 sc1
    s_waitcnt lgkmcnt(6)
    v_mfma_f32_16x16x32_bf16 v[40:43], v[96:99], v[144:147], v[40:43]
    ds_read_b64_tr_b16 v[112:113], v18 offset:8192
    v_mfma_f32_16x16x32_bf16 v[44:47], v[96:99], v[148:151], v[44:47]
    ds_read_b64_tr_b16 v[114:115], v18 offset:12288
    s_add_u32 m0, s88, 68608
    s_nop 0
    buffer_load_dwordx4 v8, s[48:51], s69 offen lds
    s_add_u32 s69, s69, 0x40000
    s_waitcnt lgkmcnt(6)
    v_mfma_f32_16x16x32_bf16 v[48:51], v[100:103], v[144:147], v[48:51]
    ds_read_b64_tr_b16 v[116:117], v19 offset:8192
    v_mfma_f32_16x16x32_bf16 v[52:55], v[100:103], v[148:151], v[52:55]
    ds_read_b64_tr_b16 v[118:119], v19 offset:12288
    s_waitcnt lgkmcnt(6)
    v_mfma_f32_16x16x32_bf16 v[56:59], v[104:107], v[144:147], v[56:59]
    ds_read_b64_tr_b16 v[88:89], v12 offset:16384
    v_mfma_f32_16x16x32_bf16 v[60:63], v[104:107], v[148:151], v[60:63]
    ds_read_b64_tr_b16 v[90:91], v12 offset:20480
    buffer_load_dwordx4 v[140:143], v9, s[44:47], s90 offen offset:1024 sc1
    s_add_u32 s90, s90, 0x20000
    s_waitcnt lgkmcnt(6)
    v_mfma_f32_16x16x32_bf16 v[64:67], v[108:111], v[144:147], v[64:67]
    ds_read_b64_tr_b16 v[92:93], v13 offset:16384
    v_mfma_f32_16x16x32_bf16 v[68:71], v[108:111], v[148:151], v[68:71]
    ds_read_b64_tr_b16 v[94:95], v13 offset:20480
    s_waitcnt lgkmcnt(6)
    v_mfma_f32_16x16x32_bf16 v[72:75], v[112:115], v[144:147], v[72:75]
    ds_read_b64_tr_b16 v[96:97], v14 offset:16384
    v_mfma_f32_16x16x32_bf16 v[76:79], v[112:115], v[148:151], v[76:79]
    ds_read_b64_tr_b16 v[98:99], v14 offset:20480
    s_waitcnt lgkmcnt(6)
    v_mfma_f32_16x16x32_bf16 v[80:83], v[116:119], v[144:147], v[80:83]
    ds_read_b64_tr_b16 v[100:101], v15 offset:16384
    v_mfma_f32_16x16x32_bf16 v[84:87], v[116:119], v[148:151], v[84:87]
    ds_read_b64_tr_b16 v[102:103], v15 offset:20480
    s_waitcnt vmcnt(17) lgkmcnt(6)
    v_mfma_f32_16x16x32_bf16 v[24:27], v[88:91], v[152:155], v[24:27]
    ds_read_b64_tr_b16 v[104:105], v16 offset:16384
    v_mfma_f32_16x16x32_bf16 v[28:31], v[88:91], v[156:159], v[28:31]
    ds_read_b64_tr_b16 v[106:107], v16 offset:20480
    v_and_b32 v10, 12, v10
    buffer_load_dword v22, v10, s[56:59], s87 offen offset:32 sc1
    s_waitcnt lgkmcnt(6)
    v_mfma_f32_16x16x32_bf16 v[32:35], v[92:95], v[152:155], v[32:35]
    ds_read_b64_tr_b16 v[108:109], v17 offset:16384
    v_mfma_f32_16x16x32_bf16 v[36:39], v[92:95], v[156:159], v[36:39]
    ds_read_b64_tr_b16 v[110:111], v17 offset:20480
    buffer_load_dwordx4 v[144:147], v9, s[44:47], s90 offen offset:0 sc1
    s_waitcnt lgkmcnt(6)
    v_mfma_f32_16x16x32_bf16 v[40:43], v[96:99], v[152:155], v[40:43]
    ds_read_b64_tr_b16 v[112:113], v18 offset:16384
    v_mfma_f32_16x16x32_bf16 v[44:47], v[96:99], v[156:159], v[44:47]
    ds_read_b64_tr_b16 v[114:115], v18 offset:20480
    s_waitcnt lgkmcnt(6)
    v_mfma_f32_16x16x32_bf16 v[48:51], v[100:103], v[152:155], v[48:51]
    ds_read_b64_tr_b16 v[116:117], v19 offset:16384
    v_mfma_f32_16x16x32_bf16 v[52:55], v[100:103], v[156:159], v[52:55]
    ds_read_b64_tr_b16 v[118:119], v19 offset:20480
    s_cmp_lt_u32 s28, 4
    s_cbranch_scc1 L_skKY192
    s_waitcnt vmcnt(20)
    s_barrier
L_skKY192:
    s_waitcnt lgkmcnt(6)
    v_mfma_f32_16x16x32_bf16 v[56:59], v[104:107], v[152:155], v[56:59]
    ds_read_b64_tr_b16 v[88:89], v12 offset:24576
    v_mfma_f32_16x16x32_bf16 v[60:63], v[104:107], v[156:159], v[60:63]
    ds_read_b64_tr_b16 v[90:91], v12 offset:28672
    buffer_load_dwordx4 v[148:151], v9, s[44:47], s90 offen offset:1024 sc1
    s_add_u32 s90, s90, 0x20000
    s_waitcnt lgkmcnt(6)
    v_mfma_f32_16x16x32_bf16 v[64:67], v[108:111], v[152:155], v[64:67]
    ds_read_b64_tr_b16 v[92:93], v13 offset:24576
    v_mfma_f32_16x16x32_bf16 v[68:71], v[108:111], v[156:159], v[68:71]
    ds_read_b64_tr_b16 v[94:95], v13 offset:28672
    s_waitcnt lgkmcnt(6)
    v_mfma_f32_16x16x32_bf16 v[72:75], v[112:115], v[152:155], v[72:75]
    ds_read_b64_tr_b16 v[96:97], v14 offset:24576
    v_mfma_f32_16x16x32_bf16 v[76:79], v[112:115], v[156:159], v[76:79]
    ds_read_b64_tr_b16 v[98:99], v14 offset:28672
    s_waitcnt lgkmcnt(6)
    v_mfma_f32_16x16x32_bf16 v[80:83], v[116:119], v[152:155], v[80:83]
    ds_read_b64_tr_b16 v[100:101], v15 offset:24576
    v_mfma_f32_16x16x32_bf16 v[84:87], v[116:119], v[156:159], v[84:87]
    ds_read_b64_tr_b16 v[102:103], v15 offset:28672
    s_waitcnt vmcnt(18) lgkmcnt(6)
    v_mfma_f32_16x16x32_bf16 v[24:27], v[88:91], v[160:163], v[24:27]
    ds_read_b64_tr_b16 v[104:105], v16 offset:24576
    v_mfma_f32_16x16x32_bf16 v[28:31], v[88:91], v[164:167], v[28:31]
    ds_read_b64_tr_b16 v[106:107], v16 offset:28672
    s_waitcnt lgkmcnt(6)
    v_mfma_f32_16x16x32_bf16 v[32:35], v[92:95], v[160:163], v[32:35]
    ds_read_b64_tr_b16 v[108:109], v17 offset:24576
    v_mfma_f32_16x16x32_bf16 v[36:39], v[92:95], v[164:167], v[36:39]
    ds_read_b64_tr_b16 v[110:111], v17 offset:28672
    s_waitcnt lgkmcnt(6)
    v_mfma_f32_16x16x32_bf16 v[40:43], v[96:99], v[160:163], v[40:43]
    ds_read_b64_tr_b16 v[112:113], v18 offset:24576
    v_mfma_f32_16x16x32_bf16 v[44:47], v[96:99], v[164:167], v[44:47]
    ds_read_b64_tr_b16 v[114:115], v18 offset:28672
    s_waitcnt lgkmcnt(6)
    v_mfma_f32_16x16x32_bf16 v[48:51], v[100:103], v[160:163], v[48:51]
    ds_read_b64_tr_b16 v[116:117], v19 offset:24576
    v_mfma_f32_16x16x32_bf16 v[52:55], v[100:103], v[164:167], v[52:55]
    ds_read_b64_tr_b16 v[118:119], v19 offset:28672
    s_cmp_lt_u32 s28, 4
    s_cbranch_scc0 L_skKX192
    s_waitcnt vmcnt(21)
    s_barrier
L_skKX192:
    v_add_u32 v12, 4294868992, v12
    s_waitcnt lgkmcnt(6)
    v_mfma_f32_16x16x32_bf16 v[56:59], v[104:107], v[160:163], v[56:59]
    ds_read_b64_tr_b16 v[88:89], v12 offset:0
    v_mfma_f32_16x16x32_bf16 v[60:63], v[104:107], v[164:167], v[60:63]
    ds_read_b64_tr_b16 v[90:91], v12 offset:4096
    s_add_u32 m0, s88, 98304
    s_nop 0
    buffer_load_dwordx4 v5, s[48:51], s69 offen lds
    v_add_u32 v13, 4294868992, v13
    s_waitcnt lgkmcnt(6)
    v_mfma_f32_16x16x32_bf16 v[64:67], v[108:111], v[160:163], v[64:67]
    ds_read_b64_tr_b16 v[92:93], v13 offset:0
    v_mfma_f32_16x16x32_bf16 v[68:71], v[108:111], v[164:167], v[68:71]
    ds_read_b64_tr_b16 v[94:95], v13 offset:4096
    s_add_u32 m0, s88, 99328
    s_nop 0
    buffer_load_dwordx4 v6, s[48:51], s69 offen lds
    v_add_u32 v14, 4294868992, v14
    s_waitcnt lgkmcnt(6)
    v_mfma_f32_16x16x32_bf16 v[72:75], v[112:115], v[160:163], v[72:75]
    ds_read_b64_tr_b16 v[96:97], v14 offset:0
    v_mfma_f32_16x16x32_bf16 v[76:79], v[112:115], v[164:167], v[76:79]
    ds_read_b64_tr_b16 v[98:99], v14 offset:4096
    s_add_u32 m0, s88, 100352
    s_nop 0
    buffer_load_dwordx4 v7, s[48:51], s69 offen lds
    v_add_u32 v15, 4294868992, v15
    s_waitcnt lgkmcnt(6)
    v_mfma_f32_16x16x32_bf16 v[80:83], v[116:119], v[160:163], v[80:83]
    ds_read_b64_tr_b16 v[100:101], v15 offset:0
    v_mfma_f32_16x16x32_bf16 v[84:87], v[116:119], v[164:167], v[84:87]
    ds_read_b64_tr_b16 v[102:103], v15 offset:4096
    s_add_u32 m0, s88, 101376
    s_nop 0
    buffer_load_dwordx4 v8, s[48:51], s69 offen lds
    s_add_u32 s69, s69, 0x40000
    s_waitcnt vmcnt(6)
    v_cmp_eq_u32 vcc, 0, v22
    s_mov_b32 s34, 0
    s_cbranch_vccz L_go2K
L_poll2K:
    buffer_load_dword v22, v10, s[56:59], s87 offen offset:32 sc1
    s_add_u32 s34, s34, 1
    s_waitcnt vmcnt(0)
    v_cmp_eq_u32 vcc, 0, v22
    s_cmp_gt_u32 s34, 200000
    s_cbranch_scc1 L_go2K
    s_cbranch_vccnz L_poll2K
L_go2K:
    v_add_u32 v16, 4294868992, v16
    s_waitcnt vmcnt(15) lgkmcnt(6)
    v_mfma_f32_16x16x32_bf16 v[24:27], v[88:91], v[120:123], v[24:27]
    ds_read_b64_tr_b16 v[104:105], v16 offset:0
    v_mfma_f32_16x16x32_bf16 v[28:31], v[88:91], v[124:127], v[28:31]
    ds_read_b64_tr_b16 v[106:107], v16 offset:4096
    buffer_load_dwordx4 v[168:171], v9, s[44:47], s91 offen offset:0 sc1
    v_add_u32 v17, 4294868992, v17
    s_waitcnt lgkmcnt(6)
    v_mfma_f32_16x16x32_bf16 v[32:35], v[92:95], v[120:123], v[32:35]
    ds_read_b64_tr_b16 v[108:109], v17 offset:0
    v_mfma_f32_16x16x32_bf16 v[36:39], v[92:95], v[124:127], v[36:39]
    ds_read_b64_tr_b16 v[110:111], v17 offset:4096
    v_add_u32 v18, 4294868992, v18
    s_waitcnt lgkmcnt(6)
    v_mfma_f32_16x16x32_bf16 v[40:43], v[96:99], v[120:123], v[40:43]
    ds_read_b64_tr_b16 v[112:113], v18 offset:0
    v_mfma_f32_16x16x32_bf16 v[44:47], v[96:99], v[124:127], v[44:47]
    ds_read_b64_tr_b16 v[114:115], v18 offset:4096
    buffer_load_dwordx4 v[172:175], v9, s[44:47], s91 offen offset:1024 sc1
    s_add_u32 s91, s91, 0x20000
    v_add_u32 v19, 4294868992, v19
    s_waitcnt lgkmcnt(6)
    v_mfma_f32_16x16x32_bf16 v[48:51], v[100:103], v[120:123], v[48:51]
    ds_read_b64_tr_b16 v[116:117], v19 offset:0
    v_mfma_f32_16x16x32_bf16 v[52:55], v[100:103], v[124:127], v[52:55]
    ds_read_b64_tr_b16 v[118:119], v19 offset:4096
    s_waitcnt lgkmcnt(6)
    v_mfma_f32_16x16x32_bf16 v[56:59], v[104:107], v[120:123], v[56:59]
    ds_read_b64_tr_b16 v[88:89], v12 offset:8192
    v_mfma_f32_16x16x32_bf16 v[60:63], v[104:107], v[124:127], v[60:63]
    ds_read_b64_tr_b16 v[90:91], v12 offset:12288
    buffer_load_dwordx4 v[176:179], v9, s[44:47], s91 offen offset:0 sc1
    s_waitcnt lgkmcnt(6)
    v_mfma_f32_16x16x32_bf16 v[64:67], v[108:111], v[120:123], v[64:67]
    ds_read_b64_tr_b16 v[92:93], v13 offset:8192
    v_mfma_f32_16x16x32_bf16 v[68:71], v[108:111], v[124:127], v[68:71]
    ds_read_b64_tr_b16 v[94:95], v13 offset:12288
    s_waitcnt lgkmcnt(6)
    v_mfma_f32_16x16x32_bf16 v[72:75], v[112:115], v[120:123], v[72:75]
    ds_read_b64_tr_b16 v[96:97], v14 offset:8192
    v_mfma_f32_16x16x32_bf16 v[76:79], v[112:115], v[124:127], v[76:79]
    ds_read_b64_tr_b16 v[98:99], v14 offset:12288
    buffer_load_dwordx4 v[180:183], v9, s[44:47], s91 offen offset:1024 sc1
    s_add_u32 s91, s91, 0x20000
    s_waitcnt lgkmcnt(6)
    v_mfma_f32_16x16x32_bf16 v[80:83], v[116:119], v[120:123], v[80:83]
    ds_read_b64_tr_b16 v[100:101], v15 offset:8192
    v_mfma_f32_16x16x32_bf16 v[84:87], v[116:119], v[124:127], v[84:87]
    ds_read_b64_tr_b16 v[102:103], v15 offset:12288
    s_waitcnt vmcnt(15) lgkmcnt(6)
    v_mfma_f32_16x16x32_bf16 v[24:27], v[88:91], v[128:131], v[24:27]
    ds_read_b64_tr_b16 v[104:105], v16 offset:8192
    v_mfma_f32_16x16x32_bf16 v[28:31], v[88:91], v[132:135], v[28:31]
    ds_read_b64_tr_b16 v[106:107], v16 offset:12288
    buffer_load_dwordx4 v[184:187], v9, s[44:47], s91 offen offset:0 sc1
    s_waitcnt lgkmcnt(6)
    v_mfma_f32_16x16x32_bf16 v[32:35], v[92:95], v[128:131], v[32:35]
    ds_read_b64_tr_b16 v[108:109], v17 offset:8192
    v_mfma_f32_16x16x32_bf16 v[36:39], v[92:95], v[132:135], v[36:39]
    ds_read_b64_tr_b16 v[110:111], v17 offset:12288
    s_waitcnt lgkmcnt(6)
    v_mfma_f32_16x16x32_bf16 v[40:43], v[96:99], v[128:131], v[40:43]
    ds_read_b64_tr_b16 v[112:113], v18 offset:8192
    v_mfma_f32_16x16x32_bf16 v[44:47], v[96:99], v[132:135], v[44:47]
    ds_read_b64_tr_b16 v[114:115], v18 offset:12288
    buffer_load_dwordx4 v[188:191], v9, s[44:47], s91 offen offset:1024 sc1
    s_add_u32 s91, s91, 0x20000
    s_waitcnt lgkmcnt(6)
    v_mfma_f32_16x16x32_bf16 v[48:51], v[100:103], v[128:131], v[48:51]
    ds_read_b64_tr_b16 v[116:117], v19 offset:8192
    v_mfma_f32_16x16x32_bf16 v[52:55], v[100:103], v[132:135], v[52:55]
    ds_read_b64_tr_b16 v[118:119], v19 offset:12288
    s_waitcnt lgkmcnt(6)
    v_mfma_f32_16x16x32_bf16 v[56:59], v[104:107], v[128:131], v[56:59]
    ds_read_b64_tr_b16 v[88:89], v12 offset:16384
    v_mfma_f32_16x16x32_bf16 v[60:63], v[104:107], v[132:135], v[60:63]
    ds_read_b64_tr_b16 v[90:91], v12 offset:20480
    buffer_load_dwordx4 v[192:195], v9, s[44:47], s91 offen offset:0 sc1
    s_waitcnt lgkmcnt(6)
    v_mfma_f32_16x16x32_bf16 v[64:67], v[108:111], v[128:131], v[64:67]
    ds_read_b64_tr_b16 v[92:93], v13 offset:16384
    v_mfma_f32_16x16x32_bf16 v[68:71], v[108:111], v[132:135], v[68:71]
    ds_read_b64_tr_b16 v[94:95], v13 offset:20480
    s_waitcnt lgkmcnt(6)
    v_mfma_f32_16x16x32_bf16 v[72:75], v[112:115], v[128:131], v[72:75]
    ds_read_b64_tr_b16 v[96:97], v14 offset:16384
    v_mfma_f32_16x16x32_bf16 v[76:79], v[112:115], v[132:135], v[76:79]
    ds_read_b64_tr_b16 v[98:99], v14 offset:20480
    buffer_load_dwordx4 v[196:199], v9, s[44:47], s91 offen offset:1024 sc1
    s_add_u32 s91, s91, 0x20000
    s_waitcnt lgkmcnt(6)
    v_mfma_f32_16x16x32_bf16 v[80:83], v[116:119], v[128:131], v[80:83]
    ds_read_b64_tr_b16 v[100:101], v15 offset:16384
    v_mfma_f32_16x16x32_bf16 v[84:87], v[116:119], v[132:135], v[84:87]
    ds_read_b64_tr_b16 v[102:103], v15 offset:20480
    s_waitcnt vmcnt(15) lgkmcnt(6)
    v_mfma_f32_16x16x32_bf16 v[24:27], v[88:91], v[136:139], v[24:27]
    ds_read_b64_tr_b16 v[104:105], v16 offset:16384
    v_mfma_f32_16x16x32_bf16 v[28:31], v[88:91], v[140:143], v[28:31]
    ds_read_b64_tr_b16 v[106:107], v16 offset:20480
    buffer_load_dwordx4 v[200:203], v9, s[44:47], s91 offen offset:0 sc1
    s_waitcnt lgkmcnt(6)
    v_mfma_f32_16x16x32_bf16 v[32:35], v[92:95], v[136:139], v[32:35]
    ds_read_b64_tr_b16 v[108:109], v17 offset:16384
    v_mfma_f32_16x16x32_bf16 v[36:39], v[92:95], v[140:143], v[36:39]
    ds_read_b64_tr_b16 v[110:111], v17 offset:20480
    s_waitcnt lgkmcnt(6)
    v_mfma_f32_16x16x32_bf16 v[40:43], v[96:99], v[136:139], v[40:43]
    ds_read_b64_tr_b16 v[112:113], v18 offset:16384
    v_mfma_f32_16x16x32_bf16 v[44:47], v[96:99], v[140:143], v[44:47]
    ds_read_b64_tr_b16 v[114:115], v18 offset:20480
    buffer_load_dwordx4 v[204:207], v9, s[44:47], s91 offen offset:1024 sc1
    s_add_u32 s91, s91, 0x20000
    s_waitcnt lgkmcnt(6)
    v_mfma_f32_16x16x32_bf16 v[48:51], v[100:103], v[136:139], v[48:51]
    ds_read_b64_tr_b16 v[116:117], v19 offset:16384
    v_mfma_f32_16x16x32_bf16 v[52:55], v[100:103], v[140:143], v[52:55]
    ds_read_b64_tr_b16 v[118:119], v19 offset:20480
    s_cmp_lt_u32 s28, 4
    s_cbranch_scc1 L_skKY224
    s_waitcnt vmcnt(18)
    s_barrier
L_skKY224:
    s_waitcnt lgkmcnt(6)
    v_mfma_f32_16x16x32_bf16 v[56:59], v[104:107], v[136:139], v[56:59]
    ds_read_b64_tr_b16 v[88:89], v12 offset:24576
    v_mfma_f32_16x16x32_bf16 v[60:63], v[104:107], v[140:143], v[60:63]
    ds_read_b64_tr_b16 v[90:91], v12 offset:28672
    buffer_load_dwordx4 v[208:211], v9, s[44:47], s91 offen offset:0 sc1
    s_waitcnt lgkmcnt(6)
    v_mfma_f32_16x16x32_bf16 v[64:67], v[108:111], v[136:139], v[64:67]
    ds_read_b64_tr_b16 v[92:93], v13 offset:24576
    v_mfma_f32_16x16x32_bf16 v[68:71], v[108:111], v[140:143], v[68:71]
    ds_read_b64_tr_b16 v[94:95], v13 offset:28672
    s_waitcnt lgkmcnt(6)
    v_mfma_f32_16x16x32_bf16 v[72:75], v[112:115], v[136:139], v[72:75]
    ds_read_b64_tr_b16 v[96:97], v14 offset:24576
    v_mfma_f32_16x16x32_bf16 v[76:79], v[112:115], v[140:143], v[76:79]
    ds_read_b64_tr_b16 v[98:99], v14 offset:28672
    buffer_load_dwordx4 v[212:215], v9, s[44:47], s91 offen offset:1024 sc1
    s_add_u32 s91, s91, 0x20000
    s_waitcnt lgkmcnt(6)
    v_mfma_f32_16x16x32_bf16 v[80:83], v[116:119], v[136:139], v[80:83]
    ds_read_b64_tr_b16 v[100:101], v15 offset:24576
    v_mfma_f32_16x16x32_bf16 v[84:87], v[116:119], v[140:143], v[84:87]
    ds_read_b64_tr_b16 v[102:103], v15 offset:28672
    s_waitcnt vmcnt(16) lgkmcnt(6)
    v_mfma_f32_16x16x32_bf16 v[24:27], v[88:91], v[144:147], v[24:27]
    ds_read_b64_tr_b16 v[104:105], v16 offset:24576
    v_mfma_f32_16x16x32_bf16 v[28:31], v[88:91], v[148:151], v[28:31]
    ds_read_b64_tr_b16 v[106:107], v16 offset:28672
    buffer_load_dwordx4 v[216:219], v9, s[44:47], s91 offen offset:0 sc1
    s_waitcnt lgkmcnt(6)
    v_mfma_f32_16x16x32_bf16 v[32:35], v[92:95], v[144:147], v[32:35]
    ds_read_b64_tr_b16 v[108:109], v17 offset:24576
    v_mfma_f32_16x16x32_bf16 v[36:39], v[92:95], v[148:151], v[36:39]
    ds_read_b64_tr_b16 v[110:111], v17 offset:28672
    s_waitcnt lgkmcnt(6)
    v_mfma_f32_16x16x32_bf16 v[40:43], v[96:99], v[144:147], v[40:43]
    ds_read_b64_tr_b16 v[112:113], v18 offset:24576
    v_mfma_f32_16x16x32_bf16 v[44:47], v[96:99], v[148:151], v[44:47]
    ds_read_b64_tr_b16 v[114:115], v18 offset:28672
    buffer_load_dwordx4 v[220:223], v9, s[44:47], s91 offen offset:1024 sc1
    s_add_u32 s91, s91, 0x20000
    s_waitcnt lgkmcnt(6)
    v_mfma_f32_16x16x32_bf16 v[48:51], v[100:103], v[144:147], v[48:51]
    ds_read_b64_tr_b16 v[116:117], v19 offset:24576
    v_mfma_f32_16x16x32_bf16 v[52:55], v[100:103], v[148:151], v[52:55]
    ds_read_b64_tr_b16 v[118:119], v19 offset:28672
    s_cmp_lt_u32 s28, 4
    s_cbranch_scc0 L_skKX224
    s_waitcnt vmcnt(22)
    s_barrier
L_skKX224:
    s_cmp_lt_u32 s28, 4
    s_cbranch_scc1 L_skKY232
    s_waitcnt vmcnt(14)
    s_barrier
L_skKY232:
    v_add_u32 v14, 32768, v14
    s_waitcnt lgkmcnt(6)
    v_mfma_f32_16x16x32_bf16 v[56:59], v[104:107], v[144:147], v[56:59]
    ds_read_b64_tr_b16 v[88:89], v14 offset:0
    v_mfma_f32_16x16x32_bf16 v[60:63], v[104:107], v[148:151], v[60:63]
    ds_read_b64_tr_b16 v[90:91], v14 offset:4096
    buffer_load_dwordx4 v[224:227], v9, s[44:47], s91 offen offset:0 sc1
    v_add_u32 v15, 32768, v15
    s_waitcnt lgkmcnt(6)
    v_mfma_f32_16x16x32_bf16 v[64:67], v[108:111], v[144:147], v[64:67]
    ds_read_b64_tr_b16 v[92:93], v15 offset:0
    v_mfma_f32_16x16x32_bf16 v[68:71], v[108:111], v[148:151], v[68:71]
    ds_read_b64_tr_b16 v[94:95], v15 offset:4096
    v_add_u32 v16, 32768, v16
    s_waitcnt lgkmcnt(6)
    v_mfma_f32_16x16x32_bf16 v[72:75], v[112:115], v[144:147], v[72:75]
    ds_read_b64_tr_b16 v[96:97], v14 offset:8192
    v_mfma_f32_16x16x32_bf16 v[76:79], v[112:115], v[148:151], v[76:79]
    ds_read_b64_tr_b16 v[98:99], v14 offset:12288
    buffer_load_dwordx4 v[228:231], v9, s[44:47], s91 offen offset:1024 sc1
    s_add_u32 s91, s91, 0x20000
    v_add_u32 v17, 32768, v17
    s_waitcnt lgkmcnt(6)
    v_mfma_f32_16x16x32_bf16 v[80:83], v[116:119], v[144:147], v[80:83]
    ds_read_b64_tr_b16 v[100:101], v15 offset:8192
    v_mfma_f32_16x16x32_bf16 v[84:87], v[116:119], v[148:151], v[84:87]
    ds_read_b64_tr_b16 v[102:103], v15 offset:12288
    v_add_u32 v18, 32768, v18
    s_waitcnt vmcnt(14) lgkmcnt(6)
    v_mfma_f32_16x16x32_bf16 v[40:43], v[88:91], v[168:171], v[40:43]
    ds_read_b64_tr_b16 v[104:105], v14 offset:16384
    v_mfma_f32_16x16x32_bf16 v[44:47], v[88:91], v[172:175], v[44:47]
    ds_read_b64_tr_b16 v[106:107], v14 offset:20480
    v_add_u32 v19, 32768, v19
    s_waitcnt lgkmcnt(6)
    v_mfma_f32_16x16x32_bf16 v[48:51], v[92:95], v[168:171], v[48:51]
    ds_read_b64_tr_b16 v[108:109], v15 offset:16384
    v_mfma_f32_16x16x32_bf16 v[52:55], v[92:95], v[172:175], v[52:55]
    ds_read_b64_tr_b16 v[110:111], v15 offset:20480
    v_add_u32 v12, 32768, v12
    s_waitcnt vmcnt(12) lgkmcnt(6)
    v_mfma_f32_16x16x32_bf16 v[40:43], v[96:99], v[176:179], v[40:43]
    ds_read_b64_tr_b16 v[112:113], v14 offset:24576
    v_mfma_f32_16x16x32_bf16 v[44:47], v[96:99], v[180:183], v[44:47]
    ds_read_b64_tr_b16 v[114:115], v14 offset:28672
    v_add_u32 v13, 32768, v13
    s_waitcnt lgkmcnt(6)
    v_mfma_f32_16x16x32_bf16 v[48:51], v[100:103], v[176:179], v[48:51]
    ds_read_b64_tr_b16 v[116:117], v15 offset:24576
    v_mfma_f32_16x16x32_bf16 v[52:55], v[100:103], v[180:183], v[52:55]
    ds_read_b64_tr_b16 v[118:119], v15 offset:28672
    s_cmp_lt_u32 s28, 4
    s_cbranch_scc0 L_skKX232
    s_waitcnt vmcnt(16)
    s_barrier
L_skKX232:
    s_waitcnt vmcnt(10) lgkmcnt(6)
    v_mfma_f32_16x16x32_bf16 v[40:43], v[104:107], v[184:187], v[40:43]
    ds_read_b64_tr_b16 v[88:89], v14 offset:32768
    v_mfma_f32_16x16x32_bf16 v[44:47], v[104:107], v[188:191], v[44:47]
    ds_read_b64_tr_b16 v[90:91], v14 offset:36864
    s_waitcnt lgkmcnt(6)
    v_mfma_f32_16x16x32_bf16 v[48:51], v[108:111], v[184:187], v[48:51]
    ds_read_b64_tr_b16 v[92:93], v15 offset:32768
    v_mfma_f32_16x16x32_bf16 v[52:55], v[108:111], v[188:191], v[52:55]
    ds_read_b64_tr_b16 v[94:95], v15 offset:36864
    s_waitcnt vmcnt(8) lgkmcnt(6)
    v_mfma_f32_16x16x32_bf16 v[40:43], v[112:115], v[192:195], v[40:43]
    ds_read_b64_tr_b16 v[96:97], v14 offset:40960
    v_mfma_f32_16x16x32_bf16 v[44:47], v[112:115], v[196:199], v[44:47]
    ds_read_b64_tr_b16 v[98:99], v14 offset:45056
    s_waitcnt lgkmcnt(6)
    v_mfma_f32_16x16x32_bf16 v[48:51], v[116:119], v[192:195], v[48:51]
    ds_read_b64_tr_b16 v[100:101], v15 offset:40960
    v_mfma_f32_16x16x32_bf16 v[52:55], v[116:119], v[196:199], v[52:55]
    ds_read_b64_tr_b16 v[102:103], v15 offset:45056
    s_waitcnt vmcnt(6) lgkmcnt(6)
    v_mfma_f32_16x16x32_bf16 v[40:43], v[88:91], v[200:203], v[40:43]
    ds_read_b64_tr_b16 v[104:105], v14 offset:49152
    v_mfma_f32_16x16x32_bf16 v[44:47], v[88:91], v[204:207], v[44:47]
    ds_read_b64_tr_b16 v[106:107], v14 offset:53248
    s_waitcnt lgkmcnt(6)
    v_mfma_f32_16x16x32_bf16 v[48:51], v[92:95], v[200:203], v[48:51]
    ds_read_b64_tr_b16 v[108:109], v15 offset:49152
    v_mfma_f32_16x16x32_bf16 v[52:55], v[92:95], v[204:207], v[52:55]
    ds_read_b64_tr_b16 v[110:111], v15 offset:53248
    s_waitcnt vmcnt(4) lgkmcnt(6)
    v_mfma_f32_16x16x32_bf16 v[40:43], v[96:99], v[208:211], v[40:43]
    ds_read_b64_tr_b16 v[112:113], v14 offset:57344
    v_mfma_f32_16x16x32_bf16 v[44:47], v[96:99], v[212:215], v[44:47]
    ds_read_b64_tr_b16 v[114:115], v14 offset:61440
    s_waitcnt lgkmcnt(6)
    v_mfma_f32_16x16x32_bf16 v[48:51], v[100:103], v[208:211], v[48:51]
    ds_read_b64_tr_b16 v[116:117], v15 offset:57344
    v_mfma_f32_16x16x32_bf16 v[52:55], v[100:103], v[212:215], v[52:55]
    ds_read_b64_tr_b16 v[118:119], v15 offset:61440
    s_waitcnt vmcnt(2) lgkmcnt(6)
    v_mfma_f32_16x16x32_bf16 v[40:43], v[104:107], v[216:219], v[40:43]
    ds_read_b64_tr_b16 v[88:89], v16 offset:0
    v_mfma_f32_16x16x32_bf16 v[44:47], v[104:107], v[220:223], v[44:47]
    ds_read_b64_tr_b16 v[90:91], v16 offset:4096
    s_waitcnt lgkmcnt(6)
    v_mfma_f32_16x16x32_bf16 v[48:51], v[108:111], v[216:219], v[48:51]
    ds_read_b64_tr_b16 v[92:93], v17 offset:0
    v_mfma_f32_16x16x32_bf16 v[52:55], v[108:111], v[220:223], v[52:55]
    ds_read_b64_tr_b16 v[94:95], v17 offset:4096
    s_waitcnt vmcnt(0) lgkmcnt(6)
    v_mfma_f32_16x16x32_bf16 v[40:43], v[112:115], v[224:227], v[40:43]
    ds_read_b64_tr_b16 v[96:97], v16 offset:8192
    v_mfma_f32_16x16x32_bf16 v[44:47], v[112:115], v[228:231], v[44:47]
    ds_read_b64_tr_b16 v[98:99], v16 offset:12288
    s_waitcnt lgkmcnt(6)
    v_mfma_f32_16x16x32_bf16 v[48:51], v[116:119], v[224:227], v[48:51]
    ds_read_b64_tr_b16 v[100:101], v17 offset:8192
    v_mfma_f32_16x16x32_bf16 v[52:55], v[116:119], v[228:231], v[52:55]
    ds_read_b64_tr_b16 v[102:103], v17 offset:12288
    s_waitcnt lgkmcnt(6)
    v_mfma_f32_16x16x32_bf16 v[56:59], v[88:91], v[168:171], v[56:59]
    ds_read_b64_tr_b16 v[104:105], v16 offset:16384
    v_mfma_f32_16x16x32_bf16 v[60:63], v[88:91], v[172:175], v[60:63]
    ds_read_b64_tr_b16 v[106:107], v16 offset:20480
    s_xor_b32 s93, s64, 1
    s_mul_i32 s93, s93, 49152
    s_add_u32 s93, s93, s92
    s_add_u32 s93, s93, 0
    s_waitcnt lgkmcnt(6)
    v_mfma_f32_16x16x32_bf16 v[64:67], v[92:95], v[168:171], v[64:67]
    ds_read_b64_tr_b16 v[108:109], v17 offset:16384
    v_mfma_f32_16x16x32_bf16 v[68:71], v[92:95], v[172:175], v[68:71]
    ds_read_b64_tr_b16 v[110:111], v17 offset:20480
    v_cvt_pk_bf16_f32 v120, v40, v41
    v_cvt_pk_bf16_f32 v121, v42, v43
    v_cvt_pk_bf16_f32 v122, v48, v49
    v_cvt_pk_bf16_f32 v123, v50, v51
    buffer_store_dwordx4 v[120:123], v11, s[56:59], s93 offen offset:0 sc1
    s_waitcnt lgkmcnt(6)
    v_mfma_f32_16x16x32_bf16 v[56:59], v[96:99], v[176:179], v[56:59]
    ds_read_b64_tr_b16 v[112:113], v16 offset:24576
    v_mfma_f32_16x16x32_bf16 v[60:63], v[96:99], v[180:183], v[60:63]
    ds_read_b64_tr_b16 v[114:115], v16 offset:28672
    v_cvt_pk_bf16_f32 v124, v44, v45
    v_cvt_pk_bf16_f32 v125, v46, v47
    v_cvt_pk_bf16_f32 v126, v52, v53
    v_cvt_pk_bf16_f32 v127, v54, v55
    buffer_store_dwordx4 v[124:127], v11, s[56:59], s93 offen offset:1024 sc1
    s_waitcnt lgkmcnt(6)
    v_mfma_f32_16x16x32_bf16 v[64:67], v[100:103], v[176:179], v[64:67]
    ds_read_b64_tr_b16 v[116:117], v17 offset:24576
    v_mfma_f32_16x16x32_bf16 v[68:71], v[100:103], v[180:183], v[68:71]
    ds_read_b64_tr_b16 v[118:119], v17 offset:28672
    s_waitcnt lgkmcnt(6)
    v_mfma_f32_16x16x32_bf16 v[56:59], v[104:107], v[184:187], v[56:59]
    ds_read_b64_tr_b16 v[88:89], v16 offset:32768
    v_mfma_f32_16x16x32_bf16 v[60:63], v[104:107], v[188:191], v[60:63]
    ds_read_b64_tr_b16 v[90:91], v16 offset:36864
    s_waitcnt lgkmcnt(6)
    v_mfma_f32_16x16x32_bf16 v[64:67], v[108:111], v[184:187], v[64:67]
    ds_read_b64_tr_b16 v[92:93], v17 offset:32768
    v_mfma_f32_16x16x32_bf16 v[68:71], v[108:111], v[188:191], v[68:71]
    ds_read_b64_tr_b16 v[94:95], v17 offset:36864
    s_waitcnt lgkmcnt(6)
    v_mfma_f32_16x16x32_bf16 v[56:59], v[112:115], v[192:195], v[56:59]
    ds_read_b64_tr_b16 v[96:97], v16 offset:40960
    v_mfma_f32_16x16x32_bf16 v[60:63], v[112:115], v[196:199], v[60:63]
    ds_read_b64_tr_b16 v[98:99], v16 offset:45056
    s_waitcnt vmcnt(35)
    v_lshlrev_b32 v40, 16, v232
    v_and_b32 v41, 0xffff0000, v232
    v_lshlrev_b32 v48, 16, v236
    v_and_b32 v49, 0xffff0000, v236
    s_waitcnt lgkmcnt(6)
    v_mfma_f32_16x16x32_bf16 v[64:67], v[116:119], v[192:195], v[64:67]
    ds_read_b64_tr_b16 v[100:101], v17 offset:40960
    v_mfma_f32_16x16x32_bf16 v[68:71], v[116:119], v[196:199], v[68:71]
    ds_read_b64_tr_b16 v[102:103], v17 offset:45056
    v_lshlrev_b32 v0, 16, v240
    v_and_b32 v20, 0xffff0000, v240
    v_add_f32 v40, v40, v0
    v_add_f32 v41, v41, v20
    v_add_f32 v48, v48, v0
    s_waitcnt lgkmcnt(6)
    v_mfma_f32_16x16x32_bf16 v[56:59], v[88:91], v[200:203], v[56:59]
    ds_read_b64_tr_b16 v[104:105], v16 offset:49152
    v_mfma_f32_16x16x32_bf16 v[60:63], v[88:91], v[204:207], v[60:63]
    ds_read_b64_tr_b16 v[106:107], v16 offset:53248
    v_add_f32 v49, v49, v20
    v_lshlrev_b32 v42, 16, v233
    v_and_b32 v43, 0xffff0000, v233
    v_lshlrev_b32 v50, 16, v237
    v_and_b32 v51, 0xffff0000, v237
    s_waitcnt lgkmcnt(6)
    v_mfma_f32_16x16x32_bf16 v[64:67], v[92:95], v[200:203], v[64:67]
    ds_read_b64_tr_b16 v[108:109], v17 offset:49152
    v_mfma_f32_16x16x32_bf16 v[68:71], v[92:95], v[204:207], v[68:71]
    ds_read_b64_tr_b16 v[110:111], v17 offset:53248
    v_lshlrev_b32 v0, 16, v241
    v_and_b32 v20, 0xffff0000, v241
    v_add_f32 v42, v42, v0
    v_add_f32 v43, v43, v20
    v_add_f32 v50, v50, v0
    s_waitcnt lgkmcnt(6)
    v_mfma_f32_16x16x32_bf16 v[56:59], v[96:99], v[208:211], v[56:59]
    ds_read_b64_tr_b16 v[112:113], v16 offset:57344
    v_mfma_f32_16x16x32_bf16 v[60:63], v[96:99], v[212:215], v[60:63]
    ds_read_b64_tr_b16 v[114:115], v16 offset:61440
    v_add_f32 v51, v51, v20
    v_lshlrev_b32 v44, 16, v234
    v_and_b32 v45, 0xffff0000, v234
    v_lshlrev_b32 v52, 16, v238
    v_and_b32 v53, 0xffff0000, v238
    s_waitcnt lgkmcnt(6)
    v_mfma_f32_16x16x32_bf16 v[64:67], v[100:103], v[208:211], v[64:67]
    ds_read_b64_tr_b16 v[116:117], v17 offset:57344
    v_mfma_f32_16x16x32_bf16 v[68:71], v[100:103], v[212:215], v[68:71]
    ds_read_b64_tr_b16 v[118:119], v17 offset:61440
    v_lshlrev_b32 v0, 16, v242
    v_and_b32 v20, 0xffff0000, v242
    v_add_f32 v44, v44, v0
    v_add_f32 v45, v45, v20
    v_add_f32 v52, v52, v0
    s_waitcnt lgkmcnt(6)
    v_mfma_f32_16x16x32_bf16 v[56:59], v[104:107], v[216:219], v[56:59]
    ds_read_b64_tr_b16 v[88:89], v18 offset:0
    v_mfma_f32_16x16x32_bf16 v[60:63], v[104:107], v[220:223], v[60:63]
    ds_read_b64_tr_b16 v[90:91], v18 offset:4096
    v_add_f32 v53, v53, v20
    v_lshlrev_b32 v46, 16, v235
    v_and_b32 v47, 0xffff0000, v235
    v_lshlrev_b32 v54, 16, v239
    v_and_b32 v55, 0xffff0000, v239
    s_waitcnt lgkmcnt(6)
    v_mfma_f32_16x16x32_bf16 v[64:67], v[108:111], v[216:219], v[64:67]
    ds_read_b64_tr_b16 v[92:93], v19 offset:0
    v_mfma_f32_16x16x32_bf16 v[68:71], v[108:111], v[220:223], v[68:71]
    ds_read_b64_tr_b16 v[94:95], v19 offset:4096
    v_lshlrev_b32 v0, 16, v243
    v_and_b32 v20, 0xffff0000, v243
    v_add_f32 v46, v46, v0
    v_add_f32 v47, v47, v20
    v_add_f32 v54, v54, v0
    s_waitcnt lgkmcnt(6)
    v_mfma_f32_16x16x32_bf16 v[56:59], v[112:115], v[224:227], v[56:59]
    ds_read_b64_tr_b16 v[96:97], v18 offset:8192
    v_mfma_f32_16x16x32_bf16 v[60:63], v[112:115], v[228:231], v[60:63]
    ds_read_b64_tr_b16 v[98:99], v18 offset:12288
    v_add_f32 v55, v55, v20
    v_mul_f32 v244, v244, v244
    v_mul_f32 v245, v245, v245
    s_waitcnt lgkmcnt(6)
    v_mfma_f32_16x16x32_bf16 v[64:67], v[116:119], v[224:227], v[64:67]
    ds_read_b64_tr_b16 v[100:101], v19 offset:8192
    v_mfma_f32_16x16x32_bf16 v[68:71], v[116:119], v[228:231], v[68:71]
    ds_read_b64_tr_b16 v[102:103], v19 offset:12288
    s_waitcnt lgkmcnt(6)
    v_mfma_f32_16x16x32_bf16 v[72:75], v[88:91], v[168:171], v[72:75]
    ds_read_b64_tr_b16 v[104:105], v18 offset:16384
    v_mfma_f32_16x16x32_bf16 v[76:79], v[88:91], v[172:175], v[76:79]
    ds_read_b64_tr_b16 v[106:107], v18 offset:20480
    s_xor_b32 s93, s64, 2
    s_mul_i32 s93, s93, 49152
    s_add_u32 s93, s93, s92
    s_add_u32 s93, s93, 16384
    s_waitcnt lgkmcnt(6)
    v_mfma_f32_16x16x32_bf16 v[80:83], v[92:95], v[168:171], v[80:83]
    ds_read_b64_tr_b16 v[108:109], v19 offset:16384
    v_mfma_f32_16x16x32_bf16 v[84:87], v[92:95], v[172:175], v[84:87]
    ds_read_b64_tr_b16 v[110:111], v19 offset:20480
    v_cvt_pk_bf16_f32 v128, v56, v57
    v_cvt_pk_bf16_f32 v129, v58, v59
    v_cvt_pk_bf16_f32 v130, v64, v65
    v_cvt_pk_bf16_f32 v131, v66, v67
    buffer_store_dwordx4 v[128:131], v11, s[56:59], s93 offen offset:0 sc1
    s_waitcnt lgkmcnt(6)
    v_mfma_f32_16x16x32_bf16 v[72:75], v[96:99], v[176:179], v[72:75]
    ds_read_b64_tr_b16 v[112:113], v18 offset:24576
    v_mfma_f32_16x16x32_bf16 v[76:79], v[96:99], v[180:183], v[76:79]
    ds_read_b64_tr_b16 v[114:115], v18 offset:28672
    v_cvt_pk_bf16_f32 v132, v60, v61
    v_cvt_pk_bf16_f32 v133, v62, v63
    v_cvt_pk_bf16_f32 v134, v68, v69
    v_cvt_pk_bf16_f32 v135, v70, v71
    buffer_store_dwordx4 v[132:135], v11, s[56:59], s93 offen offset:1024 sc1
    s_waitcnt lgkmcnt(6)
    v_mfma_f32_16x16x32_bf16 v[80:83], v[100:103], v[176:179], v[80:83]
    ds_read_b64_tr_b16 v[116:117], v19 offset:24576
    v_mfma_f32_16x16x32_bf16 v[84:87], v[100:103], v[180:183], v[84:87]
    ds_read_b64_tr_b16 v[118:119], v19 offset:28672
    s_waitcnt lgkmcnt(6)
    v_mfma_f32_16x16x32_bf16 v[72:75], v[104:107], v[184:187], v[72:75]
    ds_read_b64_tr_b16 v[88:89], v18 offset:32768
    v_mfma_f32_16x16x32_bf16 v[76:79], v[104:107], v[188:191], v[76:79]
    ds_read_b64_tr_b16 v[90:91], v18 offset:36864
    s_waitcnt lgkmcnt(6)
    v_mfma_f32_16x16x32_bf16 v[80:83], v[108:111], v[184:187], v[80:83]
    ds_read_b64_tr_b16 v[92:93], v19 offset:32768
    v_mfma_f32_16x16x32_bf16 v[84:87], v[108:111], v[188:191], v[84:87]
    ds_read_b64_tr_b16 v[94:95], v19 offset:36864
    s_waitcnt lgkmcnt(6)
    v_mfma_f32_16x16x32_bf16 v[72:75], v[112:115], v[192:195], v[72:75]
    ds_read_b64_tr_b16 v[96:97], v18 offset:40960
    v_mfma_f32_16x16x32_bf16 v[76:79], v[112:115], v[196:199], v[76:79]
    ds_read_b64_tr_b16 v[98:99], v18 offset:45056
    s_waitcnt lgkmcnt(6)
    v_mfma_f32_16x16x32_bf16 v[80:83], v[116:119], v[192:195], v[80:83]
    ds_read_b64_tr_b16 v[100:101], v19 offset:40960
    v_mfma_f32_16x16x32_bf16 v[84:87], v[116:119], v[196:199], v[84:87]
    ds_read_b64_tr_b16 v[102:103], v19 offset:45056
    s_waitcnt lgkmcnt(6)
    v_mfma_f32_16x16x32_bf16 v[72:75], v[88:91], v[200:203], v[72:75]
    ds_read_b64_tr_b16 v[104:105], v18 offset:49152
    v_mfma_f32_16x16x32_bf16 v[76:79], v[88:91], v[204:207], v[76:79]
    ds_read_b64_tr_b16 v[106:107], v18 offset:53248
    s_waitcnt lgkmcnt(6)
    v_mfma_f32_16x16x32_bf16 v[80:83], v[92:95], v[200:203], v[80:83]
    ds_read_b64_tr_b16 v[108:109], v19 offset:49152
    v_mfma_f32_16x16x32_bf16 v[84:87], v[92:95], v[204:207], v[84:87]
    ds_read_b64_tr_b16 v[110:111], v19 offset:53248
    s_waitcnt lgkmcnt(6)
    v_mfma_f32_16x16x32_bf16 v[72:75], v[96:99], v[208:211], v[72:75]
    ds_read_b64_tr_b16 v[112:113], v18 offset:57344
    v_mfma_f32_16x16x32_bf16 v[76:79], v[96:99], v[212:215], v[76:79]
    ds_read_b64_tr_b16 v[114:115], v18 offset:61440
    s_waitcnt lgkmcnt(6)
    v_mfma_f32_16x16x32_bf16 v[80:83], v[100:103], v[208:211], v[80:83]
    ds_read_b64_tr_b16 v[116:117], v19 offset:57344
    v_mfma_f32_16x16x32_bf16 v[84:87], v[100:103], v[212:215], v[84:87]
    ds_read_b64_tr_b16 v[118:119], v19 offset:61440
    s_waitcnt lgkmcnt(6)
    v_mfma_f32_16x16x32_bf16 v[72:75], v[104:107], v[216:219], v[72:75]
    ds_read_b64_tr_b16 v[88:89], v12 offset:0
    v_mfma_f32_16x16x32_bf16 v[76:79], v[104:107], v[220:223], v[76:79]
    ds_read_b64_tr_b16 v[90:91], v12 offset:4096
    s_waitcnt lgkmcnt(6)
    v_mfma_f32_16x16x32_bf16 v[80:83], v[108:111], v[216:219], v[80:83]
    ds_read_b64_tr_b16 v[92:93], v13 offset:0
    v_mfma_f32_16x16x32_bf16 v[84:87], v[108:111], v[220:223], v[84:87]
    ds_read_b64_tr_b16 v[94:95], v13 offset:4096
    s_waitcnt lgkmcnt(6)
    v_mfma_f32_16x16x32_bf16 v[72:75], v[112:115], v[224:227], v[72:75]
    ds_read_b64_tr_b16 v[96:97], v12 offset:8192
    v_mfma_f32_16x16x32_bf16 v[76:79], v[112:115], v[228:231], v[76:79]
    ds_read_b64_tr_b16 v[98:99], v12 offset:12288
    s_waitcnt lgkmcnt(6)
    v_mfma_f32_16x16x32_bf16 v[80:83], v[116:119], v[224:227], v[80:83]
    ds_read_b64_tr_b16 v[100:101], v13 offset:8192
    v_mfma_f32_16x16x32_bf16 v[84:87], v[116:119], v[228:231], v[84:87]
    ds_read_b64_tr_b16 v[102:103], v13 offset:12288
    s_waitcnt lgkmcnt(6)
    v_mfma_f32_16x16x32_bf16 v[24:27], v[88:91], v[168:171], v[24:27]
    ds_read_b64_tr_b16 v[104:105], v12 offset:16384
    v_mfma_f32_16x16x32_bf16 v[28:31], v[88:91], v[172:175], v[28:31]
    ds_read_b64_tr_b16 v[106:107], v12 offset:20480
    s_xor_b32 s93, s64, 3
    s_mul_i32 s93, s93, 49152
    s_add_u32 s93, s93, s92
    s_add_u32 s93, s93, 32768
    s_waitcnt lgkmcnt(6)
    v_mfma_f32_16x16x32_bf16 v[32:35], v[92:95], v[168:171], v[32:35]
    ds_read_b64_tr_b16 v[108:109], v13 offset:16384
    v_mfma_f32_16x16x32_bf16 v[36:39], v[92:95], v[172:175], v[36:39]
    ds_read_b64_tr_b16 v[110:111], v13 offset:20480
    v_cvt_pk_bf16_f32 v136, v72, v73
    v_cvt_pk_bf16_f32 v137, v74, v75
    v_cvt_pk_bf16_f32 v138, v80, v81
    v_cvt_pk_bf16_f32 v139, v82, v83
    buffer_store_dwordx4 v[136:139], v11, s[56:59], s93 offen offset:0 sc1
    s_waitcnt lgkmcnt(6)
    v_mfma_f32_16x16x32_bf16 v[24:27], v[96:99], v[176:179], v[24:27]
    ds_read_b64_tr_b16 v[112:113], v12 offset:24576
    v_mfma_f32_16x16x32_bf16 v[28:31], v[96:99], v[180:183], v[28:31]
    ds_read_b64_tr_b16 v[114:115], v12 offset:28672
    v_cvt_pk_bf16_f32 v140, v76, v77
    v_cvt_pk_bf16_f32 v141, v78, v79
    v_cvt_pk_bf16_f32 v142, v84, v85
    v_cvt_pk_bf16_f32 v143, v86, v87
    buffer_store_dwordx4 v[140:143], v11, s[56:59], s93 offen offset:1024 sc1
    s_waitcnt lgkmcnt(6)
    v_mfma_f32_16x16x32_bf16 v[32:35], v[100:103], v[176:179], v[32:35]
    ds_read_b64_tr_b16 v[116:117], v13 offset:24576
    v_mfma_f32_16x16x32_bf16 v[36:39], v[100:103], v[180:183], v[36:39]
    ds_read_b64_tr_b16 v[118:119], v13 offset:28672
    s_waitcnt lgkmcnt(6)
    v_mfma_f32_16x16x32_bf16 v[24:27], v[104:107], v[184:187], v[24:27]
    ds_read_b64_tr_b16 v[88:89], v12 offset:32768
    v_mfma_f32_16x16x32_bf16 v[28:31], v[104:107], v[188:191], v[28:31]
    ds_read_b64_tr_b16 v[90:91], v12 offset:36864
    s_add_u32 s33, s94, 0
    buffer_load_dwordx4 v[144:147], v11, s[56:59], s33 offen offset:0 sc1
    buffer_load_dwordx4 v[156:159], v11, s[56:59], s33 offen offset:1024 sc1
    s_waitcnt lgkmcnt(6)
    v_mfma_f32_16x16x32_bf16 v[32:35], v[108:111], v[184:187], v[32:35]
    ds_read_b64_tr_b16 v[92:93], v13 offset:32768
    v_mfma_f32_16x16x32_bf16 v[36:39], v[108:111], v[188:191], v[36:39]
    ds_read_b64_tr_b16 v[94:95], v13 offset:36864
    s_add_u32 s33, s94, 16384
    buffer_load_dwordx4 v[148:151], v11, s[56:59], s33 offen offset:0 sc1
    buffer_load_dwordx4 v[160:163], v11, s[56:59], s33 offen offset:1024 sc1
    s_waitcnt lgkmcnt(6)
    v_mfma_f32_16x16x32_bf16 v[24:27], v[112:115], v[192:195], v[24:27]
    ds_read_b64_tr_b16 v[96:97], v12 offset:40960
    v_mfma_f32_16x16x32_bf16 v[28:31], v[112:115], v[196:199], v[28:31]
    ds_read_b64_tr_b16 v[98:99], v12 offset:45056
    s_waitcnt lgkmcnt(6)
    v_mfma_f32_16x16x32_bf16 v[32:35], v[116:119], v[192:195], v[32:35]
    ds_read_b64_tr_b16 v[100:101], v13 offset:40960
    v_mfma_f32_16x16x32_bf16 v[36:39], v[116:119], v[196:199], v[36:39]
    ds_read_b64_tr_b16 v[102:103], v13 offset:45056
    s_waitcnt lgkmcnt(6)
    v_mfma_f32_16x16x32_bf16 v[24:27], v[88:91], v[200:203], v[24:27]
    ds_read_b64_tr_b16 v[104:105], v12 offset:49152
    v_mfma_f32_16x16x32_bf16 v[28:31], v[88:91], v[204:207], v[28:31]
    ds_read_b64_tr_b16 v[106:107], v12 offset:53248
    s_waitcnt lgkmcnt(6)
    v_mfma_f32_16x16x32_bf16 v[32:35], v[92:95], v[200:203], v[32:35]
    ds_read_b64_tr_b16 v[108:109], v13 offset:49152
    v_mfma_f32_16x16x32_bf16 v[36:39], v[92:95], v[204:207], v[36:39]
    ds_read_b64_tr_b16 v[110:111], v13 offset:53248
    s_waitcnt lgkmcnt(6)
    v_mfma_f32_16x16x32_bf16 v[24:27], v[96:99], v[208:211], v[24:27]
    ds_read_b64_tr_b16 v[112:113], v12 offset:57344
    v_mfma_f32_16x16x32_bf16 v[28:31], v[96:99], v[212:215], v[28:31]
    ds_read_b64_tr_b16 v[114:115], v12 offset:61440
    s_waitcnt lgkmcnt(6)
    v_mfma_f32_16x16x32_bf16 v[32:35], v[100:103], v[208:211], v[32:35]
    ds_read_b64_tr_b16 v[116:117], v13 offset:57344
    v_mfma_f32_16x16x32_bf16 v[36:39], v[100:103], v[212:215], v[36:39]
    ds_read_b64_tr_b16 v[118:119], v13 offset:61440
    s_waitcnt lgkmcnt(6)
    v_mfma_f32_16x16x32_bf16 v[24:27], v[104:107], v[216:219], v[24:27]
    v_mfma_f32_16x16x32_bf16 v[28:31], v[104:107], v[220:223], v[28:31]
    s_waitcnt lgkmcnt(4)
    v_mfma_f32_16x16x32_bf16 v[32:35], v[108:111], v[216:219], v[32:35]
    v_mfma_f32_16x16x32_bf16 v[36:39], v[108:111], v[220:223], v[36:39]
    s_waitcnt lgkmcnt(2)
    v_mfma_f32_16x16x32_bf16 v[24:27], v[112:115], v[224:227], v[24:27]
    v_mfma_f32_16x16x32_bf16 v[28:31], v[112:115], v[228:231], v[28:31]
    s_waitcnt lgkmcnt(0)
    v_mfma_f32_16x16x32_bf16 v[32:35], v[116:119], v[224:227], v[32:35]
    v_mfma_f32_16x16x32_bf16 v[36:39], v[116:119], v[228:231], v[36:39]
    s_branch L_exch
L_typeQ:
    v_max_f32 v56, 0, v56
    v_max_f32 v57, 0, v57
    v_max_f32 v58, 0, v58
    v_max_f32 v59, 0, v59
    v_max_f32 v60, 0, v60
    v_max_f32 v61, 0, v61
    v_max_f32 v62, 0, v62
    v_max_f32 v63, 0, v63
    v_pk_mul_f32 v[56:57], v[56:57], v[56:57]
    v_pk_mul_f32 v[58:59], v[58:59], v[58:59]
    v_pk_mul_f32 v[60:61], v[60:61], v[60:61]
    v_pk_mul_f32 v[62:63], v[62:63], v[62:63]
    v_cvt_pk_bf16_f32 v56, v56, v57
    v_cvt_pk_bf16_f32 v57, v58, v59
    v_cvt_pk_bf16_f32 v60, v60, v61
    v_cvt_pk_bf16_f32 v61, v62, v63
    v_max_f32 v64, 0, v64
    v_max_f32 v65, 0, v65
    v_max_f32 v66, 0, v66
    v_max_f32 v67, 0, v67
    v_max_f32 v68, 0, v68
    v_max_f32 v69, 0, v69
    v_max_f32 v70, 0, v70
    v_max_f32 v71, 0, v71
    v_pk_mul_f32 v[64:65], v[64:65], v[64:65]
    v_pk_mul_f32 v[66:67], v[66:67], v[66:67]
    v_pk_mul_f32 v[68:69], v[68:69], v[68:69]
    v_pk_mul_f32 v[70:71], v[70:71], v[70:71]
    v_cvt_pk_bf16_f32 v58, v64, v65
    v_cvt_pk_bf16_f32 v59, v66, v67
    s_cmp_eq_u32 s76, 1
    s_cbranch_scc0 L_ss7
    buffer_store_dwordx4 v[56:59], v11, s[56:59], s41 offen offset:0
L_sb7:
    v_cvt_pk_bf16_f32 v62, v68, v69
    v_cvt_pk_bf16_f32 v63, v70, v71
    s_cmp_eq_u32 s76, 1
    s_cbranch_scc0 L_ss8
    buffer_store_dwordx4 v[60:63], v11, s[56:59], s41 offen offset:1024
L_sb8:
    s_add_u32 s41, s41, 0x20000
    v_max_f32 v72, 0, v72
    v_max_f32 v73, 0, v73
    v_max_f32 v74, 0, v74
    v_max_f32 v75, 0, v75
    v_max_f32 v76, 0, v76
    v_max_f32 v77, 0, v77
    v_max_f32 v78, 0, v78
    v_max_f32 v79, 0, v79
    v_pk_mul_f32 v[72:73], v[72:73], v[72:73]
    v_pk_mul_f32 v[74:75], v[74:75], v[74:75]
    v_pk_mul_f32 v[76:77], v[76:77], v[76:77]
    v_pk_mul_f32 v[78:79], v[78:79], v[78:79]
    v_cvt_pk_bf16_f32 v72, v72, v73
    v_cvt_pk_bf16_f32 v73, v74, v75
    v_cvt_pk_bf16_f32 v76, v76, v77
    v_cvt_pk_bf16_f32 v77, v78, v79
    v_max_f32 v80, 0, v80
    v_max_f32 v81, 0, v81
    v_max_f32 v82, 0, v82
    v_max_f32 v83, 0, v83
    v_max_f32 v84, 0, v84
    v_max_f32 v85, 0, v85
    v_max_f32 v86, 0, v86
    v_max_f32 v87, 0, v87
    v_pk_mul_f32 v[80:81], v[80:81], v[80:81]
    v_pk_mul_f32 v[82:83], v[82:83], v[82:83]
    v_pk_mul_f32 v[84:85], v[84:85], v[84:85]
    v_pk_mul_f32 v[86:87], v[86:87], v[86:87]
    v_cvt_pk_bf16_f32 v74, v80, v81
    v_cvt_pk_bf16_f32 v75, v82, v83
    s_cmp_eq_u32 s76, 1
    s_cbranch_scc0 L_ss9
    buffer_store_dwordx4 v[72:75], v11, s[56:59], s41 offen offset:0
L_sb9:
    v_cvt_pk_bf16_f32 v78, v84, v85
    v_cvt_pk_bf16_f32 v79, v86, v87
    s_cmp_eq_u32 s76, 1
    s_cbranch_scc0 L_ss10
    buffer_store_dwordx4 v[76:79], v11, s[56:59], s41 offen offset:1024
L_sb10:
    v_cvt_pk_bf16_f32 v88, v24, v25
    v_cvt_pk_bf16_f32 v89, v26, v27
    v_cvt_pk_bf16_f32 v90, v32, v33
    v_cvt_pk_bf16_f32 v91, v34, v35
    v_cvt_pk_bf16_f32 v92, v28, v29
    v_cvt_pk_bf16_f32 v93, v30, v31
    v_cvt_pk_bf16_f32 v94, v36, v37
    v_cvt_pk_bf16_f32 v95, v38, v39
    v_mfma_f32_16x16x32_bf16 v[56:59], v[200:203], v[88:91], 0
    v_mfma_f32_16x16x32_bf16 v[60:63], v[204:207], v[88:91], 0
    v_mfma_f32_16x16x32_bf16 v[64:67], v[200:203], v[92:95], 0
    v_mfma_f32_16x16x32_bf16 v[68:71], v[204:207], v[92:95], 0
    s_add_u32 m0, s88, 98304
    s_nop 0
    buffer_load_dwordx4 v5, s[36:39], s68 offen lds
    s_add_u32 m0, s88, 99328
    s_nop 0
    buffer_load_dwordx4 v6, s[36:39], s68 offen lds
    s_add_u32 m0, s88, 100352
    s_nop 0
    buffer_load_dwordx4 v7, s[36:39], s68 offen lds
    s_add_u32 m0, s88, 101376
    s_nop 0
    buffer_load_dwordx4 v8, s[36:39], s68 offen lds
    s_add_u32 s68, s68, 0x40000
    v_max3_f32 v72, v56, v57, v58
    v_max3_f32 v73, -v56, -v57, -v58
    v_max3_f32 v74, v64, v65, v66
    v_max3_f32 v75, -v64, -v65, -v66
    v_max3_f32 v72, v72, v59, v60
    v_max3_f32 v73, v73, -v59, -v60
    v_max3_f32 v74, v74, v67, v68
    v_max3_f32 v75, v75, -v67, -v68
    v_max3_f32 v72, v72, v61, v62
    v_max3_f32 v73, v73, -v61, -v62
    v_max3_f32 v74, v74, v69, v70
    v_max3_f32 v75, v75, -v69, -v70
    v_max_f32 v88, v72, v63
    v_max_f32_e64 v90, v73, -v63
    v_max_f32 v92, v74, v71
    v_max_f32_e64 v94, v75, -v71
    s_nop 0
    v_permlane32_swap_b32 v88, v92
    v_permlane32_swap_b32 v90, v94
    v_max_f32 v88, v88, v92
    v_max_f32 v90, v90, v94
    s_nop 1
    v_permlane16_swap_b32 v88, v90
    v_max_f32 v88, v88, v90
    v_mul_f32 v88, v88, v225
    v_mov_b32 v90, v88
    s_add_u32 m0, s88, 131072
    s_nop 0
    buffer_load_dwordx4 v5, s[36:39], s68 offen lds
    v_permlane16_swap_b32 v88, v90
    v_mov_b32 v92, v88
    v_mov_b32 v94, v90
    s_nop 0
    v_permlane32_swap_b32 v88, v92
    v_permlane32_swap_b32 v90, v94
    v_mov_b32 v89, v88
    s_add_u32 m0, s88, 132096
    s_nop 0
    buffer_load_dwordx4 v6, s[36:39], s68 offen lds
    v_mov_b32 v93, v92
    v_mov_b32 v91, v90
    v_mov_b32 v95, v94
    v_pk_fma_f32 v[72:73], v[56:57], v[226:227], v[88:89]
    v_pk_fma_f32 v[80:81], v[64:65], v[228:229], v[92:93]
    v_pk_fma_f32 v[56:57], v[56:57], v[230:231], v[90:91]
    s_add_u32 m0, s88, 133120
    s_nop 0
    buffer_load_dwordx4 v7, s[36:39], s68 offen lds
    v_pk_fma_f32 v[64:65], v[64:65], v[244:245], v[94:95]
    v_pk_fma_f32 v[74:75], v[58:59], v[226:227], v[88:89]
    v_pk_fma_f32 v[82:83], v[66:67], v[228:229], v[92:93]
    v_pk_fma_f32 v[58:59], v[58:59], v[230:231], v[90:91]
    v_pk_fma_f32 v[66:67], v[66:67], v[244:245], v[94:95]
    v_pk_fma_f32 v[76:77], v[60:61], v[226:227], v[88:89]
    s_add_u32 m0, s88, 134144
    s_nop 0
    buffer_load_dwordx4 v8, s[36:39], s68 offen lds
    s_add_u32 s68, s68, 0x40000
    v_pk_fma_f32 v[84:85], v[68:69], v[228:229], v[92:93]
    v_pk_fma_f32 v[60:61], v[60:61], v[230:231], v[90:91]
    v_pk_fma_f32 v[68:69], v[68:69], v[244:245], v[94:95]
    v_pk_fma_f32 v[78:79], v[62:63], v[226:227], v[88:89]
    v_pk_fma_f32 v[86:87], v[70:71], v[228:229], v[92:93]
    v_pk_fma_f32 v[62:63], v[62:63], v[230:231], v[90:91]
    s_waitcnt vmcnt(8)
    s_cmp_eq_u32 s76, 1
    s_cbranch_scc0 L_ss11
    buffer_store_dword v23, v21, s[56:59], s81 offen
L_sb11:
    v_pk_fma_f32 v[70:71], v[70:71], v[244:245], v[94:95]
    v_exp_f32 v72, v72
    v_exp_f32 v56, v56
    v_exp_f32 v80, v80
    v_exp_f32 v64, v64
    v_exp_f32 v73, v73
    v_exp_f32 v57, v57
    v_exp_f32 v81, v81
    v_exp_f32 v65, v65
    v_exp_f32 v74, v74
    v_exp_f32 v58, v58
    v_exp_f32 v82, v82
    v_exp_f32 v66, v66
    v_cvt_pk_bf16_f32 v168, v72, v73
    v_cvt_pk_bf16_f32 v172, v56, v57
    v_cvt_pk_bf16_f32 v176, v80, v81
    v_cvt_pk_bf16_f32 v180, v64, v65
    v_exp_f32 v75, v75
    v_exp_f32 v59, v59
    v_exp_f32 v83, v83
    v_exp_f32 v67, v67
    v_exp_f32 v76, v76
    v_exp_f32 v60, v60
    v_exp_f32 v84, v84
    v_exp_f32 v68, v68
    v_cvt_pk_bf16_f32 v169, v74, v75
    v_cvt_pk_bf16_f32 v173, v58, v59
    v_cvt_pk_bf16_f32 v177, v82, v83
    v_cvt_pk_bf16_f32 v181, v66, v67
    v_exp_f32 v77, v77
    v_exp_f32 v61, v61
    v_exp_f32 v85, v85
    v_exp_f32 v69, v69
    v_exp_f32 v78, v78
    v_exp_f32 v62, v62
    v_exp_f32 v86, v86
    v_exp_f32 v70, v70
    v_cvt_pk_bf16_f32 v170, v76, v77
    v_cvt_pk_bf16_f32 v174, v60, v61
    v_cvt_pk_bf16_f32 v178, v84, v85
    v_cvt_pk_bf16_f32 v182, v68, v69
    v_exp_f32 v79, v79
    v_exp_f32 v63, v63
    v_exp_f32 v87, v87
    v_exp_f32 v71, v71
    v_cvt_pk_bf16_f32 v171, v78, v79
    v_cvt_pk_bf16_f32 v175, v62, v63
    v_cvt_pk_bf16_f32 v179, v86, v87
    v_cvt_pk_bf16_f32 v183, v70, v71
    v_cvt_pk_bf16_f32 v88, v40, v41
    v_cvt_pk_bf16_f32 v89, v42, v43
    v_cvt_pk_bf16_f32 v90, v48, v49
    v_cvt_pk_bf16_f32 v91, v50, v51
    s_add_u32 m0, s88, 32768
    s_nop 0
    buffer_load_dwordx4 v5, s[36:39], s68 offen lds
    v_cvt_pk_bf16_f32 v92, v44, v45
    v_cvt_pk_bf16_f32 v93, v46, v47
    v_cvt_pk_bf16_f32 v94, v52, v53
    v_cvt_pk_bf16_f32 v95, v54, v55
    v_mfma_f32_16x16x32_bf16 v[56:59], v[208:211], v[88:91], 0
    v_mfma_f32_16x16x32_bf16 v[60:63], v[212:215], v[88:91], 0
    s_add_u32 m0, s88, 33792
    s_nop 0
    buffer_load_dwordx4 v6, s[36:39], s68 offen lds
    v_mfma_f32_16x16x32_bf16 v[64:67], v[208:211], v[92:95], 0
    v_mfma_f32_16x16x32_bf16 v[68:71], v[212:215], v[92:95], 0
    s_nop 1
    v_max3_f32 v72, v56, v57, v58
    v_max3_f32 v73, -v56, -v57, -v58
    s_nop 2
    v_max3_f32 v74, v64, v65, v66
    s_add_u32 m0, s88, 34816
    s_nop 0
    buffer_load_dwordx4 v7, s[36:39], s68 offen lds
    v_max3_f32 v75, -v64, -v65, -v66
    v_max3_f32 v72, v72, v59, v60
    v_max3_f32 v73, v73, -v59, -v60
    v_max3_f32 v74, v74, v67, v68
    v_max3_f32 v75, v75, -v67, -v68
    v_max3_f32 v72, v72, v61, v62
    s_add_u32 m0, s88, 35840
    s_nop 0
    buffer_load_dwordx4 v8, s[36:39], s68 offen lds
    s_add_u32 s68, s68, 0x40000
    v_max3_f32 v73, v73, -v61, -v62
    v_max3_f32 v74, v74, v69, v70
    v_max3_f32 v75, v75, -v69, -v70
    v_max_f32 v88, v72, v63
    v_max_f32_e64 v90, v73, -v63
    v_max_f32 v92, v74, v71
    s_add_u32 m0, s88, 65536
    s_nop 0
    buffer_load_dwordx4 v5, s[36:39], s68 offen lds
    v_max_f32_e64 v94, v75, -v71
    v_permlane32_swap_b32 v88, v92
    s_nop 0
    v_permlane32_swap_b32 v90, v94
    v_max_f32 v88, v88, v92
    v_max_f32 v90, v90, v94
    s_nop 1
    v_permlane16_swap_b32 v88, v90
    s_add_u32 m0, s88, 66560
    s_nop 0
    buffer_load_dwordx4 v6, s[36:39], s68 offen lds
    v_max_f32 v88, v88, v90
    v_mul_f32 v88, v88, v225
    v_mov_b32 v90, v88
    s_nop 1
    v_permlane16_swap_b32 v88, v90
    v_mov_b32 v92, v88
    v_mov_b32 v94, v90
    s_add_u32 m0, s88, 67584
    s_nop 0
    buffer_load_dwordx4 v7, s[36:39], s68 offen lds
    v_permlane32_swap_b32 v88, v92
    buffer_load_dword v22, v10, s[56:59], s87 offen sc1
    v_permlane32_swap_b32 v90, v94
    v_mov_b32 v89, v88
    v_mov_b32 v93, v92
    v_mov_b32 v91, v90
    v_mov_b32 v95, v94
    s_add_u32 m0, s88, 68608
    s_nop 0
    buffer_load_dwordx4 v8, s[36:39], s68 offen lds
    s_add_u32 s68, s68, 0x40000
    v_pk_fma_f32 v[72:73], v[56:57], v[226:227], v[88:89]
    v_pk_fma_f32 v[80:81], v[64:65], v[228:229], v[92:93]
    v_pk_fma_f32 v[56:57], v[56:57], v[230:231], v[90:91]
    v_pk_fma_f32 v[64:65], v[64:65], v[244:245], v[94:95]
    v_pk_fma_f32 v[74:75], v[58:59], v[226:227], v[88:89]
    v_pk_fma_f32 v[82:83], v[66:67], v[228:229], v[92:93]
    v_pk_fma_f32 v[58:59], v[58:59], v[230:231], v[90:91]
    v_pk_fma_f32 v[66:67], v[66:67], v[244:245], v[94:95]
    v_pk_fma_f32 v[76:77], v[60:61], v[226:227], v[88:89]
    v_pk_fma_f32 v[84:85], v[68:69], v[228:229], v[92:93]
    v_pk_fma_f32 v[60:61], v[60:61], v[230:231], v[90:91]
    v_pk_fma_f32 v[68:69], v[68:69], v[244:245], v[94:95]
    v_pk_fma_f32 v[78:79], v[62:63], v[226:227], v[88:89]
    v_pk_fma_f32 v[86:87], v[70:71], v[228:229], v[92:93]
    v_pk_fma_f32 v[62:63], v[62:63], v[230:231], v[90:91]
    v_pk_fma_f32 v[70:71], v[70:71], v[244:245], v[94:95]
    v_exp_f32 v72, v72
    v_exp_f32 v56, v56
    v_exp_f32 v80, v80
    v_exp_f32 v64, v64
    v_exp_f32 v73, v73
    v_exp_f32 v57, v57
    v_exp_f32 v81, v81
    v_exp_f32 v65, v65
    v_exp_f32 v74, v74
    v_exp_f32 v58, v58
    v_exp_f32 v82, v82
    v_exp_f32 v66, v66
    v_cvt_pk_bf16_f32 v184, v72, v73
    v_cvt_pk_bf16_f32 v188, v56, v57
    v_cvt_pk_bf16_f32 v192, v80, v81
    v_cvt_pk_bf16_f32 v196, v64, v65
    v_exp_f32 v75, v75
    v_exp_f32 v59, v59
    v_exp_f32 v83, v83
    v_exp_f32 v67, v67
    v_exp_f32 v76, v76
    v_exp_f32 v60, v60
    v_exp_f32 v84, v84
    v_exp_f32 v68, v68
    v_cvt_pk_bf16_f32 v185, v74, v75
    v_cvt_pk_bf16_f32 v189, v58, v59
    v_cvt_pk_bf16_f32 v193, v82, v83
    v_cvt_pk_bf16_f32 v197, v66, v67
    v_exp_f32 v77, v77
    v_exp_f32 v61, v61
    v_exp_f32 v85, v85
    v_exp_f32 v69, v69
    v_exp_f32 v78, v78
    v_exp_f32 v62, v62
    v_exp_f32 v86, v86
    v_exp_f32 v70, v70
    v_cvt_pk_bf16_f32 v186, v76, v77
    v_cvt_pk_bf16_f32 v190, v60, v61
    v_cvt_pk_bf16_f32 v194, v84, v85
    v_cvt_pk_bf16_f32 v198, v68, v69
    v_exp_f32 v79, v79
    v_exp_f32 v63, v63
    v_exp_f32 v87, v87
    v_exp_f32 v71, v71
    v_cvt_pk_bf16_f32 v187, v78, v79
    v_cvt_pk_bf16_f32 v191, v62, v63
    v_cvt_pk_bf16_f32 v195, v86, v87
    v_cvt_pk_bf16_f32 v199, v70, v71
    s_waitcnt vmcnt(1)
    v_cmp_eq_u32 vcc, 0, v22
    s_mov_b32 s34, 0
    s_cbranch_vccz L_go1Q
L_poll1Q:
    buffer_load_dword v22, v10, s[56:59], s87 offen offset:0 sc1
    s_add_u32 s34, s34, 1
    s_waitcnt vmcnt(0)
    v_cmp_eq_u32 vcc, 0, v22
    s_cmp_gt_u32 s34, 200000
    s_cbranch_scc1 L_go1Q
    s_cbranch_vccnz L_poll1Q
L_go1Q:
    buffer_load_dwordx4 v[120:123], v9, s[44:47], s90 offen offset:0 sc1
    buffer_load_dwordx4 v[124:127], v9, s[44:47], s90 offen offset:1024 sc1
    s_add_u32 s90, s90, 0x20000
    buffer_load_dwordx4 v[128:131], v9, s[44:47], s90 offen offset:0 sc1
    buffer_load_dwordx4 v[132:135], v9, s[44:47], s90 offen offset:1024 sc1
    s_add_u32 s90, s90, 0x20000
    buffer_load_dwordx4 v[136:139], v9, s[44:47], s90 offen offset:0 sc1
    buffer_load_dwordx4 v[140:143], v9, s[44:47], s90 offen offset:1024 sc1
    s_add_u32 s90, s90, 0x20000
    buffer_load_dwordx4 v[144:147], v9, s[44:47], s90 offen offset:0 sc1
    buffer_load_dwordx4 v[148:151], v9, s[44:47], s90 offen offset:1024 sc1
    s_add_u32 s90, s90, 0x20000
    buffer_load_dwordx4 v[152:155], v9, s[44:47], s90 offen offset:0 sc1
    buffer_load_dwordx4 v[156:159], v9, s[44:47], s90 offen offset:1024 sc1
    s_add_u32 s90, s90, 0x20000
    v_lshrrev_b32 v0, 2, v1
    v_lshlrev_b32 v12, 8, v0
    v_and_b32 v15, 3, v1
    v_lshl_add_u32 v12, v15, 3, v12
    v_and_b32 v0, 7, v0
    v_lshl_add_u32 v12, v0, 5, v12
    v_add_u32 v12, 98304, v12
    v_xor_b32 v13, 32, v12
    v_xor_b32 v14, 64, v12
    v_xor_b32 v15, 96, v12
    v_xor_b32 v16, 128, v12
    v_xor_b32 v17, 160, v12
    v_xor_b32 v18, 192, v12
    v_xor_b32 v19, 224, v12
    s_waitcnt vmcnt(24)
    s_barrier
    ds_read_b64_tr_b16 v[88:89], v12 offset:0
    ds_read_b64_tr_b16 v[90:91], v12 offset:4096
    ds_read_b64_tr_b16 v[92:93], v13 offset:0
    ds_read_b64_tr_b16 v[94:95], v13 offset:4096
    ds_read_b64_tr_b16 v[96:97], v14 offset:0
    ds_read_b64_tr_b16 v[98:99], v14 offset:4096
    ds_read_b64_tr_b16 v[100:101], v15 offset:0
    ds_read_b64_tr_b16 v[102:103], v15 offset:4096
    s_waitcnt vmcnt(8) lgkmcnt(6)
    v_mfma_f32_16x16x32_bf16 v[24:27], v[88:91], v[120:123], 0
    ds_read_b64_tr_b16 v[104:105], v16 offset:0
    v_mfma_f32_16x16x32_bf16 v[28:31], v[88:91], v[124:127], 0
    ds_read_b64_tr_b16 v[106:107], v16 offset:4096
    s_waitcnt lgkmcnt(6)
    v_mfma_f32_16x16x32_bf16 v[32:35], v[92:95], v[120:123], 0
    ds_read_b64_tr_b16 v[108:109], v17 offset:0
    v_mfma_f32_16x16x32_bf16 v[36:39], v[92:95], v[124:127], 0
    ds_read_b64_tr_b16 v[110:111], v17 offset:4096
    buffer_load_dwordx4 v[160:163], v9, s[44:47], s90 offen offset:0 sc1
    v_mov_b32 v0, v242
    v_mov_b32 v20, v243
    v_and_b32 v246, 1, v3
    s_waitcnt lgkmcnt(6)
    v_mfma_f32_16x16x32_bf16 v[40:43], v[96:99], v[120:123], 0
    ds_read_b64_tr_b16 v[112:113], v18 offset:0
    v_mfma_f32_16x16x32_bf16 v[44:47], v[96:99], v[124:127], 0
    ds_read_b64_tr_b16 v[114:115], v18 offset:4096
    v_lshlrev_b32 v246, 4, v246
    v_mov_b32 v247, 0x3f80
    v_lshlrev_b32 v246, v246, v247
    s_waitcnt lgkmcnt(6)
    v_mfma_f32_16x16x32_bf16 v[48:51], v[100:103], v[120:123], 0
    ds_read_b64_tr_b16 v[116:117], v19 offset:0
    v_mfma_f32_16x16x32_bf16 v[52:55], v[100:103], v[124:127], 0
    ds_read_b64_tr_b16 v[118:119], v19 offset:4096
    v_lshrrev_b32 v247, 1, v3
    v_lshlrev_b32 v250, 1, v4
    v_cmp_eq_u32 vcc, v250, v247
    s_waitcnt lgkmcnt(6)
    v_mfma_f32_16x16x32_bf16 v[56:59], v[104:107], v[120:123], 0
    ds_read_b64_tr_b16 v[88:89], v12 offset:8192
    v_mfma_f32_16x16x32_bf16 v[60:63], v[104:107], v[124:127], 0
    ds_read_b64_tr_b16 v[90:91], v12 offset:12288
    buffer_load_dwordx4 v[164:167], v9, s[44:47], s90 offen offset:1024 sc1
    s_add_u32 s90, s90, 0x20000
    v_cndmask_b32 v248, 0, v246, vcc
    v_add_u32 v250, 1, v250
    v_cmp_eq_u32 vcc, v250, v247
    s_waitcnt lgkmcnt(6)
    v_mfma_f32_16x16x32_bf16 v[64:67], v[108:111], v[120:123], 0
    ds_read_b64_tr_b16 v[92:93], v13 offset:8192
    v_mfma_f32_16x16x32_bf16 v[68:71], v[108:111], v[124:127], 0
    ds_read_b64_tr_b16 v[94:95], v13 offset:12288
    v_cndmask_b32 v249, 0, v246, vcc
    v_mov_b32 v246, 0
    v_mov_b32 v247, 0
    s_waitcnt lgkmcnt(6)
    v_mfma_f32_16x16x32_bf16 v[72:75], v[112:115], v[120:123], 0
    ds_read_b64_tr_b16 v[96:97], v14 offset:8192
    v_mfma_f32_16x16x32_bf16 v[76:79], v[112:115], v[124:127], 0
    ds_read_b64_tr_b16 v[98:99], v14 offset:12288
    v_mov_b32 v250, 0
    v_mov_b32 v251, 0
    s_lshl_b32 s85, s101, 18
    s_waitcnt lgkmcnt(6)
    v_mfma_f32_16x16x32_bf16 v[80:83], v[116:119], v[120:123], 0
    ds_read_b64_tr_b16 v[100:101], v15 offset:8192
    v_mfma_f32_16x16x32_bf16 v[84:87], v[116:119], v[124:127], 0
    ds_read_b64_tr_b16 v[102:103], v15 offset:12288
    s_add_u32 s85, s85, 18874368
    s_add_u32 s85, s85, s80
    s_lshr_b32 s31, s28, 1
    s_waitcnt vmcnt(8) lgkmcnt(6)
    v_mfma_f32_16x16x32_bf16 v[24:27], v[88:91], v[128:131], v[24:27]
    ds_read_b64_tr_b16 v[104:105], v16 offset:8192
    v_mfma_f32_16x16x32_bf16 v[28:31], v[88:91], v[132:135], v[28:31]
    ds_read_b64_tr_b16 v[106:107], v16 offset:12288
    s_mul_i32 s86, s31, 3072
    s_and_b32 s31, s28, 1
    s_lshl_b32 s31, s31, 3
    s_waitcnt lgkmcnt(6)
    v_mfma_f32_16x16x32_bf16 v[32:35], v[92:95], v[128:131], v[32:35]
    ds_read_b64_tr_b16 v[108:109], v17 offset:8192
    v_mfma_f32_16x16x32_bf16 v[36:39], v[92:95], v[132:135], v[36:39]
    ds_read_b64_tr_b16 v[110:111], v17 offset:12288
    buffer_load_dwordx4 v[120:123], v9, s[44:47], s90 offen offset:0 sc1
    s_add_u32 s86, s86, s31
    v_add_u32 v252, s86, v11
    v_lshlrev_b32 v253, 12, v10
    s_waitcnt lgkmcnt(6)
    v_mfma_f32_16x16x32_bf16 v[40:43], v[96:99], v[128:131], v[40:43]
    ds_read_b64_tr_b16 v[112:113], v18 offset:8192
    v_mfma_f32_16x16x32_bf16 v[44:47], v[96:99], v[132:135], v[44:47]
    ds_read_b64_tr_b16 v[114:115], v18 offset:12288
    v_lshl_add_u32 v253, v4, 7, v253
    v_and_b32 v254, 3, v3
    v_mov_b32 v255, 0x3f803f80
    s_waitcnt lgkmcnt(6)
    v_mfma_f32_16x16x32_bf16 v[48:51], v[100:103], v[128:131], v[48:51]
    ds_read_b64_tr_b16 v[116:117], v19 offset:8192
    v_mfma_f32_16x16x32_bf16 v[52:55], v[100:103], v[132:135], v[52:55]
    ds_read_b64_tr_b16 v[118:119], v19 offset:12288
    s_waitcnt lgkmcnt(6)
    v_mfma_f32_16x16x32_bf16 v[56:59], v[104:107], v[128:131], v[56:59]
    ds_read_b64_tr_b16 v[88:89], v12 offset:16384
    v_mfma_f32_16x16x32_bf16 v[60:63], v[104:107], v[132:135], v[60:63]
    ds_read_b64_tr_b16 v[90:91], v12 offset:20480
    buffer_load_dwordx4 v[124:127], v9, s[44:47], s90 offen offset:1024 sc1
    s_add_u32 s90, s90, 0x20000
    s_waitcnt lgkmcnt(6)
    v_mfma_f32_16x16x32_bf16 v[64:67], v[108:111], v[128:131], v[64:67]
    ds_read_b64_tr_b16 v[92:93], v13 offset:16384
    v_mfma_f32_16x16x32_bf16 v[68:71], v[108:111], v[132:135], v[68:71]
    ds_read_b64_tr_b16 v[94:95], v13 offset:20480
    s_waitcnt lgkmcnt(6)
    v_mfma_f32_16x16x32_bf16 v[72:75], v[112:115], v[128:131], v[72:75]
    ds_read_b64_tr_b16 v[96:97], v14 offset:16384
    v_mfma_f32_16x16x32_bf16 v[76:79], v[112:115], v[132:135], v[76:79]
    ds_read_b64_tr_b16 v[98:99], v14 offset:20480
    s_waitcnt lgkmcnt(6)
    v_mfma_f32_16x16x32_bf16 v[80:83], v[116:119], v[128:131], v[80:83]
    ds_read_b64_tr_b16 v[100:101], v15 offset:16384
    v_mfma_f32_16x16x32_bf16 v[84:87], v[116:119], v[132:135], v[84:87]
    ds_read_b64_tr_b16 v[102:103], v15 offset:20480
    s_waitcnt vmcnt(8) lgkmcnt(6)
    v_mfma_f32_16x16x32_bf16 v[24:27], v[88:91], v[136:139], v[24:27]
    ds_read_b64_tr_b16 v[104:105], v16 offset:16384
    v_mfma_f32_16x16x32_bf16 v[28:31], v[88:91], v[140:143], v[28:31]
    ds_read_b64_tr_b16 v[106:107], v16 offset:20480
    s_waitcnt lgkmcnt(6)
    v_mfma_f32_16x16x32_bf16 v[32:35], v[92:95], v[136:139], v[32:35]
    ds_read_b64_tr_b16 v[108:109], v17 offset:16384
    v_mfma_f32_16x16x32_bf16 v[36:39], v[92:95], v[140:143], v[36:39]
    ds_read_b64_tr_b16 v[110:111], v17 offset:20480
    buffer_load_dwordx4 v[128:131], v9, s[44:47], s90 offen offset:0 sc1
    s_waitcnt lgkmcnt(6)
    v_mfma_f32_16x16x32_bf16 v[40:43], v[96:99], v[136:139], v[40:43]
    ds_read_b64_tr_b16 v[112:113], v18 offset:16384
    v_mfma_f32_16x16x32_bf16 v[44:47], v[96:99], v[140:143], v[44:47]
    ds_read_b64_tr_b16 v[114:115], v18 offset:20480
    s_waitcnt lgkmcnt(6)
    v_mfma_f32_16x16x32_bf16 v[48:51], v[100:103], v[136:139], v[48:51]
    ds_read_b64_tr_b16 v[116:117], v19 offset:16384
    v_mfma_f32_16x16x32_bf16 v[52:55], v[100:103], v[140:143], v[52:55]
    ds_read_b64_tr_b16 v[118:119], v19 offset:20480
    s_cmp_lt_u32 s28, 4
    s_cbranch_scc1 L_skQY32
    s_waitcnt vmcnt(25)
    s_barrier
L_skQY32:
    s_waitcnt lgkmcnt(6)
    v_mfma_f32_16x16x32_bf16 v[56:59], v[104:107], v[136:139], v[56:59]
    ds_read_b64_tr_b16 v[88:89], v12 offset:24576
    v_mfma_f32_16x16x32_bf16 v[60:63], v[104:107], v[140:143], v[60:63]
    ds_read_b64_tr_b16 v[90:91], v12 offset:28672
    buffer_load_dwordx4 v[132:135], v9, s[44:47], s90 offen offset:1024 sc1
    s_add_u32 s90, s90, 0x20000
    s_waitcnt lgkmcnt(6)
    v_mfma_f32_16x16x32_bf16 v[64:67], v[108:111], v[136:139], v[64:67]
    ds_read_b64_tr_b16 v[92:93], v13 offset:24576
    v_mfma_f32_16x16x32_bf16 v[68:71], v[108:111], v[140:143], v[68:71]
    ds_read_b64_tr_b16 v[94:95], v13 offset:28672
    s_waitcnt lgkmcnt(6)
    v_mfma_f32_16x16x32_bf16 v[72:75], v[112:115], v[136:139], v[72:75]
    ds_read_b64_tr_b16 v[96:97], v14 offset:24576
    v_mfma_f32_16x16x32_bf16 v[76:79], v[112:115], v[140:143], v[76:79]
    ds_read_b64_tr_b16 v[98:99], v14 offset:28672
    s_waitcnt lgkmcnt(6)
    v_mfma_f32_16x16x32_bf16 v[80:83], v[116:119], v[136:139], v[80:83]
    ds_read_b64_tr_b16 v[100:101], v15 offset:24576
    v_mfma_f32_16x16x32_bf16 v[84:87], v[116:119], v[140:143], v[84:87]
    ds_read_b64_tr_b16 v[102:103], v15 offset:28672
    s_waitcnt vmcnt(8) lgkmcnt(6)
    v_mfma_f32_16x16x32_bf16 v[24:27], v[88:91], v[144:147], v[24:27]
    ds_read_b64_tr_b16 v[104:105], v16 offset:24576
    v_mfma_f32_16x16x32_bf16 v[28:31], v[88:91], v[148:151], v[28:31]
    ds_read_b64_tr_b16 v[106:107], v16 offset:28672
    s_waitcnt lgkmcnt(6)
    v_mfma_f32_16x16x32_bf16 v[32:35], v[92:95], v[144:147], v[32:35]
    ds_read_b64_tr_b16 v[108:109], v17 offset:24576
    v_mfma_f32_16x16x32_bf16 v[36:39], v[92:95], v[148:151], v[36:39]
    ds_read_b64_tr_b16 v[110:111], v17 offset:28672
    buffer_load_dwordx4 v[136:139], v9, s[44:47], s90 offen offset:0 sc1
    s_waitcnt lgkmcnt(6)
    v_mfma_f32_16x16x32_bf16 v[40:43], v[96:99], v[144:147], v[40:43]
    ds_read_b64_tr_b16 v[112:113], v18 offset:24576
    v_mfma_f32_16x16x32_bf16 v[44:47], v[96:99], v[148:151], v[44:47]
    ds_read_b64_tr_b16 v[114:115], v18 offset:28672
    s_waitcnt lgkmcnt(6)
    v_mfma_f32_16x16x32_bf16 v[48:51], v[100:103], v[144:147], v[48:51]
    ds_read_b64_tr_b16 v[116:117], v19 offset:24576
    v_mfma_f32_16x16x32_bf16 v[52:55], v[100:103], v[148:151], v[52:55]
    ds_read_b64_tr_b16 v[118:119], v19 offset:28672
    s_cmp_lt_u32 s28, 4
    s_cbranch_scc0 L_skQX32
    s_waitcnt vmcnt(27)
    s_barrier
L_skQX32:
    v_add_u32 v12, 32768, v12
    s_waitcnt lgkmcnt(6)
    v_mfma_f32_16x16x32_bf16 v[56:59], v[104:107], v[144:147], v[56:59]
    ds_read_b64_tr_b16 v[88:89], v12 offset:0
    v_mfma_f32_16x16x32_bf16 v[60:63], v[104:107], v[148:151], v[60:63]
    ds_read_b64_tr_b16 v[90:91], v12 offset:4096
    buffer_load_dwordx4 v[140:143], v9, s[44:47], s90 offen offset:1024 sc1
    s_add_u32 s90, s90, 0x20000
    v_add_u32 v13, 32768, v13
    s_waitcnt lgkmcnt(6)
    v_mfma_f32_16x16x32_bf16 v[64:67], v[108:111], v[144:147], v[64:67]
    ds_read_b64_tr_b16 v[92:93], v13 offset:0
    v_mfma_f32_16x16x32_bf16 v[68:71], v[108:111], v[148:151], v[68:71]
    ds_read_b64_tr_b16 v[94:95], v13 offset:4096
    v_add_u32 v14, 32768, v14
    s_waitcnt lgkmcnt(6)
    v_mfma_f32_16x16x32_bf16 v[72:75], v[112:115], v[144:147], v[72:75]
    ds_read_b64_tr_b16 v[96:97], v14 offset:0
    v_mfma_f32_16x16x32_bf16 v[76:79], v[112:115], v[148:151], v[76:79]
    ds_read_b64_tr_b16 v[98:99], v14 offset:4096
    v_add_u32 v15, 32768, v15
    s_waitcnt lgkmcnt(6)
    v_mfma_f32_16x16x32_bf16 v[80:83], v[116:119], v[144:147], v[80:83]
    ds_read_b64_tr_b16 v[100:101], v15 offset:0
    v_mfma_f32_16x16x32_bf16 v[84:87], v[116:119], v[148:151], v[84:87]
    ds_read_b64_tr_b16 v[102:103], v15 offset:4096
    v_add_u32 v16, 32768, v16
    s_waitcnt vmcnt(8) lgkmcnt(6)
    v_mfma_f32_16x16x32_bf16 v[24:27], v[88:91], v[152:155], v[24:27]
    ds_read_b64_tr_b16 v[104:105], v16 offset:0
    v_mfma_f32_16x16x32_bf16 v[28:31], v[88:91], v[156:159], v[28:31]
    ds_read_b64_tr_b16 v[106:107], v16 offset:4096
    v_add_u32 v17, 32768, v17
    s_waitcnt lgkmcnt(6)
    v_mfma_f32_16x16x32_bf16 v[32:35], v[92:95], v[152:155], v[32:35]
    ds_read_b64_tr_b16 v[108:109], v17 offset:0
    v_mfma_f32_16x16x32_bf16 v[36:39], v[92:95], v[156:159], v[36:39]
    ds_read_b64_tr_b16 v[110:111], v17 offset:4096
    buffer_load_dwordx4 v[144:147], v9, s[44:47], s90 offen offset:0 sc1
    v_add_u32 v18, 32768, v18
    s_waitcnt lgkmcnt(6)
    v_mfma_f32_16x16x32_bf16 v[40:43], v[96:99], v[152:155], v[40:43]
    ds_read_b64_tr_b16 v[112:113], v18 offset:0
    v_mfma_f32_16x16x32_bf16 v[44:47], v[96:99], v[156:159], v[44:47]
    ds_read_b64_tr_b16 v[114:115], v18 offset:4096
    v_add_u32 v19, 32768, v19
    s_waitcnt lgkmcnt(6)
    v_mfma_f32_16x16x32_bf16 v[48:51], v[100:103], v[152:155], v[48:51]
    ds_read_b64_tr_b16 v[116:117], v19 offset:0
    v_mfma_f32_16x16x32_bf16 v[52:55], v[100:103], v[156:159], v[52:55]
    ds_read_b64_tr_b16 v[118:119], v19 offset:4096
    s_waitcnt lgkmcnt(6)
    v_mfma_f32_16x16x32_bf16 v[56:59], v[104:107], v[152:155], v[56:59]
    ds_read_b64_tr_b16 v[88:89], v12 offset:8192
    v_mfma_f32_16x16x32_bf16 v[60:63], v[104:107], v[156:159], v[60:63]
    ds_read_b64_tr_b16 v[90:91], v12 offset:12288
    buffer_load_dwordx4 v[148:151], v9, s[44:47], s90 offen offset:1024 sc1
    s_add_u32 s90, s90, 0x20000
    buffer_load_dwordx2 v[244:245], v253, s[56:59], s84 offen offset:1024 sc1
    s_add_u32 s31, s84, 0
    buffer_load_dwordx4 v[200:203], v11, s[56:59], s31 offen sc1
    s_add_u32 s31, s84, 16384
    buffer_load_dwordx4 v[204:207], v11, s[56:59], s31 offen sc1
    s_waitcnt lgkmcnt(6)
    v_mfma_f32_16x16x32_bf16 v[64:67], v[108:111], v[152:155], v[64:67]
    ds_read_b64_tr_b16 v[92:93], v13 offset:8192
    v_mfma_f32_16x16x32_bf16 v[68:71], v[108:111], v[156:159], v[68:71]
    ds_read_b64_tr_b16 v[94:95], v13 offset:12288
    s_add_u32 s31, s84, 32768
    buffer_load_dwordx4 v[208:211], v11, s[56:59], s31 offen sc1
    s_add_u32 s31, s84, 49152
    buffer_load_dwordx4 v[212:215], v11, s[56:59], s31 offen sc1
    s_waitcnt lgkmcnt(6)
    v_mfma_f32_16x16x32_bf16 v[72:75], v[112:115], v[152:155], v[72:75]
    ds_read_b64_tr_b16 v[96:97], v14 offset:8192
    v_mfma_f32_16x16x32_bf16 v[76:79], v[112:115], v[156:159], v[76:79]
    ds_read_b64_tr_b16 v[98:99], v14 offset:12288
    s_add_u32 s31, s84, 65536
    buffer_load_dwordx4 v[216:219], v11, s[56:59], s31 offen sc1
    s_add_u32 s31, s84, 81920
    buffer_load_dwordx4 v[220:223], v11, s[56:59], s31 offen sc1
    s_waitcnt lgkmcnt(6)
    v_mfma_f32_16x16x32_bf16 v[80:83], v[116:119], v[152:155], v[80:83]
    ds_read_b64_tr_b16 v[100:101], v15 offset:8192
    v_mfma_f32_16x16x32_bf16 v[84:87], v[116:119], v[156:159], v[84:87]
    ds_read_b64_tr_b16 v[102:103], v15 offset:12288
    s_add_u32 s31, s84, 98304
    buffer_load_dwordx4 v[224:227], v11, s[56:59], s31 offen sc1
    s_add_u32 s31, s84, 114688
    buffer_load_dwordx4 v[228:231], v11, s[56:59], s31 offen sc1
    s_waitcnt vmcnt(17) lgkmcnt(6)
    v_mfma_f32_16x16x32_bf16 v[24:27], v[88:91], v[160:163], v[24:27]
    ds_read_b64_tr_b16 v[104:105], v16 offset:8192
    v_mfma_f32_16x16x32_bf16 v[28:31], v[88:91], v[164:167], v[28:31]
    ds_read_b64_tr_b16 v[106:107], v16 offset:12288
    s_waitcnt lgkmcnt(6)
    v_mfma_f32_16x16x32_bf16 v[32:35], v[92:95], v[160:163], v[32:35]
    ds_read_b64_tr_b16 v[108:109], v17 offset:8192
    v_mfma_f32_16x16x32_bf16 v[36:39], v[92:95], v[164:167], v[36:39]
    ds_read_b64_tr_b16 v[110:111], v17 offset:12288
    buffer_load_dwordx4 v[152:155], v9, s[44:47], s90 offen offset:0 sc1
    s_waitcnt lgkmcnt(6)
    v_mfma_f32_16x16x32_bf16 v[40:43], v[96:99], v[160:163], v[40:43]
    ds_read_b64_tr_b16 v[112:113], v18 offset:8192
    v_mfma_f32_16x16x32_bf16 v[44:47], v[96:99], v[164:167], v[44:47]
    ds_read_b64_tr_b16 v[114:115], v18 offset:12288
    s_waitcnt lgkmcnt(6)
    v_mfma_f32_16x16x32_bf16 v[48:51], v[100:103], v[160:163], v[48:51]
    ds_read_b64_tr_b16 v[116:117], v19 offset:8192
    v_mfma_f32_16x16x32_bf16 v[52:55], v[100:103], v[164:167], v[52:55]
    ds_read_b64_tr_b16 v[118:119], v19 offset:12288
    s_waitcnt lgkmcnt(6)
    v_mfma_f32_16x16x32_bf16 v[56:59], v[104:107], v[160:163], v[56:59]
    ds_read_b64_tr_b16 v[88:89], v12 offset:16384
    v_mfma_f32_16x16x32_bf16 v[60:63], v[104:107], v[164:167], v[60:63]
    ds_read_b64_tr_b16 v[90:91], v12 offset:20480
    buffer_load_dwordx4 v[156:159], v9, s[44:47], s90 offen offset:1024 sc1
    s_add_u32 s90, s90, 0x20000
    s_waitcnt lgkmcnt(6)
    v_mfma_f32_16x16x32_bf16 v[64:67], v[108:111], v[160:163], v[64:67]
    ds_read_b64_tr_b16 v[92:93], v13 offset:16384
    v_mfma_f32_16x16x32_bf16 v[68:71], v[108:111], v[164:167], v[68:71]
    ds_read_b64_tr_b16 v[94:95], v13 offset:20480
    s_waitcnt lgkmcnt(6)
    v_mfma_f32_16x16x32_bf16 v[72:75], v[112:115], v[160:163], v[72:75]
    ds_read_b64_tr_b16 v[96:97], v14 offset:16384
    v_mfma_f32_16x16x32_bf16 v[76:79], v[112:115], v[164:167], v[76:79]
    ds_read_b64_tr_b16 v[98:99], v14 offset:20480
    s_waitcnt lgkmcnt(6)
    v_mfma_f32_16x16x32_bf16 v[80:83], v[116:119], v[160:163], v[80:83]
    ds_read_b64_tr_b16 v[100:101], v15 offset:16384
    v_mfma_f32_16x16x32_bf16 v[84:87], v[116:119], v[164:167], v[84:87]
    ds_read_b64_tr_b16 v[102:103], v15 offset:20480
    s_waitcnt vmcnt(17) lgkmcnt(6)
    v_mfma_f32_16x16x32_bf16 v[24:27], v[88:91], v[120:123], v[24:27]
    ds_read_b64_tr_b16 v[104:105], v16 offset:16384
    v_mfma_f32_16x16x32_bf16 v[28:31], v[88:91], v[124:127], v[28:31]
    ds_read_b64_tr_b16 v[106:107], v16 offset:20480
    s_waitcnt lgkmcnt(6)
    v_mfma_f32_16x16x32_bf16 v[32:35], v[92:95], v[120:123], v[32:35]
    ds_read_b64_tr_b16 v[108:109], v17 offset:16384
    v_mfma_f32_16x16x32_bf16 v[36:39], v[92:95], v[124:127], v[36:39]
    ds_read_b64_tr_b16 v[110:111], v17 offset:20480
    buffer_load_dwordx4 v[160:163], v9, s[44:47], s90 offen offset:0 sc1
    s_waitcnt lgkmcnt(6)
    v_mfma_f32_16x16x32_bf16 v[40:43], v[96:99], v[120:123], v[40:43]
    ds_read_b64_tr_b16 v[112:113], v18 offset:16384
    v_mfma_f32_16x16x32_bf16 v[44:47], v[96:99], v[124:127], v[44:47]
    ds_read_b64_tr_b16 v[114:115], v18 offset:20480
    s_waitcnt vmcnt(3)
    v_max3_u32 v240, v200, v201, v202
    v_max3_u32 v241, v203, v204, v205
    v_max3_u32 v240, v240, v206, v207
    v_max3_u32 v241, v241, v208, v209
    v_max3_u32 v240, v240, v210, v211
    v_max3_u32 v241, v241, v212, v213
    v_max3_u32 v240, v240, v214, v215
    v_max3_u32 v241, v241, v216, v217
    v_max3_u32 v240, v240, v218, v219
    v_max3_u32 v241, v241, v220, v221
    v_max3_u32 v240, v240, v222, v223
    v_max3_u32 v241, v241, v224, v225
    v_max3_u32 v240, v240, v226, v227
    v_max3_u32 v241, v241, v228, v229
    v_max3_u32 v240, v240, v230, v231
    v_max3_u32 v241, v241, v244, v245
    v_max_u32 v240, v240, v241
    v_cmp_eq_u32 vcc, -1, v240
    s_mov_b32 s34, 0
    s_cbranch_vccz L_goK
L_pollK:
    buffer_load_dwordx2 v[244:245], v253, s[56:59], s84 offen offset:1024 sc1
    s_add_u32 s31, s84, 0
    buffer_load_dwordx4 v[200:203], v11, s[56:59], s31 offen sc1
    s_add_u32 s31, s84, 16384
    buffer_load_dwordx4 v[204:207], v11, s[56:59], s31 offen sc1
    s_add_u32 s31, s84, 32768
    buffer_load_dwordx4 v[208:211], v11, s[56:59], s31 offen sc1
    s_add_u32 s31, s84, 49152
    buffer_load_dwordx4 v[212:215], v11, s[56:59], s31 offen sc1
    s_add_u32 s31, s84, 65536
    buffer_load_dwordx4 v[216:219], v11, s[56:59], s31 offen sc1
    s_add_u32 s31, s84, 81920
    buffer_load_dwordx4 v[220:223], v11, s[56:59], s31 offen sc1
    s_add_u32 s31, s84, 98304
    buffer_load_dwordx4 v[224:227], v11, s[56:59], s31 offen sc1
    s_add_u32 s31, s84, 114688
    buffer_load_dwordx4 v[228:231], v11, s[56:59], s31 offen sc1
    s_add_u32 s34, s34, 1
    s_waitcnt vmcnt(0)
    v_max3_u32 v240, v200, v201, v202
    v_max3_u32 v241, v203, v204, v205
    v_max3_u32 v240, v240, v206, v207
    v_max3_u32 v241, v241, v208, v209
    v_max3_u32 v240, v240, v210, v211
    v_max3_u32 v241, v241, v212, v213
    v_max3_u32 v240, v240, v214, v215
    v_max3_u32 v241, v241, v216, v217
    v_max3_u32 v240, v240, v218, v219
    v_max3_u32 v241, v241, v220, v221
    v_max3_u32 v240, v240, v222, v223
    v_max3_u32 v241, v241, v224, v225
    v_max3_u32 v240, v240, v226, v227
    v_max3_u32 v241, v241, v228, v229
    v_max3_u32 v240, v240, v230, v231
    v_max3_u32 v241, v241, v244, v245
    v_max_u32 v240, v240, v241
    v_cmp_eq_u32 vcc, -1, v240
    s_cmp_gt_u32 s34, 4000
    s_cbranch_scc1 L_goK
    s_cbranch_vccnz L_pollK
L_goK:
    v_lshlrev_b32 v240, 16, v244
    v_and_b32 v241, 0xffff0000, v244
    v_lshlrev_b32 v242, 16, v245
    s_waitcnt lgkmcnt(6)
    v_mfma_f32_16x16x32_bf16 v[48:51], v[100:103], v[120:123], v[48:51]
    ds_read_b64_tr_b16 v[116:117], v19 offset:16384
    v_mfma_f32_16x16x32_bf16 v[52:55], v[100:103], v[124:127], v[52:55]
    ds_read_b64_tr_b16 v[118:119], v19 offset:20480
    v_and_b32 v243, 0xffff0000, v245
    v_mfma_f32_16x16x32_bf16 v[232:235], v[248:251], v[200:203], 0
    v_mfma_f32_16x16x32_bf16 v[236:239], v[246:249], v[200:203], 0
    v_add_f32_dpp v240, v240, v240 row_ror:1 row_mask:0xf bank_mask:0xf
    v_add_f32_dpp v241, v241, v241 row_ror:1 row_mask:0xf bank_mask:0xf
    s_cmp_lt_u32 s28, 4
    s_cbranch_scc1 L_skQY64
    s_waitcnt vmcnt(37)
    s_barrier
L_skQY64:
    s_waitcnt lgkmcnt(6)
    v_mfma_f32_16x16x32_bf16 v[56:59], v[104:107], v[120:123], v[56:59]
    ds_read_b64_tr_b16 v[88:89], v12 offset:24576
    v_mfma_f32_16x16x32_bf16 v[60:63], v[104:107], v[124:127], v[60:63]
    ds_read_b64_tr_b16 v[90:91], v12 offset:28672
    buffer_load_dwordx4 v[164:167], v9, s[44:47], s90 offen offset:1024 sc1
    s_add_u32 s90, s90, 0x20000
    v_add_f32_dpp v242, v242, v242 row_ror:1 row_mask:0xf bank_mask:0xf
    v_mfma_f32_16x16x32_bf16 v[232:235], v[248:251], v[204:207], v[232:235]
    v_mfma_f32_16x16x32_bf16 v[236:239], v[246:249], v[204:207], v[236:239]
    v_add_f32_dpp v243, v243, v243 row_ror:1 row_mask:0xf bank_mask:0xf
    v_add_f32_dpp v240, v240, v240 row_ror:2 row_mask:0xf bank_mask:0xf
    s_waitcnt lgkmcnt(6)
    v_mfma_f32_16x16x32_bf16 v[64:67], v[108:111], v[120:123], v[64:67]
    ds_read_b64_tr_b16 v[92:93], v13 offset:24576
    v_mfma_f32_16x16x32_bf16 v[68:71], v[108:111], v[124:127], v[68:71]
    ds_read_b64_tr_b16 v[94:95], v13 offset:28672
    v_add_f32_dpp v241, v241, v241 row_ror:2 row_mask:0xf bank_mask:0xf
    v_mfma_f32_16x16x32_bf16 v[232:235], v[248:251], v[208:211], v[232:235]
    v_mfma_f32_16x16x32_bf16 v[236:239], v[246:249], v[208:211], v[236:239]
    v_add_f32_dpp v242, v242, v242 row_ror:2 row_mask:0xf bank_mask:0xf
    v_add_f32_dpp v243, v243, v243 row_ror:2 row_mask:0xf bank_mask:0xf
    s_waitcnt lgkmcnt(6)
    v_mfma_f32_16x16x32_bf16 v[72:75], v[112:115], v[120:123], v[72:75]
    ds_read_b64_tr_b16 v[96:97], v14 offset:24576
    v_mfma_f32_16x16x32_bf16 v[76:79], v[112:115], v[124:127], v[76:79]
    ds_read_b64_tr_b16 v[98:99], v14 offset:28672
    v_add_f32_dpp v240, v240, v240 row_ror:4 row_mask:0xf bank_mask:0xf
    v_mfma_f32_16x16x32_bf16 v[232:235], v[248:251], v[212:215], v[232:235]
    v_mfma_f32_16x16x32_bf16 v[236:239], v[246:249], v[212:215], v[236:239]
    v_add_f32_dpp v241, v241, v241 row_ror:4 row_mask:0xf bank_mask:0xf
    v_add_f32_dpp v242, v242, v242 row_ror:4 row_mask:0xf bank_mask:0xf
    s_waitcnt lgkmcnt(6)
    v_mfma_f32_16x16x32_bf16 v[80:83], v[116:119], v[120:123], v[80:83]
    ds_read_b64_tr_b16 v[100:101], v15 offset:24576
    v_mfma_f32_16x16x32_bf16 v[84:87], v[116:119], v[124:127], v[84:87]
    ds_read_b64_tr_b16 v[102:103], v15 offset:28672
    v_add_f32_dpp v243, v243, v243 row_ror:4 row_mask:0xf bank_mask:0xf
    v_mfma_f32_16x16x32_bf16 v[232:235], v[248:251], v[216:219], v[232:235]
    v_mfma_f32_16x16x32_bf16 v[236:239], v[246:249], v[216:219], v[236:239]
    v_cvt_pk_bf16_f32 v244, v240, v241
    v_cvt_pk_bf16_f32 v245, v242, v243
    s_waitcnt vmcnt(17) lgkmcnt(6)
    v_mfma_f32_16x16x32_bf16 v[24:27], v[88:91], v[128:131], v[24:27]
    ds_read_b64_tr_b16 v[104:105], v16 offset:24576
    v_mfma_f32_16x16x32_bf16 v[28:31], v[88:91], v[132:135], v[28:31]
    ds_read_b64_tr_b16 v[106:107], v16 offset:28672
    v_cmp_eq_u32 vcc, 1, v254
    v_mfma_f32_16x16x32_bf16 v[232:235], v[248:251], v[220:223], v[232:235]
    v_mfma_f32_16x16x32_bf16 v[236:239], v[246:249], v[220:223], v[236:239]
    v_cndmask_b32 v244, v244, v255, vcc
    v_cndmask_b32 v245, v245, v255, vcc
    s_waitcnt lgkmcnt(6)
    v_mfma_f32_16x16x32_bf16 v[32:35], v[92:95], v[128:131], v[32:35]
    ds_read_b64_tr_b16 v[108:109], v17 offset:24576
    v_mfma_f32_16x16x32_bf16 v[36:39], v[92:95], v[132:135], v[36:39]
    ds_read_b64_tr_b16 v[110:111], v17 offset:28672
    buffer_load_dwordx4 v[120:123], v9, s[44:47], s90 offen offset:0 sc1
    ds_write_b64 v252, v[244:245] offset:2048
    v_mfma_f32_16x16x32_bf16 v[232:235], v[248:251], v[224:227], v[232:235]
    v_mfma_f32_16x16x32_bf16 v[236:239], v[246:249], v[224:227], v[236:239]
    v_mfma_f32_16x16x32_bf16 v[232:235], v[248:251], v[228:231], v[232:235]
    v_mfma_f32_16x16x32_bf16 v[236:239], v[246:249], v[228:231], v[236:239]
    s_waitcnt lgkmcnt(7)
    v_mfma_f32_16x16x32_bf16 v[40:43], v[96:99], v[128:131], v[40:43]
    ds_read_b64_tr_b16 v[112:113], v18 offset:24576
    v_mfma_f32_16x16x32_bf16 v[44:47], v[96:99], v[132:135], v[44:47]
    ds_read_b64_tr_b16 v[114:115], v18 offset:28672
    s_waitcnt lgkmcnt(7)
    v_mfma_f32_16x16x32_bf16 v[48:51], v[100:103], v[128:131], v[48:51]
    ds_read_b64_tr_b16 v[116:117], v19 offset:24576
    v_mfma_f32_16x16x32_bf16 v[52:55], v[100:103], v[132:135], v[52:55]
    ds_read_b64_tr_b16 v[118:119], v19 offset:28672
    v_cvt_pk_bf16_f32 v232, v232, v233
    v_cvt_pk_bf16_f32 v233, v234, v235
    ds_write_b64 v252, v[232:233] offset:0
    v_cvt_pk_bf16_f32 v236, v236, v237
    v_cvt_pk_bf16_f32 v237, v238, v239
    ds_write_b64 v252, v[236:237] offset:1024
    s_cmp_lt_u32 s28, 4
    s_cbranch_scc0 L_skQX64
    s_waitcnt vmcnt(39)
    s_barrier
L_skQX64:
    s_cmp_lt_u32 s28, 4
    s_cbranch_scc1 L_skQY72
    s_waitcnt lgkmcnt(0)
    s_barrier
L_skQY72:
    v_add_u32 v12, 4294868992, v12
    s_waitcnt lgkmcnt(9)
    v_mfma_f32_16x16x32_bf16 v[56:59], v[104:107], v[128:131], v[56:59]
    ds_read_b64_tr_b16 v[88:89], v12 offset:0
    v_mfma_f32_16x16x32_bf16 v[60:63], v[104:107], v[132:135], v[60:63]
    ds_read_b64_tr_b16 v[90:91], v12 offset:4096
    buffer_load_dwordx4 v[124:127], v9, s[44:47], s90 offen offset:1024 sc1
    s_add_u32 s90, s90, 0x20000
    v_add_u32 v13, 4294868992, v13
    s_waitcnt lgkmcnt(9)
    v_mfma_f32_16x16x32_bf16 v[64:67], v[108:111], v[128:131], v[64:67]
    ds_read_b64_tr_b16 v[92:93], v13 offset:0
    v_mfma_f32_16x16x32_bf16 v[68:71], v[108:111], v[132:135], v[68:71]
    ds_read_b64_tr_b16 v[94:95], v13 offset:4096
    v_add_u32 v14, 4294868992, v14
    s_waitcnt lgkmcnt(8)
    v_mfma_f32_16x16x32_bf16 v[72:75], v[112:115], v[128:131], v[72:75]
    ds_read_b64_tr_b16 v[96:97], v14 offset:0
    v_mfma_f32_16x16x32_bf16 v[76:79], v[112:115], v[132:135], v[76:79]
    ds_read_b64_tr_b16 v[98:99], v14 offset:4096
    s_add_u32 m0, s88, 98304
    s_nop 0
    buffer_load_dwordx4 v5, s[36:39], s68 offen lds
    v_add_u32 v15, 4294868992, v15
    s_waitcnt lgkmcnt(8)
    v_mfma_f32_16x16x32_bf16 v[80:83], v[116:119], v[128:131], v[80:83]
    ds_read_b64_tr_b16 v[100:101], v15 offset:0
    v_mfma_f32_16x16x32_bf16 v[84:87], v[116:119], v[132:135], v[84:87]
    ds_read_b64_tr_b16 v[102:103], v15 offset:4096
    v_add_u32 v16, 4294868992, v16
    s_waitcnt vmcnt(18) lgkmcnt(6)
    v_mfma_f32_16x16x32_bf16 v[24:27], v[88:91], v[136:139], v[24:27]
    ds_read_b64_tr_b16 v[104:105], v16 offset:0
    v_mfma_f32_16x16x32_bf16 v[28:31], v[88:91], v[140:143], v[28:31]
    ds_read_b64_tr_b16 v[106:107], v16 offset:4096
    v_add_u32 v17, 4294868992, v17
    s_waitcnt lgkmcnt(6)
    v_mfma_f32_16x16x32_bf16 v[32:35], v[92:95], v[136:139], v[32:35]
    ds_read_b64_tr_b16 v[108:109], v17 offset:0
    v_mfma_f32_16x16x32_bf16 v[36:39], v[92:95], v[140:143], v[36:39]
    ds_read_b64_tr_b16 v[110:111], v17 offset:4096
    buffer_load_dwordx4 v[128:131], v9, s[44:47], s90 offen offset:0 sc1
    v_add_u32 v18, 4294868992, v18
    s_waitcnt lgkmcnt(6)
    v_mfma_f32_16x16x32_bf16 v[40:43], v[96:99], v[136:139], v[40:43]
    ds_read_b64_tr_b16 v[112:113], v18 offset:0
    v_mfma_f32_16x16x32_bf16 v[44:47], v[96:99], v[140:143], v[44:47]
    ds_read_b64_tr_b16 v[114:115], v18 offset:4096
    s_add_u32 m0, s88, 99328
    s_nop 0
    buffer_load_dwordx4 v6, s[36:39], s68 offen lds
    v_add_u32 v19, 4294868992, v19
    s_waitcnt lgkmcnt(6)
    v_mfma_f32_16x16x32_bf16 v[48:51], v[100:103], v[136:139], v[48:51]
    ds_read_b64_tr_b16 v[116:117], v19 offset:0
    v_mfma_f32_16x16x32_bf16 v[52:55], v[100:103], v[140:143], v[52:55]
    ds_read_b64_tr_b16 v[118:119], v19 offset:4096
    s_cmp_lt_u32 s28, 4
    s_cbranch_scc0 L_skQX72
    s_waitcnt lgkmcnt(15)
    s_barrier
L_skQX72:
    s_waitcnt lgkmcnt(6)
    v_mfma_f32_16x16x32_bf16 v[56:59], v[104:107], v[136:139], v[56:59]
    ds_read_b64_tr_b16 v[88:89], v12 offset:8192
    v_mfma_f32_16x16x32_bf16 v[60:63], v[104:107], v[140:143], v[60:63]
    ds_read_b64_tr_b16 v[90:91], v12 offset:12288
    buffer_load_dwordx4 v[132:135], v9, s[44:47], s90 offen offset:1024 sc1
    s_add_u32 s90, s90, 0x20000
    ds_read_b128 v[208:211], v11 offset:2048
    ds_read_b128 v[220:223], v11 offset:5120
    s_waitcnt lgkmcnt(8)
    v_mfma_f32_16x16x32_bf16 v[64:67], v[108:111], v[136:139], v[64:67]
    ds_read_b64_tr_b16 v[92:93], v13 offset:8192
    v_mfma_f32_16x16x32_bf16 v[68:71], v[108:111], v[140:143], v[68:71]
    ds_read_b64_tr_b16 v[94:95], v13 offset:12288
    ds_read_b128 v[200:203], v11 offset:0
    ds_read_b128 v[204:207], v11 offset:1024
    s_waitcnt lgkmcnt(10)
    v_mfma_f32_16x16x32_bf16 v[72:75], v[112:115], v[136:139], v[72:75]
    ds_read_b64_tr_b16 v[96:97], v14 offset:8192
    v_mfma_f32_16x16x32_bf16 v[76:79], v[112:115], v[140:143], v[76:79]
    ds_read_b64_tr_b16 v[98:99], v14 offset:12288
    s_add_u32 m0, s88, 100352
    s_nop 0
    buffer_load_dwordx4 v7, s[36:39], s68 offen lds
    ds_read_b128 v[212:215], v11 offset:3072
    ds_read_b128 v[216:219], v11 offset:4096
    s_waitcnt lgkmcnt(12)
    v_mfma_f32_16x16x32_bf16 v[80:83], v[116:119], v[136:139], v[80:83]
    ds_read_b64_tr_b16 v[100:101], v15 offset:8192
    v_mfma_f32_16x16x32_bf16 v[84:87], v[116:119], v[140:143], v[84:87]
    ds_read_b64_tr_b16 v[102:103], v15 offset:12288
    s_waitcnt vmcnt(20) lgkmcnt(12)
    v_mfma_f32_16x16x32_bf16 v[24:27], v[88:91], v[144:147], v[24:27]
    ds_read_b64_tr_b16 v[104:105], v16 offset:8192
    v_mfma_f32_16x16x32_bf16 v[28:31], v[88:91], v[148:151], v[28:31]
    ds_read_b64_tr_b16 v[106:107], v16 offset:12288
    s_waitcnt lgkmcnt(10)
    v_mfma_f32_16x16x32_bf16 v[32:35], v[92:95], v[144:147], v[32:35]
    ds_read_b64_tr_b16 v[108:109], v17 offset:8192
    v_mfma_f32_16x16x32_bf16 v[36:39], v[92:95], v[148:151], v[36:39]
    ds_read_b64_tr_b16 v[110:111], v17 offset:12288
    buffer_load_dwordx4 v[136:139], v9, s[44:47], s90 offen offset:0 sc1
    s_waitcnt lgkmcnt(6)
    v_mfma_f32_16x16x32_bf16 v[232:235], v[208:211], v[168:171], 0
    v_mfma_f32_16x16x32_bf16 v[244:247], v[220:223], v[172:175], 0
    v_mfma_f32_16x16x32_bf16 v[224:227], v[200:203], v[168:171], 0
    s_waitcnt lgkmcnt(8)
    v_mfma_f32_16x16x32_bf16 v[40:43], v[96:99], v[144:147], v[40:43]
    ds_read_b64_tr_b16 v[112:113], v18 offset:8192
    v_mfma_f32_16x16x32_bf16 v[44:47], v[96:99], v[148:151], v[44:47]
    ds_read_b64_tr_b16 v[114:115], v18 offset:12288
    s_add_u32 m0, s88, 101376
    s_nop 0
    buffer_load_dwordx4 v8, s[36:39], s68 offen lds
    s_add_u32 s68, s68, 0x40000
    v_mfma_f32_16x16x32_bf16 v[228:231], v[204:207], v[168:171], 0
    v_mfma_f32_16x16x32_bf16 v[236:239], v[212:215], v[172:175], 0
    v_mfma_f32_16x16x32_bf16 v[240:243], v[216:219], v[172:175], 0
    s_waitcnt lgkmcnt(6)
    v_mfma_f32_16x16x32_bf16 v[48:51], v[100:103], v[144:147], v[48:51]
    ds_read_b64_tr_b16 v[116:117], v19 offset:8192
    v_mfma_f32_16x16x32_bf16 v[52:55], v[100:103], v[148:151], v[52:55]
    ds_read_b64_tr_b16 v[118:119], v19 offset:12288
    s_waitcnt lgkmcnt(6)
    v_mfma_f32_16x16x32_bf16 v[56:59], v[104:107], v[144:147], v[56:59]
    ds_read_b64_tr_b16 v[88:89], v12 offset:16384
    v_mfma_f32_16x16x32_bf16 v[60:63], v[104:107], v[148:151], v[60:63]
    ds_read_b64_tr_b16 v[90:91], v12 offset:20480
    buffer_load_dwordx4 v[140:143], v9, s[44:47], s90 offen offset:1024 sc1
    s_add_u32 s90, s90, 0x20000
    v_rcp_f32 v233, v233
    v_rcp_f32 v245, v245
    v_fmaak_f32 v232, v232, v233, 0x358637bd
    v_fmac_f32 v232, v244, v245
    s_waitcnt lgkmcnt(6)
    v_mfma_f32_16x16x32_bf16 v[64:67], v[108:111], v[144:147], v[64:67]
    ds_read_b64_tr_b16 v[92:93], v13 offset:16384
    v_mfma_f32_16x16x32_bf16 v[68:71], v[108:111], v[148:151], v[68:71]
    ds_read_b64_tr_b16 v[94:95], v13 offset:20480
    v_rcp_f32 v232, v232
    s_nop 0
    v_mul_f32 v232, v232, v0
    v_mul_f32 v246, v245, v232
    v_mul_f32 v247, v245, v232
    s_waitcnt lgkmcnt(6)
    v_mfma_f32_16x16x32_bf16 v[72:75], v[112:115], v[144:147], v[72:75]
    ds_read_b64_tr_b16 v[96:97], v14 offset:16384
    v_mfma_f32_16x16x32_bf16 v[76:79], v[112:115], v[148:151], v[76:79]
    ds_read_b64_tr_b16 v[98:99], v14 offset:20480
    v_mul_f32 v244, v233, v232
    v_mul_f32 v245, v233, v232
    v_pk_mul_f32 v[224:225], v[224:225], v[244:245]
    v_pk_mul_f32 v[226:227], v[226:227], v[244:245]
    s_waitcnt lgkmcnt(6)
    v_mfma_f32_16x16x32_bf16 v[80:83], v[116:119], v[144:147], v[80:83]
    ds_read_b64_tr_b16 v[100:101], v15 offset:16384
    v_mfma_f32_16x16x32_bf16 v[84:87], v[116:119], v[148:151], v[84:87]
    ds_read_b64_tr_b16 v[102:103], v15 offset:20480
    v_pk_mul_f32 v[228:229], v[228:229], v[244:245]
    v_pk_mul_f32 v[230:231], v[230:231], v[244:245]
    v_pk_fma_f32 v[224:225], v[236:237], v[246:247], v[224:225]
    v_pk_fma_f32 v[226:227], v[238:239], v[246:247], v[226:227]
    s_waitcnt vmcnt(12) lgkmcnt(6)
    v_mfma_f32_16x16x32_bf16 v[24:27], v[88:91], v[152:155], v[24:27]
    ds_read_b64_tr_b16 v[104:105], v16 offset:16384
    v_mfma_f32_16x16x32_bf16 v[28:31], v[88:91], v[156:159], v[28:31]
    ds_read_b64_tr_b16 v[106:107], v16 offset:20480
    v_pk_fma_f32 v[228:229], v[240:241], v[246:247], v[228:229]
    v_pk_fma_f32 v[230:231], v[242:243], v[246:247], v[230:231]
    v_cvt_pk_bf16_f32 v248, v224, v225
    v_cvt_pk_bf16_f32 v249, v226, v227
    s_waitcnt lgkmcnt(6)
    v_mfma_f32_16x16x32_bf16 v[32:35], v[92:95], v[152:155], v[32:35]
    ds_read_b64_tr_b16 v[108:109], v17 offset:16384
    v_mfma_f32_16x16x32_bf16 v[36:39], v[92:95], v[156:159], v[36:39]
    ds_read_b64_tr_b16 v[110:111], v17 offset:20480
    buffer_load_dwordx4 v[144:147], v9, s[44:47], s90 offen offset:0 sc1
    v_cvt_pk_bf16_f32 v250, v228, v229
    v_cvt_pk_bf16_f32 v251, v230, v231
    s_cmp_eq_u32 s76, 1
    s_cbranch_scc0 L_ss12
    buffer_store_dwordx4 v[248:251], v11, s[56:59], s85 offen offset:0
L_sb12:
    s_waitcnt lgkmcnt(6)
    v_mfma_f32_16x16x32_bf16 v[40:43], v[96:99], v[152:155], v[40:43]
    ds_read_b64_tr_b16 v[112:113], v18 offset:16384
    v_mfma_f32_16x16x32_bf16 v[44:47], v[96:99], v[156:159], v[44:47]
    ds_read_b64_tr_b16 v[114:115], v18 offset:20480
    s_waitcnt lgkmcnt(15)
    v_mfma_f32_16x16x32_bf16 v[232:235], v[208:211], v[176:179], 0
    v_mfma_f32_16x16x32_bf16 v[244:247], v[220:223], v[180:183], 0
    v_mfma_f32_16x16x32_bf16 v[224:227], v[200:203], v[176:179], 0
    s_waitcnt lgkmcnt(6)
    v_mfma_f32_16x16x32_bf16 v[48:51], v[100:103], v[152:155], v[48:51]
    ds_read_b64_tr_b16 v[116:117], v19 offset:16384
    v_mfma_f32_16x16x32_bf16 v[52:55], v[100:103], v[156:159], v[52:55]
    ds_read_b64_tr_b16 v[118:119], v19 offset:20480
    v_mfma_f32_16x16x32_bf16 v[228:231], v[204:207], v[176:179], 0
    v_mfma_f32_16x16x32_bf16 v[236:239], v[212:215], v[180:183], 0
    v_mfma_f32_16x16x32_bf16 v[240:243], v[216:219], v[180:183], 0
    s_cmp_lt_u32 s28, 4
    s_cbranch_scc1 L_skQY96
    s_waitcnt vmcnt(45)
    s_barrier
L_skQY96:
    s_waitcnt lgkmcnt(6)
    v_mfma_f32_16x16x32_bf16 v[56:59], v[104:107], v[152:155], v[56:59]
    ds_read_b64_tr_b16 v[88:89], v12 offset:24576
    v_mfma_f32_16x16x32_bf16 v[60:63], v[104:107], v[156:159], v[60:63]
    ds_read_b64_tr_b16 v[90:91], v12 offset:28672
    buffer_load_dwordx4 v[148:151], v9, s[44:47], s90 offen offset:1024 sc1
    s_add_u32 s90, s90, 0x20000
    s_waitcnt lgkmcnt(6)
    v_mfma_f32_16x16x32_bf16 v[64:67], v[108:111], v[152:155], v[64:67]
    ds_read_b64_tr_b16 v[92:93], v13 offset:24576
    v_mfma_f32_16x16x32_bf16 v[68:71], v[108:111], v[156:159], v[68:71]
    ds_read_b64_tr_b16 v[94:95], v13 offset:28672
    v_rcp_f32 v233, v233
    v_rcp_f32 v245, v245
    v_fmaak_f32 v232, v232, v233, 0x358637bd
    v_fmac_f32 v232, v244, v245
    s_waitcnt lgkmcnt(6)
    v_mfma_f32_16x16x32_bf16 v[72:75], v[112:115], v[152:155], v[72:75]
    ds_read_b64_tr_b16 v[96:97], v14 offset:24576
    v_mfma_f32_16x16x32_bf16 v[76:79], v[112:115], v[156:159], v[76:79]
    ds_read_b64_tr_b16 v[98:99], v14 offset:28672
    v_rcp_f32 v232, v232
    s_nop 0
    v_mul_f32 v232, v232, v20
    v_mul_f32 v246, v245, v232
    v_mul_f32 v247, v245, v232
    s_waitcnt lgkmcnt(6)
    v_mfma_f32_16x16x32_bf16 v[80:83], v[116:119], v[152:155], v[80:83]
    ds_read_b64_tr_b16 v[100:101], v15 offset:24576
    v_mfma_f32_16x16x32_bf16 v[84:87], v[116:119], v[156:159], v[84:87]
    ds_read_b64_tr_b16 v[102:103], v15 offset:28672
    v_mul_f32 v244, v233, v232
    v_mul_f32 v245, v233, v232
    v_pk_mul_f32 v[224:225], v[224:225], v[244:245]
    v_pk_mul_f32 v[226:227], v[226:227], v[244:245]
    s_waitcnt vmcnt(13) lgkmcnt(6)
    v_mfma_f32_16x16x32_bf16 v[24:27], v[88:91], v[160:163], v[24:27]
    ds_read_b64_tr_b16 v[104:105], v16 offset:24576
    v_mfma_f32_16x16x32_bf16 v[28:31], v[88:91], v[164:167], v[28:31]
    ds_read_b64_tr_b16 v[106:107], v16 offset:28672
    v_pk_mul_f32 v[228:229], v[228:229], v[244:245]
    v_pk_mul_f32 v[230:231], v[230:231], v[244:245]
    v_pk_fma_f32 v[224:225], v[236:237], v[246:247], v[224:225]
    v_pk_fma_f32 v[226:227], v[238:239], v[246:247], v[226:227]
    s_waitcnt lgkmcnt(6)
    v_mfma_f32_16x16x32_bf16 v[32:35], v[92:95], v[160:163], v[32:35]
    ds_read_b64_tr_b16 v[108:109], v17 offset:24576
    v_mfma_f32_16x16x32_bf16 v[36:39], v[92:95], v[164:167], v[36:39]
    ds_read_b64_tr_b16 v[110:111], v17 offset:28672
    buffer_load_dwordx4 v[152:155], v9, s[44:47], s90 offen offset:0 sc1
    v_pk_fma_f32 v[228:229], v[240:241], v[246:247], v[228:229]
    v_pk_fma_f32 v[230:231], v[242:243], v[246:247], v[230:231]
    v_cvt_pk_bf16_f32 v252, v224, v225
    v_cvt_pk_bf16_f32 v253, v226, v227
    s_waitcnt lgkmcnt(6)
    v_mfma_f32_16x16x32_bf16 v[40:43], v[96:99], v[160:163], v[40:43]
    ds_read_b64_tr_b16 v[112:113], v18 offset:24576
    v_mfma_f32_16x16x32_bf16 v[44:47], v[96:99], v[164:167], v[44:47]
    ds_read_b64_tr_b16 v[114:115], v18 offset:28672
    v_cvt_pk_bf16_f32 v254, v228, v229
    v_cvt_pk_bf16_f32 v255, v230, v231
    s_cmp_eq_u32 s76, 1
    s_cbranch_scc0 L_ss13
    buffer_store_dwordx4 v[252:255], v11, s[56:59], s85 offen offset:1024
L_sb13:
    s_add_u32 s85, s85, 0x20000
    s_waitcnt lgkmcnt(6)
    v_mfma_f32_16x16x32_bf16 v[48:51], v[100:103], v[160:163], v[48:51]
    ds_read_b64_tr_b16 v[116:117], v19 offset:24576
    v_mfma_f32_16x16x32_bf16 v[52:55], v[100:103], v[164:167], v[52:55]
    ds_read_b64_tr_b16 v[118:119], v19 offset:28672
    ds_read_b128 v[208:211], v11 offset:8192
    ds_read_b128 v[220:223], v11 offset:11264
    s_cmp_lt_u32 s28, 4
    s_cbranch_scc0 L_skQX96
    s_waitcnt vmcnt(48)
    s_barrier
L_skQX96:
    v_add_u32 v12, 32768, v12
    s_waitcnt lgkmcnt(8)
    v_mfma_f32_16x16x32_bf16 v[56:59], v[104:107], v[160:163], v[56:59]
    ds_read_b64_tr_b16 v[88:89], v12 offset:0
    v_mfma_f32_16x16x32_bf16 v[60:63], v[104:107], v[164:167], v[60:63]
    ds_read_b64_tr_b16 v[90:91], v12 offset:4096
    buffer_load_dwordx4 v[156:159], v9, s[44:47], s90 offen offset:1024 sc1
    s_add_u32 s90, s90, 0x20000
    ds_read_b128 v[200:203], v11 offset:6144
    ds_read_b128 v[204:207], v11 offset:7168
    v_add_u32 v13, 32768, v13
    s_waitcnt lgkmcnt(10)
    v_mfma_f32_16x16x32_bf16 v[64:67], v[108:111], v[160:163], v[64:67]
    ds_read_b64_tr_b16 v[92:93], v13 offset:0
    v_mfma_f32_16x16x32_bf16 v[68:71], v[108:111], v[164:167], v[68:71]
    ds_read_b64_tr_b16 v[94:95], v13 offset:4096
    ds_read_b128 v[212:215], v11 offset:9216
    ds_read_b128 v[216:219], v11 offset:10240
    v_add_u32 v14, 32768, v14
    s_waitcnt lgkmcnt(12)
    v_mfma_f32_16x16x32_bf16 v[72:75], v[112:115], v[160:163], v[72:75]
    ds_read_b64_tr_b16 v[96:97], v14 offset:0
    v_mfma_f32_16x16x32_bf16 v[76:79], v[112:115], v[164:167], v[76:79]
    ds_read_b64_tr_b16 v[98:99], v14 offset:4096
    s_add_u32 m0, s88, 131072
    s_nop 0
    buffer_load_dwordx4 v5, s[36:39], s68 offen lds
    v_add_u32 v15, 32768, v15
    s_waitcnt lgkmcnt(12)
    v_mfma_f32_16x16x32_bf16 v[80:83], v[116:119], v[160:163], v[80:83]
    ds_read_b64_tr_b16 v[100:101], v15 offset:0
    v_mfma_f32_16x16x32_bf16 v[84:87], v[116:119], v[164:167], v[84:87]
    ds_read_b64_tr_b16 v[102:103], v15 offset:4096
    v_add_u32 v16, 32768, v16
    s_waitcnt vmcnt(15) lgkmcnt(10)
    v_mfma_f32_16x16x32_bf16 v[24:27], v[88:91], v[120:123], v[24:27]
    ds_read_b64_tr_b16 v[104:105], v16 offset:0
    v_mfma_f32_16x16x32_bf16 v[28:31], v[88:91], v[124:127], v[28:31]
    ds_read_b64_tr_b16 v[106:107], v16 offset:4096
    s_waitcnt lgkmcnt(6)
    v_mfma_f32_16x16x32_bf16 v[232:235], v[208:211], v[184:187], 0
    v_mfma_f32_16x16x32_bf16 v[244:247], v[220:223], v[188:191], 0
    v_mfma_f32_16x16x32_bf16 v[224:227], v[200:203], v[184:187], 0
    v_add_u32 v17, 32768, v17
    s_waitcnt lgkmcnt(8)
    v_mfma_f32_16x16x32_bf16 v[32:35], v[92:95], v[120:123], v[32:35]
    ds_read_b64_tr_b16 v[108:109], v17 offset:0
    v_mfma_f32_16x16x32_bf16 v[36:39], v[92:95], v[124:127], v[36:39]
    ds_read_b64_tr_b16 v[110:111], v17 offset:4096
    buffer_load_dwordx4 v[160:163], v9, s[44:47], s90 offen offset:0 sc1
    v_mfma_f32_16x16x32_bf16 v[228:231], v[204:207], v[184:187], 0
    v_mfma_f32_16x16x32_bf16 v[236:239], v[212:215], v[188:191], 0
    v_mfma_f32_16x16x32_bf16 v[240:243], v[216:219], v[188:191], 0
    v_add_u32 v18, 32768, v18
    s_waitcnt lgkmcnt(6)
    v_mfma_f32_16x16x32_bf16 v[40:43], v[96:99], v[120:123], v[40:43]
    ds_read_b64_tr_b16 v[112:113], v18 offset:0
    v_mfma_f32_16x16x32_bf16 v[44:47], v[96:99], v[124:127], v[44:47]
    ds_read_b64_tr_b16 v[114:115], v18 offset:4096
    s_add_u32 m0, s88, 132096
    s_nop 0
    buffer_load_dwordx4 v6, s[36:39], s68 offen lds
    v_add_u32 v19, 32768, v19
    s_waitcnt lgkmcnt(6)
    v_mfma_f32_16x16x32_bf16 v[48:51], v[100:103], v[120:123], v[48:51]
    ds_read_b64_tr_b16 v[116:117], v19 offset:0
    v_mfma_f32_16x16x32_bf16 v[52:55], v[100:103], v[124:127], v[52:55]
    ds_read_b64_tr_b16 v[118:119], v19 offset:4096
    v_rcp_f32 v233, v233
    v_rcp_f32 v245, v245
    v_fmaak_f32 v232, v232, v233, 0x358637bd
    v_fmac_f32 v232, v244, v245
    s_waitcnt lgkmcnt(6)
    v_mfma_f32_16x16x32_bf16 v[56:59], v[104:107], v[120:123], v[56:59]
    ds_read_b64_tr_b16 v[88:89], v12 offset:8192
    v_mfma_f32_16x16x32_bf16 v[60:63], v[104:107], v[124:127], v[60:63]
    ds_read_b64_tr_b16 v[90:91], v12 offset:12288
    buffer_load_dwordx4 v[164:167], v9, s[44:47], s90 offen offset:1024 sc1
    s_add_u32 s90, s90, 0x20000
    v_rcp_f32 v232, v232
    s_nop 0
    v_mul_f32 v232, v232, v0
    v_mul_f32 v246, v245, v232
    v_mul_f32 v247, v245, v232
    s_waitcnt lgkmcnt(6)
    v_mfma_f32_16x16x32_bf16 v[64:67], v[108:111], v[120:123], v[64:67]
    ds_read_b64_tr_b16 v[92:93], v13 offset:8192
    v_mfma_f32_16x16x32_bf16 v[68:71], v[108:111], v[124:127], v[68:71]
    ds_read_b64_tr_b16 v[94:95], v13 offset:12288
    v_mul_f32 v244, v233, v232
    v_mul_f32 v245, v233, v232
    v_pk_mul_f32 v[224:225], v[224:225], v[244:245]
    v_pk_mul_f32 v[226:227], v[226:227], v[244:245]
    s_waitcnt lgkmcnt(6)
    v_mfma_f32_16x16x32_bf16 v[72:75], v[112:115], v[120:123], v[72:75]
    ds_read_b64_tr_b16 v[96:97], v14 offset:8192
    v_mfma_f32_16x16x32_bf16 v[76:79], v[112:115], v[124:127], v[76:79]
    ds_read_b64_tr_b16 v[98:99], v14 offset:12288
    s_add_u32 m0, s88, 133120
    s_nop 0
    buffer_load_dwordx4 v7, s[36:39], s68 offen lds
    v_pk_mul_f32 v[228:229], v[228:229], v[244:245]
    v_pk_mul_f32 v[230:231], v[230:231], v[244:245]
    v_pk_fma_f32 v[224:225], v[236:237], v[246:247], v[224:225]
    v_pk_fma_f32 v[226:227], v[238:239], v[246:247], v[226:227]
    s_waitcnt lgkmcnt(6)
    v_mfma_f32_16x16x32_bf16 v[80:83], v[116:119], v[120:123], v[80:83]
    ds_read_b64_tr_b16 v[100:101], v15 offset:8192
    v_mfma_f32_16x16x32_bf16 v[84:87], v[116:119], v[124:127], v[84:87]
    ds_read_b64_tr_b16 v[102:103], v15 offset:12288
    v_pk_fma_f32 v[228:229], v[240:241], v[246:247], v[228:229]
    v_pk_fma_f32 v[230:231], v[242:243], v[246:247], v[230:231]
    v_cvt_pk_bf16_f32 v248, v224, v225
    v_cvt_pk_bf16_f32 v249, v226, v227
    s_waitcnt vmcnt(15) lgkmcnt(6)
    v_mfma_f32_16x16x32_bf16 v[24:27], v[88:91], v[128:131], v[24:27]
    ds_read_b64_tr_b16 v[104:105], v16 offset:8192
    v_mfma_f32_16x16x32_bf16 v[28:31], v[88:91], v[132:135], v[28:31]
    ds_read_b64_tr_b16 v[106:107], v16 offset:12288
    v_cvt_pk_bf16_f32 v250, v228, v229
    v_cvt_pk_bf16_f32 v251, v230, v231
    s_cmp_eq_u32 s76, 1
    s_cbranch_scc0 L_ss14
    buffer_store_dwordx4 v[248:251], v11, s[56:59], s85 offen offset:0
L_sb14:
    s_waitcnt lgkmcnt(6)
    v_mfma_f32_16x16x32_bf16 v[32:35], v[92:95], v[128:131], v[32:35]
    ds_read_b64_tr_b16 v[108:109], v17 offset:8192
    v_mfma_f32_16x16x32_bf16 v[36:39], v[92:95], v[132:135], v[36:39]
    ds_read_b64_tr_b16 v[110:111], v17 offset:12288
    buffer_load_dwordx4 v[120:123], v9, s[44:47], s90 offen offset:0 sc1
    s_waitcnt lgkmcnt(15)
    v_mfma_f32_16x16x32_bf16 v[232:235], v[208:211], v[192:195], 0
    v_mfma_f32_16x16x32_bf16 v[244:247], v[220:223], v[196:199], 0
    v_mfma_f32_16x16x32_bf16 v[224:227], v[200:203], v[192:195], 0
    s_waitcnt lgkmcnt(6)
    v_mfma_f32_16x16x32_bf16 v[40:43], v[96:99], v[128:131], v[40:43]
    ds_read_b64_tr_b16 v[112:113], v18 offset:8192
    v_mfma_f32_16x16x32_bf16 v[44:47], v[96:99], v[132:135], v[44:47]
    ds_read_b64_tr_b16 v[114:115], v18 offset:12288
    s_add_u32 m0, s88, 134144
    s_nop 0
    buffer_load_dwordx4 v8, s[36:39], s68 offen lds
    s_add_u32 s68, s68, 0x40000
    v_mfma_f32_16x16x32_bf16 v[228:231], v[204:207], v[192:195], 0
    v_mfma_f32_16x16x32_bf16 v[236:239], v[212:215], v[196:199], 0
    v_mfma_f32_16x16x32_bf16 v[240:243], v[216:219], v[196:199], 0
    s_waitcnt lgkmcnt(6)
    v_mfma_f32_16x16x32_bf16 v[48:51], v[100:103], v[128:131], v[48:51]
    ds_read_b64_tr_b16 v[116:117], v19 offset:8192
    v_mfma_f32_16x16x32_bf16 v[52:55], v[100:103], v[132:135], v[52:55]
    ds_read_b64_tr_b16 v[118:119], v19 offset:12288
    s_waitcnt lgkmcnt(6)
    v_mfma_f32_16x16x32_bf16 v[56:59], v[104:107], v[128:131], v[56:59]
    ds_read_b64_tr_b16 v[88:89], v12 offset:16384
    v_mfma_f32_16x16x32_bf16 v[60:63], v[104:107], v[132:135], v[60:63]
    ds_read_b64_tr_b16 v[90:91], v12 offset:20480
    buffer_load_dwordx4 v[124:127], v9, s[44:47], s90 offen offset:1024 sc1
    s_add_u32 s90, s90, 0x20000
    v_rcp_f32 v233, v233
    v_rcp_f32 v245, v245
    v_fmaak_f32 v232, v232, v233, 0x358637bd
    v_fmac_f32 v232, v244, v245
    s_waitcnt lgkmcnt(6)
    v_mfma_f32_16x16x32_bf16 v[64:67], v[108:111], v[128:131], v[64:67]
    ds_read_b64_tr_b16 v[92:93], v13 offset:16384
    v_mfma_f32_16x16x32_bf16 v[68:71], v[108:111], v[132:135], v[68:71]
    ds_read_b64_tr_b16 v[94:95], v13 offset:20480
    v_rcp_f32 v232, v232
    s_nop 0
    v_mul_f32 v232, v232, v20
    v_mul_f32 v246, v245, v232
    v_mul_f32 v247, v245, v232
    s_waitcnt lgkmcnt(6)
    v_mfma_f32_16x16x32_bf16 v[72:75], v[112:115], v[128:131], v[72:75]
    ds_read_b64_tr_b16 v[96:97], v14 offset:16384
    v_mfma_f32_16x16x32_bf16 v[76:79], v[112:115], v[132:135], v[76:79]
    ds_read_b64_tr_b16 v[98:99], v14 offset:20480
    v_mul_f32 v244, v233, v232
    v_mul_f32 v245, v233, v232
    v_pk_mul_f32 v[224:225], v[224:225], v[244:245]
    v_pk_mul_f32 v[226:227], v[226:227], v[244:245]
    s_waitcnt lgkmcnt(6)
    v_mfma_f32_16x16x32_bf16 v[80:83], v[116:119], v[128:131], v[80:83]
    ds_read_b64_tr_b16 v[100:101], v15 offset:16384
    v_mfma_f32_16x16x32_bf16 v[84:87], v[116:119], v[132:135], v[84:87]
    ds_read_b64_tr_b16 v[102:103], v15 offset:20480
    v_pk_mul_f32 v[228:229], v[228:229], v[244:245]
    v_pk_mul_f32 v[230:231], v[230:231], v[244:245]
    v_pk_fma_f32 v[224:225], v[236:237], v[246:247], v[224:225]
    v_pk_fma_f32 v[226:227], v[238:239], v[246:247], v[226:227]
    s_waitcnt vmcnt(15) lgkmcnt(6)
    v_mfma_f32_16x16x32_bf16 v[24:27], v[88:91], v[136:139], v[24:27]
    ds_read_b64_tr_b16 v[104:105], v16 offset:16384
    v_mfma_f32_16x16x32_bf16 v[28:31], v[88:91], v[140:143], v[28:31]
    ds_read_b64_tr_b16 v[106:107], v16 offset:20480
    v_pk_fma_f32 v[228:229], v[240:241], v[246:247], v[228:229]
    v_pk_fma_f32 v[230:231], v[242:243], v[246:247], v[230:231]
    v_cvt_pk_bf16_f32 v252, v224, v225
    v_cvt_pk_bf16_f32 v253, v226, v227
    s_waitcnt lgkmcnt(6)
    v_mfma_f32_16x16x32_bf16 v[32:35], v[92:95], v[136:139], v[32:35]
    ds_read_b64_tr_b16 v[108:109], v17 offset:16384
    v_mfma_f32_16x16x32_bf16 v[36:39], v[92:95], v[140:143], v[36:39]
    ds_read_b64_tr_b16 v[110:111], v17 offset:20480
    buffer_load_dwordx4 v[128:131], v9, s[44:47], s90 offen offset:0 sc1
    v_cvt_pk_bf16_f32 v254, v228, v229
    v_cvt_pk_bf16_f32 v255, v230, v231
    s_cmp_eq_u32 s76, 1
    s_cbranch_scc0 L_ss15
    buffer_store_dwordx4 v[252:255], v11, s[56:59], s85 offen offset:1024
L_sb15:
    s_waitcnt lgkmcnt(6)
    v_mfma_f32_16x16x32_bf16 v[40:43], v[96:99], v[136:139], v[40:43]
    ds_read_b64_tr_b16 v[112:113], v18 offset:16384
    v_mfma_f32_16x16x32_bf16 v[44:47], v[96:99], v[140:143], v[44:47]
    ds_read_b64_tr_b16 v[114:115], v18 offset:20480
    s_waitcnt lgkmcnt(6)
    v_mfma_f32_16x16x32_bf16 v[48:51], v[100:103], v[136:139], v[48:51]
    ds_read_b64_tr_b16 v[116:117], v19 offset:16384
    v_mfma_f32_16x16x32_bf16 v[52:55], v[100:103], v[140:143], v[52:55]
    ds_read_b64_tr_b16 v[118:119], v19 offset:20480
    s_cmp_lt_u32 s28, 4
    s_cbranch_scc1 L_skQY128
    s_waitcnt vmcnt(18)
    s_barrier
L_skQY128:
    s_waitcnt lgkmcnt(6)
    v_mfma_f32_16x16x32_bf16 v[56:59], v[104:107], v[136:139], v[56:59]
    ds_read_b64_tr_b16 v[88:89], v12 offset:24576
    v_mfma_f32_16x16x32_bf16 v[60:63], v[104:107], v[140:143], v[60:63]
    ds_read_b64_tr_b16 v[90:91], v12 offset:28672
    buffer_load_dwordx4 v[132:135], v9, s[44:47], s90 offen offset:1024 sc1
    s_add_u32 s90, s90, 0x20000
    s_waitcnt lgkmcnt(6)
    v_mfma_f32_16x16x32_bf16 v[64:67], v[108:111], v[136:139], v[64:67]
    ds_read_b64_tr_b16 v[92:93], v13 offset:24576
    v_mfma_f32_16x16x32_bf16 v[68:71], v[108:111], v[140:143], v[68:71]
    ds_read_b64_tr_b16 v[94:95], v13 offset:28672
    s_waitcnt lgkmcnt(6)
    v_mfma_f32_16x16x32_bf16 v[72:75], v[112:115], v[136:139], v[72:75]
    ds_read_b64_tr_b16 v[96:97], v14 offset:24576
    v_mfma_f32_16x16x32_bf16 v[76:79], v[112:115], v[140:143], v[76:79]
    ds_read_b64_tr_b16 v[98:99], v14 offset:28672
    s_waitcnt lgkmcnt(6)
    v_mfma_f32_16x16x32_bf16 v[80:83], v[116:119], v[136:139], v[80:83]
    ds_read_b64_tr_b16 v[100:101], v15 offset:24576
    v_mfma_f32_16x16x32_bf16 v[84:87], v[116:119], v[140:143], v[84:87]
    ds_read_b64_tr_b16 v[102:103], v15 offset:28672
    s_waitcnt vmcnt(15) lgkmcnt(6)
    v_mfma_f32_16x16x32_bf16 v[24:27], v[88:91], v[144:147], v[24:27]
    ds_read_b64_tr_b16 v[104:105], v16 offset:24576
    v_mfma_f32_16x16x32_bf16 v[28:31], v[88:91], v[148:151], v[28:31]
    ds_read_b64_tr_b16 v[106:107], v16 offset:28672
    s_waitcnt vmcnt(1)
    s_cmp_eq_u32 s76, 1
    s_cbranch_scc0 L_ss16
    buffer_store_dword v23, v21, s[56:59], s82 offen
L_sb16:
    s_waitcnt lgkmcnt(6)
    v_mfma_f32_16x16x32_bf16 v[32:35], v[92:95], v[144:147], v[32:35]
    ds_read_b64_tr_b16 v[108:109], v17 offset:24576
    v_mfma_f32_16x16x32_bf16 v[36:39], v[92:95], v[148:151], v[36:39]
    ds_read_b64_tr_b16 v[110:111], v17 offset:28672
    buffer_load_dwordx4 v[136:139], v9, s[44:47], s90 offen offset:0 sc1
    s_waitcnt lgkmcnt(6)
    v_mfma_f32_16x16x32_bf16 v[40:43], v[96:99], v[144:147], v[40:43]
    ds_read_b64_tr_b16 v[112:113], v18 offset:24576
    v_mfma_f32_16x16x32_bf16 v[44:47], v[96:99], v[148:151], v[44:47]
    ds_read_b64_tr_b16 v[114:115], v18 offset:28672
    s_waitcnt lgkmcnt(6)
    v_mfma_f32_16x16x32_bf16 v[48:51], v[100:103], v[144:147], v[48:51]
    ds_read_b64_tr_b16 v[116:117], v19 offset:24576
    v_mfma_f32_16x16x32_bf16 v[52:55], v[100:103], v[148:151], v[52:55]
    ds_read_b64_tr_b16 v[118:119], v19 offset:28672
    s_cmp_lt_u32 s28, 4
    s_cbranch_scc0 L_skQX128
    s_waitcnt vmcnt(21)
    s_barrier
L_skQX128:
    v_add_u32 v12, 32768, v12
    s_waitcnt lgkmcnt(6)
    v_mfma_f32_16x16x32_bf16 v[56:59], v[104:107], v[144:147], v[56:59]
    ds_read_b64_tr_b16 v[88:89], v12 offset:0
    v_mfma_f32_16x16x32_bf16 v[60:63], v[104:107], v[148:151], v[60:63]
    ds_read_b64_tr_b16 v[90:91], v12 offset:4096
    buffer_load_dwordx4 v[140:143], v9, s[44:47], s90 offen offset:1024 sc1
    s_add_u32 s90, s90, 0x20000
    v_add_u32 v13, 32768, v13
    s_waitcnt lgkmcnt(6)
    v_mfma_f32_16x16x32_bf16 v[64:67], v[108:111], v[144:147], v[64:67]
    ds_read_b64_tr_b16 v[92:93], v13 offset:0
    v_mfma_f32_16x16x32_bf16 v[68:71], v[108:111], v[148:151], v[68:71]
    ds_read_b64_tr_b16 v[94:95], v13 offset:4096
    v_add_u32 v14, 32768, v14
    s_waitcnt lgkmcnt(6)
    v_mfma_f32_16x16x32_bf16 v[72:75], v[112:115], v[144:147], v[72:75]
    ds_read_b64_tr_b16 v[96:97], v14 offset:0
    v_mfma_f32_16x16x32_bf16 v[76:79], v[112:115], v[148:151], v[76:79]
    ds_read_b64_tr_b16 v[98:99], v14 offset:4096
    s_add_u32 m0, s88, 32768
    s_nop 0
    buffer_load_dwordx4 v5, s[36:39], s68 offen lds
    v_add_u32 v15, 32768, v15
    s_waitcnt lgkmcnt(6)
    v_mfma_f32_16x16x32_bf16 v[80:83], v[116:119], v[144:147], v[80:83]
    ds_read_b64_tr_b16 v[100:101], v15 offset:0
    v_mfma_f32_16x16x32_bf16 v[84:87], v[116:119], v[148:151], v[84:87]
    ds_read_b64_tr_b16 v[102:103], v15 offset:4096
    v_add_u32 v16, 32768, v16
    s_waitcnt vmcnt(16) lgkmcnt(6)
    v_mfma_f32_16x16x32_bf16 v[24:27], v[88:91], v[152:155], v[24:27]
    ds_read_b64_tr_b16 v[104:105], v16 offset:0
    v_mfma_f32_16x16x32_bf16 v[28:31], v[88:91], v[156:159], v[28:31]
    ds_read_b64_tr_b16 v[106:107], v16 offset:4096
    v_add_u32 v17, 32768, v17
    s_waitcnt lgkmcnt(6)
    v_mfma_f32_16x16x32_bf16 v[32:35], v[92:95], v[152:155], v[32:35]
    ds_read_b64_tr_b16 v[108:109], v17 offset:0
    v_mfma_f32_16x16x32_bf16 v[36:39], v[92:95], v[156:159], v[36:39]
    ds_read_b64_tr_b16 v[110:111], v17 offset:4096
    buffer_load_dwordx4 v[144:147], v9, s[44:47], s90 offen offset:0 sc1
    v_add_u32 v18, 32768, v18
    s_waitcnt lgkmcnt(6)
    v_mfma_f32_16x16x32_bf16 v[40:43], v[96:99], v[152:155], v[40:43]
    ds_read_b64_tr_b16 v[112:113], v18 offset:0
    v_mfma_f32_16x16x32_bf16 v[44:47], v[96:99], v[156:159], v[44:47]
    ds_read_b64_tr_b16 v[114:115], v18 offset:4096
    s_add_u32 m0, s88, 33792
    s_nop 0
    buffer_load_dwordx4 v6, s[36:39], s68 offen lds
    v_add_u32 v19, 32768, v19
    s_waitcnt lgkmcnt(6)
    v_mfma_f32_16x16x32_bf16 v[48:51], v[100:103], v[152:155], v[48:51]
    ds_read_b64_tr_b16 v[116:117], v19 offset:0
    v_mfma_f32_16x16x32_bf16 v[52:55], v[100:103], v[156:159], v[52:55]
    ds_read_b64_tr_b16 v[118:119], v19 offset:4096
    s_waitcnt lgkmcnt(6)
    v_mfma_f32_16x16x32_bf16 v[56:59], v[104:107], v[152:155], v[56:59]
    ds_read_b64_tr_b16 v[88:89], v12 offset:8192
    v_mfma_f32_16x16x32_bf16 v[60:63], v[104:107], v[156:159], v[60:63]
    ds_read_b64_tr_b16 v[90:91], v12 offset:12288
    buffer_load_dwordx4 v[148:151], v9, s[44:47], s90 offen offset:1024 sc1
    s_add_u32 s90, s90, 0x20000
    s_waitcnt lgkmcnt(6)
    v_mfma_f32_16x16x32_bf16 v[64:67], v[108:111], v[152:155], v[64:67]
    ds_read_b64_tr_b16 v[92:93], v13 offset:8192
    v_mfma_f32_16x16x32_bf16 v[68:71], v[108:111], v[156:159], v[68:71]
    ds_read_b64_tr_b16 v[94:95], v13 offset:12288
    s_waitcnt lgkmcnt(6)
    v_mfma_f32_16x16x32_bf16 v[72:75], v[112:115], v[152:155], v[72:75]
    ds_read_b64_tr_b16 v[96:97], v14 offset:8192
    v_mfma_f32_16x16x32_bf16 v[76:79], v[112:115], v[156:159], v[76:79]
    ds_read_b64_tr_b16 v[98:99], v14 offset:12288
    s_add_u32 m0, s88, 34816
    s_nop 0
    buffer_load_dwordx4 v7, s[36:39], s68 offen lds
    s_waitcnt lgkmcnt(6)
    v_mfma_f32_16x16x32_bf16 v[80:83], v[116:119], v[152:155], v[80:83]
    ds_read_b64_tr_b16 v[100:101], v15 offset:8192
    v_mfma_f32_16x16x32_bf16 v[84:87], v[116:119], v[156:159], v[84:87]
    ds_read_b64_tr_b16 v[102:103], v15 offset:12288
    s_waitcnt vmcnt(16) lgkmcnt(6)
    v_mfma_f32_16x16x32_bf16 v[24:27], v[88:91], v[160:163], v[24:27]
    ds_read_b64_tr_b16 v[104:105], v16 offset:8192
    v_mfma_f32_16x16x32_bf16 v[28:31], v[88:91], v[164:167], v[28:31]
    ds_read_b64_tr_b16 v[106:107], v16 offset:12288
    s_waitcnt lgkmcnt(6)
    v_mfma_f32_16x16x32_bf16 v[32:35], v[92:95], v[160:163], v[32:35]
    ds_read_b64_tr_b16 v[108:109], v17 offset:8192
    v_mfma_f32_16x16x32_bf16 v[36:39], v[92:95], v[164:167], v[36:39]
    ds_read_b64_tr_b16 v[110:111], v17 offset:12288
    buffer_load_dwordx4 v[152:155], v9, s[44:47], s90 offen offset:0 sc1
    s_waitcnt lgkmcnt(6)
    v_mfma_f32_16x16x32_bf16 v[40:43], v[96:99], v[160:163], v[40:43]
    ds_read_b64_tr_b16 v[112:113], v18 offset:8192
    v_mfma_f32_16x16x32_bf16 v[44:47], v[96:99], v[164:167], v[44:47]
    ds_read_b64_tr_b16 v[114:115], v18 offset:12288
    s_add_u32 m0, s88, 35840
    s_nop 0
    buffer_load_dwordx4 v8, s[36:39], s68 offen lds
    s_add_u32 s68, s68, 0x40000
    s_waitcnt lgkmcnt(6)
    v_mfma_f32_16x16x32_bf16 v[48:51], v[100:103], v[160:163], v[48:51]
    ds_read_b64_tr_b16 v[116:117], v19 offset:8192
    v_mfma_f32_16x16x32_bf16 v[52:55], v[100:103], v[164:167], v[52:55]
    ds_read_b64_tr_b16 v[118:119], v19 offset:12288
    s_waitcnt lgkmcnt(6)
    v_mfma_f32_16x16x32_bf16 v[56:59], v[104:107], v[160:163], v[56:59]
    ds_read_b64_tr_b16 v[88:89], v12 offset:16384
    v_mfma_f32_16x16x32_bf16 v[60:63], v[104:107], v[164:167], v[60:63]
    ds_read_b64_tr_b16 v[90:91], v12 offset:20480
    buffer_load_dwordx4 v[156:159], v9, s[44:47], s90 offen offset:1024 sc1
    s_add_u32 s90, s90, 0x20000
    s_waitcnt lgkmcnt(6)
    v_mfma_f32_16x16x32_bf16 v[64:67], v[108:111], v[160:163], v[64:67]
    ds_read_b64_tr_b16 v[92:93], v13 offset:16384
    v_mfma_f32_16x16x32_bf16 v[68:71], v[108:111], v[164:167], v[68:71]
    ds_read_b64_tr_b16 v[94:95], v13 offset:20480
    s_waitcnt lgkmcnt(6)
    v_mfma_f32_16x16x32_bf16 v[72:75], v[112:115], v[160:163], v[72:75]
    ds_read_b64_tr_b16 v[96:97], v14 offset:16384
    v_mfma_f32_16x16x32_bf16 v[76:79], v[112:115], v[164:167], v[76:79]
    ds_read_b64_tr_b16 v[98:99], v14 offset:20480
    s_waitcnt lgkmcnt(6)
    v_mfma_f32_16x16x32_bf16 v[80:83], v[116:119], v[160:163], v[80:83]
    ds_read_b64_tr_b16 v[100:101], v15 offset:16384
    v_mfma_f32_16x16x32_bf16 v[84:87], v[116:119], v[164:167], v[84:87]
    ds_read_b64_tr_b16 v[102:103], v15 offset:20480
    s_waitcnt vmcnt(14) lgkmcnt(6)
    v_mfma_f32_16x16x32_bf16 v[24:27], v[88:91], v[120:123], v[24:27]
    ds_read_b64_tr_b16 v[104:105], v16 offset:16384
    v_mfma_f32_16x16x32_bf16 v[28:31], v[88:91], v[124:127], v[28:31]
    ds_read_b64_tr_b16 v[106:107], v16 offset:20480
    s_waitcnt lgkmcnt(6)
    v_mfma_f32_16x16x32_bf16 v[32:35], v[92:95], v[120:123], v[32:35]
    ds_read_b64_tr_b16 v[108:109], v17 offset:16384
    v_mfma_f32_16x16x32_bf16 v[36:39], v[92:95], v[124:127], v[36:39]
    ds_read_b64_tr_b16 v[110:111], v17 offset:20480
    buffer_load_dwordx4 v[160:163], v9, s[44:47], s90 offen offset:0 sc1
    s_waitcnt lgkmcnt(6)
    v_mfma_f32_16x16x32_bf16 v[40:43], v[96:99], v[120:123], v[40:43]
    ds_read_b64_tr_b16 v[112:113], v18 offset:16384
    v_mfma_f32_16x16x32_bf16 v[44:47], v[96:99], v[124:127], v[44:47]
    ds_read_b64_tr_b16 v[114:115], v18 offset:20480
    s_waitcnt lgkmcnt(6)
    v_mfma_f32_16x16x32_bf16 v[48:51], v[100:103], v[120:123], v[48:51]
    ds_read_b64_tr_b16 v[116:117], v19 offset:16384
    v_mfma_f32_16x16x32_bf16 v[52:55], v[100:103], v[124:127], v[52:55]
    ds_read_b64_tr_b16 v[118:119], v19 offset:20480
    s_cmp_lt_u32 s28, 4
    s_cbranch_scc1 L_skQY160
    s_waitcnt vmcnt(16)
    s_barrier
L_skQY160:
    s_waitcnt lgkmcnt(6)
    v_mfma_f32_16x16x32_bf16 v[56:59], v[104:107], v[120:123], v[56:59]
    ds_read_b64_tr_b16 v[88:89], v12 offset:24576
    v_mfma_f32_16x16x32_bf16 v[60:63], v[104:107], v[124:127], v[60:63]
    ds_read_b64_tr_b16 v[90:91], v12 offset:28672
    buffer_load_dwordx4 v[164:167], v9, s[44:47], s90 offen offset:1024 sc1
    s_add_u32 s90, s90, 0x20000
    s_waitcnt lgkmcnt(6)
    v_mfma_f32_16x16x32_bf16 v[64:67], v[108:111], v[120:123], v[64:67]
    ds_read_b64_tr_b16 v[92:93], v13 offset:24576
    v_mfma_f32_16x16x32_bf16 v[68:71], v[108:111], v[124:127], v[68:71]
    ds_read_b64_tr_b16 v[94:95], v13 offset:28672
    s_waitcnt lgkmcnt(6)
    v_mfma_f32_16x16x32_bf16 v[72:75], v[112:115], v[120:123], v[72:75]
    ds_read_b64_tr_b16 v[96:97], v14 offset:24576
    v_mfma_f32_16x16x32_bf16 v[76:79], v[112:115], v[124:127], v[76:79]
    ds_read_b64_tr_b16 v[98:99], v14 offset:28672
    s_mov_b32 s52, s4
    s_mov_b32 s53, s5
    s_mov_b32 s54, 4194304
    s_mov_b32 s55, 0x00020000
    s_mov_b32 s72, s18
    s_mov_b32 s73, s19
    s_mov_b32 s74, 2048
    s_mov_b32 s75, 0x00020000
    s_lshl_b32 s31, s89, 5
    s_lshl_b32 s95, s64, 6
    s_add_u32 s95, s95, s67
    s_add_u32 s31, s31, s95
    v_and_b32 v246, 1, v4
    v_lshlrev_b32 v246, 5, v246
    v_lshrrev_b32 v248, 1, v4
    v_lshl_add_u32 v248, v248, 4, v246
    v_lshl_add_u32 v246, v3, 11, v248
    v_add_u32 v246, s31, v246
    v_add_u32 v247, 0x8000, v246
    s_lshr_b32 s96, s89, 2
    s_add_u32 s96, s96, 37748736
    v_lshlrev_b32 v249, 4, v3
    s_lshl_b32 s31, s26, 3
    s_and_b32 s32, s27, 7
    s_add_u32 s31, s31, s32
    s_mul_i32 s31, s31, 196608
    s_lshl_b32 s32, s28, 11
    s_add_u32 s31, s31, s32
    s_add_u32 s31, s31, 41943040
    s_mov_b32 s92, s31
    s_mul_i32 s94, s64, 49152
    s_add_u32 s94, s94, s31
    buffer_load_dwordx4 v[232:235], v246, s[52:55], 0 offen
    s_waitcnt lgkmcnt(6)
    v_mfma_f32_16x16x32_bf16 v[80:83], v[116:119], v[120:123], v[80:83]
    ds_read_b64_tr_b16 v[100:101], v15 offset:24576
    v_mfma_f32_16x16x32_bf16 v[84:87], v[116:119], v[124:127], v[84:87]
    ds_read_b64_tr_b16 v[102:103], v15 offset:28672
    buffer_load_dwordx4 v[236:239], v247, s[52:55], 0 offen
    buffer_load_dwordx4 v[240:243], v248, s[72:75], s95 offen
    s_waitcnt vmcnt(16) lgkmcnt(6)
    v_mfma_f32_16x16x32_bf16 v[24:27], v[88:91], v[128:131], v[24:27]
    ds_read_b64_tr_b16 v[104:105], v16 offset:24576
    v_mfma_f32_16x16x32_bf16 v[28:31], v[88:91], v[132:135], v[28:31]
    ds_read_b64_tr_b16 v[106:107], v16 offset:28672
    buffer_load_dword v244, v249, s[56:59], s96 offen offset:8 sc1
    buffer_load_dword v245, v249, s[56:59], s96 offen offset:264 sc1
    s_waitcnt lgkmcnt(6)
    v_mfma_f32_16x16x32_bf16 v[32:35], v[92:95], v[128:131], v[32:35]
    ds_read_b64_tr_b16 v[108:109], v17 offset:24576
    v_mfma_f32_16x16x32_bf16 v[36:39], v[92:95], v[132:135], v[36:39]
    ds_read_b64_tr_b16 v[110:111], v17 offset:28672
    buffer_load_dwordx4 v[120:123], v9, s[44:47], s90 offen offset:0 sc1
    s_waitcnt lgkmcnt(6)
    v_mfma_f32_16x16x32_bf16 v[40:43], v[96:99], v[128:131], v[40:43]
    ds_read_b64_tr_b16 v[112:113], v18 offset:24576
    v_mfma_f32_16x16x32_bf16 v[44:47], v[96:99], v[132:135], v[44:47]
    ds_read_b64_tr_b16 v[114:115], v18 offset:28672
    s_waitcnt lgkmcnt(6)
    v_mfma_f32_16x16x32_bf16 v[48:51], v[100:103], v[128:131], v[48:51]
    ds_read_b64_tr_b16 v[116:117], v19 offset:24576
    v_mfma_f32_16x16x32_bf16 v[52:55], v[100:103], v[132:135], v[52:55]
    ds_read_b64_tr_b16 v[118:119], v19 offset:28672
    s_cmp_lt_u32 s28, 4
    s_cbranch_scc0 L_skQX160
    s_waitcnt vmcnt(23)
    s_barrier
L_skQX160:
    v_add_u32 v12, 32768, v12
    s_waitcnt lgkmcnt(6)
    v_mfma_f32_16x16x32_bf16 v[56:59], v[104:107], v[128:131], v[56:59]
    ds_read_b64_tr_b16 v[88:89], v12 offset:0
    v_mfma_f32_16x16x32_bf16 v[60:63], v[104:107], v[132:135], v[60:63]
    ds_read_b64_tr_b16 v[90:91], v12 offset:4096
    buffer_load_dwordx4 v[124:127], v9, s[44:47], s90 offen offset:1024 sc1
    s_add_u32 s90, s90, 0x20000
    v_add_u32 v13, 32768, v13
    s_waitcnt lgkmcnt(6)
    v_mfma_f32_16x16x32_bf16 v[64:67], v[108:111], v[128:131], v[64:67]
    ds_read_b64_tr_b16 v[92:93], v13 offset:0
    v_mfma_f32_16x16x32_bf16 v[68:71], v[108:111], v[132:135], v[68:71]
    ds_read_b64_tr_b16 v[94:95], v13 offset:4096
    v_add_u32 v14, 32768, v14
    s_waitcnt lgkmcnt(6)
    v_mfma_f32_16x16x32_bf16 v[72:75], v[112:115], v[128:131], v[72:75]
    ds_read_b64_tr_b16 v[96:97], v14 offset:0
    v_mfma_f32_16x16x32_bf16 v[76:79], v[112:115], v[132:135], v[76:79]
    ds_read_b64_tr_b16 v[98:99], v14 offset:4096
    s_add_u32 m0, s88, 65536
    s_nop 0
    buffer_load_dwordx4 v5, s[48:51], s69 offen lds
    v_add_u32 v15, 32768, v15
    s_waitcnt lgkmcnt(6)
    v_mfma_f32_16x16x32_bf16 v[80:83], v[116:119], v[128:131], v[80:83]
    ds_read_b64_tr_b16 v[100:101], v15 offset:0
    v_mfma_f32_16x16x32_bf16 v[84:87], v[116:119], v[132:135], v[84:87]
    ds_read_b64_tr_b16 v[102:103], v15 offset:4096
    v_add_u32 v16, 32768, v16
    s_waitcnt vmcnt(18) lgkmcnt(6)
    v_mfma_f32_16x16x32_bf16 v[24:27], v[88:91], v[136:139], v[24:27]
    ds_read_b64_tr_b16 v[104:105], v16 offset:0
    v_mfma_f32_16x16x32_bf16 v[28:31], v[88:91], v[140:143], v[28:31]
    ds_read_b64_tr_b16 v[106:107], v16 offset:4096
    v_add_u32 v17, 32768, v17
    s_waitcnt lgkmcnt(6)
    v_mfma_f32_16x16x32_bf16 v[32:35], v[92:95], v[136:139], v[32:35]
    ds_read_b64_tr_b16 v[108:109], v17 offset:0
    v_mfma_f32_16x16x32_bf16 v[36:39], v[92:95], v[140:143], v[36:39]
    ds_read_b64_tr_b16 v[110:111], v17 offset:4096
    buffer_load_dwordx4 v[128:131], v9, s[44:47], s90 offen offset:0 sc1
    v_add_u32 v18, 32768, v18
    s_waitcnt lgkmcnt(6)
    v_mfma_f32_16x16x32_bf16 v[40:43], v[96:99], v[136:139], v[40:43]
    ds_read_b64_tr_b16 v[112:113], v18 offset:0
    v_mfma_f32_16x16x32_bf16 v[44:47], v[96:99], v[140:143], v[44:47]
    ds_read_b64_tr_b16 v[114:115], v18 offset:4096
    s_add_u32 m0, s88, 66560
    s_nop 0
    buffer_load_dwordx4 v6, s[48:51], s69 offen lds
    v_add_u32 v19, 32768, v19
    s_waitcnt lgkmcnt(6)
    v_mfma_f32_16x16x32_bf16 v[48:51], v[100:103], v[136:139], v[48:51]
    ds_read_b64_tr_b16 v[116:117], v19 offset:0
    v_mfma_f32_16x16x32_bf16 v[52:55], v[100:103], v[140:143], v[52:55]
    ds_read_b64_tr_b16 v[118:119], v19 offset:4096
    s_waitcnt lgkmcnt(6)
    v_mfma_f32_16x16x32_bf16 v[56:59], v[104:107], v[136:139], v[56:59]
    ds_read_b64_tr_b16 v[88:89], v12 offset:8192
    v_mfma_f32_16x16x32_bf16 v[60:63], v[104:107], v[140:143], v[60:63]
    ds_read_b64_tr_b16 v[90:91], v12 offset:12288
    buffer_load_dwordx4 v[132:135], v9, s[44:47], s90 offen offset:1024 sc1
    s_add_u32 s90, s90, 0x20000
    s_waitcnt lgkmcnt(6)
    v_mfma_f32_16x16x32_bf16 v[64:67], v[108:111], v[136:139], v[64:67]
    ds_read_b64_tr_b16 v[92:93], v13 offset:8192
    v_mfma_f32_16x16x32_bf16 v[68:71], v[108:111], v[140:143], v[68:71]
    ds_read_b64_tr_b16 v[94:95], v13 offset:12288
    s_waitcnt lgkmcnt(6)
    v_mfma_f32_16x16x32_bf16 v[72:75], v[112:115], v[136:139], v[72:75]
    ds_read_b64_tr_b16 v[96:97], v14 offset:8192
    v_mfma_f32_16x16x32_bf16 v[76:79], v[112:115], v[140:143], v[76:79]
    ds_read_b64_tr_b16 v[98:99], v14 offset:12288
    s_add_u32 m0, s88, 67584
    s_nop 0
    buffer_load_dwordx4 v7, s[48:51], s69 offen lds
    s_waitcnt lgkmcnt(6)
    v_mfma_f32_16x16x32_bf16 v[80:83], v[116:119], v[136:139], v[80:83]
    ds_read_b64_tr_b16 v[100:101], v15 offset:8192
    v_mfma_f32_16x16x32_bf16 v[84:87], v[116:119], v[140:143], v[84:87]
    ds_read_b64_tr_b16 v[102:103], v15 offset:12288
    s_waitcnt vmcnt(18) lgkmcnt(6)
    v_mfma_f32_16x16x32_bf16 v[24:27], v[88:91], v[144:147], v[24:27]
    ds_read_b64_tr_b16 v[104:105], v16 offset:8192
    v_mfma_f32_16x16x32_bf16 v[28:31], v[88:91], v[148:151], v[28:31]
    ds_read_b64_tr_b16 v[106:107], v16 offset:12288
    s_waitcnt lgkmcnt(6)
    v_mfma_f32_16x16x32_bf16 v[32:35], v[92:95], v[144:147], v[32:35]
    ds_read_b64_tr_b16 v[108:109], v17 offset:8192
    v_mfma_f32_16x16x32_bf16 v[36:39], v[92:95], v[148:151], v[36:39]
    ds_read_b64_tr_b16 v[110:111], v17 offset:12288
    buffer_load_dwordx4 v[136:139], v9, s[44:47], s90 offen offset:0 sc1
    s_waitcnt lgkmcnt(6)
    v_mfma_f32_16x16x32_bf16 v[40:43], v[96:99], v[144:147], v[40:43]
    ds_read_b64_tr_b16 v[112:113], v18 offset:8192
    v_mfma_f32_16x16x32_bf16 v[44:47], v[96:99], v[148:151], v[44:47]
    ds_read_b64_tr_b16 v[114:115], v18 offset:12288
    s_add_u32 m0, s88, 68608
    s_nop 0
    buffer_load_dwordx4 v8, s[48:51], s69 offen lds
    s_add_u32 s69, s69, 0x40000
    s_waitcnt lgkmcnt(6)
    v_mfma_f32_16x16x32_bf16 v[48:51], v[100:103], v[144:147], v[48:51]
    ds_read_b64_tr_b16 v[116:117], v19 offset:8192
    v_mfma_f32_16x16x32_bf16 v[52:55], v[100:103], v[148:151], v[52:55]
    ds_read_b64_tr_b16 v[118:119], v19 offset:12288
    s_waitcnt lgkmcnt(6)
    v_mfma_f32_16x16x32_bf16 v[56:59], v[104:107], v[144:147], v[56:59]
    ds_read_b64_tr_b16 v[88:89], v12 offset:16384
    v_mfma_f32_16x16x32_bf16 v[60:63], v[104:107], v[148:151], v[60:63]
    ds_read_b64_tr_b16 v[90:91], v12 offset:20480
    buffer_load_dwordx4 v[140:143], v9, s[44:47], s90 offen offset:1024 sc1
    s_add_u32 s90, s90, 0x20000
    s_waitcnt lgkmcnt(6)
    v_mfma_f32_16x16x32_bf16 v[64:67], v[108:111], v[144:147], v[64:67]
    ds_read_b64_tr_b16 v[92:93], v13 offset:16384
    v_mfma_f32_16x16x32_bf16 v[68:71], v[108:111], v[148:151], v[68:71]
    ds_read_b64_tr_b16 v[94:95], v13 offset:20480
    s_waitcnt lgkmcnt(6)
    v_mfma_f32_16x16x32_bf16 v[72:75], v[112:115], v[144:147], v[72:75]
    ds_read_b64_tr_b16 v[96:97], v14 offset:16384
    v_mfma_f32_16x16x32_bf16 v[76:79], v[112:115], v[148:151], v[76:79]
    ds_read_b64_tr_b16 v[98:99], v14 offset:20480
    s_waitcnt lgkmcnt(6)
    v_mfma_f32_16x16x32_bf16 v[80:83], v[116:119], v[144:147], v[80:83]
    ds_read_b64_tr_b16 v[100:101], v15 offset:16384
    v_mfma_f32_16x16x32_bf16 v[84:87], v[116:119], v[148:151], v[84:87]
    ds_read_b64_tr_b16 v[102:103], v15 offset:20480
    s_waitcnt vmcnt(17) lgkmcnt(6)
    v_mfma_f32_16x16x32_bf16 v[24:27], v[88:91], v[152:155], v[24:27]
    ds_read_b64_tr_b16 v[104:105], v16 offset:16384
    v_mfma_f32_16x16x32_bf16 v[28:31], v[88:91], v[156:159], v[28:31]
    ds_read_b64_tr_b16 v[106:107], v16 offset:20480
    v_and_b32 v10, 12, v10
    buffer_load_dword v22, v10, s[56:59], s87 offen offset:32 sc1
    s_waitcnt lgkmcnt(6)
    v_mfma_f32_16x16x32_bf16 v[32:35], v[92:95], v[152:155], v[32:35]
    ds_read_b64_tr_b16 v[108:109], v17 offset:16384
    v_mfma_f32_16x16x32_bf16 v[36:39], v[92:95], v[156:159], v[36:39]
    ds_read_b64_tr_b16 v[110:111], v17 offset:20480
    buffer_load_dwordx4 v[144:147], v9, s[44:47], s90 offen offset:0 sc1
    s_waitcnt lgkmcnt(6)
    v_mfma_f32_16x16x32_bf16 v[40:43], v[96:99], v[152:155], v[40:43]
    ds_read_b64_tr_b16 v[112:113], v18 offset:16384
    v_mfma_f32_16x16x32_bf16 v[44:47], v[96:99], v[156:159], v[44:47]
    ds_read_b64_tr_b16 v[114:115], v18 offset:20480
    s_waitcnt lgkmcnt(6)
    v_mfma_f32_16x16x32_bf16 v[48:51], v[100:103], v[152:155], v[48:51]
    ds_read_b64_tr_b16 v[116:117], v19 offset:16384
    v_mfma_f32_16x16x32_bf16 v[52:55], v[100:103], v[156:159], v[52:55]
    ds_read_b64_tr_b16 v[118:119], v19 offset:20480
    s_cmp_lt_u32 s28, 4
    s_cbranch_scc1 L_skQY192
    s_waitcnt vmcnt(20)
    s_barrier
L_skQY192:
    s_waitcnt lgkmcnt(6)
    v_mfma_f32_16x16x32_bf16 v[56:59], v[104:107], v[152:155], v[56:59]
    ds_read_b64_tr_b16 v[88:89], v12 offset:24576
    v_mfma_f32_16x16x32_bf16 v[60:63], v[104:107], v[156:159], v[60:63]
    ds_read_b64_tr_b16 v[90:91], v12 offset:28672
    buffer_load_dwordx4 v[148:151], v9, s[44:47], s90 offen offset:1024 sc1
    s_add_u32 s90, s90, 0x20000
    s_waitcnt lgkmcnt(6)
    v_mfma_f32_16x16x32_bf16 v[64:67], v[108:111], v[152:155], v[64:67]
    ds_read_b64_tr_b16 v[92:93], v13 offset:24576
    v_mfma_f32_16x16x32_bf16 v[68:71], v[108:111], v[156:159], v[68:71]
    ds_read_b64_tr_b16 v[94:95], v13 offset:28672
    s_waitcnt lgkmcnt(6)
    v_mfma_f32_16x16x32_bf16 v[72:75], v[112:115], v[152:155], v[72:75]
    ds_read_b64_tr_b16 v[96:97], v14 offset:24576
    v_mfma_f32_16x16x32_bf16 v[76:79], v[112:115], v[156:159], v[76:79]
    ds_read_b64_tr_b16 v[98:99], v14 offset:28672
    s_waitcnt lgkmcnt(6)
    v_mfma_f32_16x16x32_bf16 v[80:83], v[116:119], v[152:155], v[80:83]
    ds_read_b64_tr_b16 v[100:101], v15 offset:24576
    v_mfma_f32_16x16x32_bf16 v[84:87], v[116:119], v[156:159], v[84:87]
    ds_read_b64_tr_b16 v[102:103], v15 offset:28672
    s_waitcnt vmcnt(18) lgkmcnt(6)
    v_mfma_f32_16x16x32_bf16 v[24:27], v[88:91], v[160:163], v[24:27]
    ds_read_b64_tr_b16 v[104:105], v16 offset:24576
    v_mfma_f32_16x16x32_bf16 v[28:31], v[88:91], v[164:167], v[28:31]
    ds_read_b64_tr_b16 v[106:107], v16 offset:28672
    s_waitcnt lgkmcnt(6)
    v_mfma_f32_16x16x32_bf16 v[32:35], v[92:95], v[160:163], v[32:35]
    ds_read_b64_tr_b16 v[108:109], v17 offset:24576
    v_mfma_f32_16x16x32_bf16 v[36:39], v[92:95], v[164:167], v[36:39]
    ds_read_b64_tr_b16 v[110:111], v17 offset:28672
    s_waitcnt lgkmcnt(6)
    v_mfma_f32_16x16x32_bf16 v[40:43], v[96:99], v[160:163], v[40:43]
    ds_read_b64_tr_b16 v[112:113], v18 offset:24576
    v_mfma_f32_16x16x32_bf16 v[44:47], v[96:99], v[164:167], v[44:47]
    ds_read_b64_tr_b16 v[114:115], v18 offset:28672
    s_waitcnt lgkmcnt(6)
    v_mfma_f32_16x16x32_bf16 v[48:51], v[100:103], v[160:163], v[48:51]
    ds_read_b64_tr_b16 v[116:117], v19 offset:24576
    v_mfma_f32_16x16x32_bf16 v[52:55], v[100:103], v[164:167], v[52:55]
    ds_read_b64_tr_b16 v[118:119], v19 offset:28672
    s_cmp_lt_u32 s28, 4
    s_cbranch_scc0 L_skQX192
    s_waitcnt vmcnt(21)
    s_barrier
L_skQX192:
    v_add_u32 v12, 4294868992, v12
    s_waitcnt lgkmcnt(6)
    v_mfma_f32_16x16x32_bf16 v[56:59], v[104:107], v[160:163], v[56:59]
    ds_read_b64_tr_b16 v[88:89], v12 offset:0
    v_mfma_f32_16x16x32_bf16 v[60:63], v[104:107], v[164:167], v[60:63]
    ds_read_b64_tr_b16 v[90:91], v12 offset:4096
    s_add_u32 m0, s88, 98304
    s_nop 0
    buffer_load_dwordx4 v5, s[48:51], s69 offen lds
    v_add_u32 v13, 4294868992, v13
    s_waitcnt lgkmcnt(6)
    v_mfma_f32_16x16x32_bf16 v[64:67], v[108:111], v[160:163], v[64:67]
    ds_read_b64_tr_b16 v[92:93], v13 offset:0
    v_mfma_f32_16x16x32_bf16 v[68:71], v[108:111], v[164:167], v[68:71]
    ds_read_b64_tr_b16 v[94:95], v13 offset:4096
    s_add_u32 m0, s88, 99328
    s_nop 0
    buffer_load_dwordx4 v6, s[48:51], s69 offen lds
    v_add_u32 v14, 4294868992, v14
    s_waitcnt lgkmcnt(6)
    v_mfma_f32_16x16x32_bf16 v[72:75], v[112:115], v[160:163], v[72:75]
    ds_read_b64_tr_b16 v[96:97], v14 offset:0
    v_mfma_f32_16x16x32_bf16 v[76:79], v[112:115], v[164:167], v[76:79]
    ds_read_b64_tr_b16 v[98:99], v14 offset:4096
    s_add_u32 m0, s88, 100352
    s_nop 0
    buffer_load_dwordx4 v7, s[48:51], s69 offen lds
    v_add_u32 v15, 4294868992, v15
    s_waitcnt lgkmcnt(6)
    v_mfma_f32_16x16x32_bf16 v[80:83], v[116:119], v[160:163], v[80:83]
    ds_read_b64_tr_b16 v[100:101], v15 offset:0
    v_mfma_f32_16x16x32_bf16 v[84:87], v[116:119], v[164:167], v[84:87]
    ds_read_b64_tr_b16 v[102:103], v15 offset:4096
    s_add_u32 m0, s88, 101376
    s_nop 0
    buffer_load_dwordx4 v8, s[48:51], s69 offen lds
    s_add_u32 s69, s69, 0x40000
    s_waitcnt vmcnt(6)
    v_cmp_eq_u32 vcc, 0, v22
    s_mov_b32 s34, 0
    s_cbranch_vccz L_go2Q
L_poll2Q:
    buffer_load_dword v22, v10, s[56:59], s87 offen offset:32 sc1
    s_add_u32 s34, s34, 1
    s_waitcnt vmcnt(0)
    v_cmp_eq_u32 vcc, 0, v22
    s_cmp_gt_u32 s34, 200000
    s_cbranch_scc1 L_go2Q
    s_cbranch_vccnz L_poll2Q
L_go2Q:
    v_add_u32 v16, 4294868992, v16
    s_waitcnt vmcnt(15) lgkmcnt(6)
    v_mfma_f32_16x16x32_bf16 v[24:27], v[88:91], v[120:123], v[24:27]
    ds_read_b64_tr_b16 v[104:105], v16 offset:0
    v_mfma_f32_16x16x32_bf16 v[28:31], v[88:91], v[124:127], v[28:31]
    ds_read_b64_tr_b16 v[106:107], v16 offset:4096
    buffer_load_dwordx4 v[168:171], v9, s[44:47], s91 offen offset:0 sc1
    v_add_u32 v17, 4294868992, v17
    s_waitcnt lgkmcnt(6)
    v_mfma_f32_16x16x32_bf16 v[32:35], v[92:95], v[120:123], v[32:35]
    ds_read_b64_tr_b16 v[108:109], v17 offset:0
    v_mfma_f32_16x16x32_bf16 v[36:39], v[92:95], v[124:127], v[36:39]
    ds_read_b64_tr_b16 v[110:111], v17 offset:4096
    v_add_u32 v18, 4294868992, v18
    s_waitcnt lgkmcnt(6)
    v_mfma_f32_16x16x32_bf16 v[40:43], v[96:99], v[120:123], v[40:43]
    ds_read_b64_tr_b16 v[112:113], v18 offset:0
    v_mfma_f32_16x16x32_bf16 v[44:47], v[96:99], v[124:127], v[44:47]
    ds_read_b64_tr_b16 v[114:115], v18 offset:4096
    buffer_load_dwordx4 v[172:175], v9, s[44:47], s91 offen offset:1024 sc1
    s_add_u32 s91, s91, 0x20000
    v_add_u32 v19, 4294868992, v19
    s_waitcnt lgkmcnt(6)
    v_mfma_f32_16x16x32_bf16 v[48:51], v[100:103], v[120:123], v[48:51]
    ds_read_b64_tr_b16 v[116:117], v19 offset:0
    v_mfma_f32_16x16x32_bf16 v[52:55], v[100:103], v[124:127], v[52:55]
    ds_read_b64_tr_b16 v[118:119], v19 offset:4096
    s_waitcnt lgkmcnt(6)
    v_mfma_f32_16x16x32_bf16 v[56:59], v[104:107], v[120:123], v[56:59]
    ds_read_b64_tr_b16 v[88:89], v12 offset:8192
    v_mfma_f32_16x16x32_bf16 v[60:63], v[104:107], v[124:127], v[60:63]
    ds_read_b64_tr_b16 v[90:91], v12 offset:12288
    buffer_load_dwordx4 v[176:179], v9, s[44:47], s91 offen offset:0 sc1
    s_waitcnt lgkmcnt(6)
    v_mfma_f32_16x16x32_bf16 v[64:67], v[108:111], v[120:123], v[64:67]
    ds_read_b64_tr_b16 v[92:93], v13 offset:8192
    v_mfma_f32_16x16x32_bf16 v[68:71], v[108:111], v[124:127], v[68:71]
    ds_read_b64_tr_b16 v[94:95], v13 offset:12288
    s_waitcnt lgkmcnt(6)
    v_mfma_f32_16x16x32_bf16 v[72:75], v[112:115], v[120:123], v[72:75]
    ds_read_b64_tr_b16 v[96:97], v14 offset:8192
    v_mfma_f32_16x16x32_bf16 v[76:79], v[112:115], v[124:127], v[76:79]
    ds_read_b64_tr_b16 v[98:99], v14 offset:12288
    buffer_load_dwordx4 v[180:183], v9, s[44:47], s91 offen offset:1024 sc1
    s_add_u32 s91, s91, 0x20000
    s_waitcnt lgkmcnt(6)
    v_mfma_f32_16x16x32_bf16 v[80:83], v[116:119], v[120:123], v[80:83]
    ds_read_b64_tr_b16 v[100:101], v15 offset:8192
    v_mfma_f32_16x16x32_bf16 v[84:87], v[116:119], v[124:127], v[84:87]
    ds_read_b64_tr_b16 v[102:103], v15 offset:12288
    s_waitcnt vmcnt(15) lgkmcnt(6)
    v_mfma_f32_16x16x32_bf16 v[24:27], v[88:91], v[128:131], v[24:27]
    ds_read_b64_tr_b16 v[104:105], v16 offset:8192
    v_mfma_f32_16x16x32_bf16 v[28:31], v[88:91], v[132:135], v[28:31]
    ds_read_b64_tr_b16 v[106:107], v16 offset:12288
    buffer_load_dwordx4 v[184:187], v9, s[44:47], s91 offen offset:0 sc1
    s_waitcnt lgkmcnt(6)
    v_mfma_f32_16x16x32_bf16 v[32:35], v[92:95], v[128:131], v[32:35]
    ds_read_b64_tr_b16 v[108:109], v17 offset:8192
    v_mfma_f32_16x16x32_bf16 v[36:39], v[92:95], v[132:135], v[36:39]
    ds_read_b64_tr_b16 v[110:111], v17 offset:12288
    s_waitcnt lgkmcnt(6)
    v_mfma_f32_16x16x32_bf16 v[40:43], v[96:99], v[128:131], v[40:43]
    ds_read_b64_tr_b16 v[112:113], v18 offset:8192
    v_mfma_f32_16x16x32_bf16 v[44:47], v[96:99], v[132:135], v[44:47]
    ds_read_b64_tr_b16 v[114:115], v18 offset:12288
    buffer_load_dwordx4 v[188:191], v9, s[44:47], s91 offen offset:1024 sc1
    s_add_u32 s91, s91, 0x20000
    s_waitcnt lgkmcnt(6)
    v_mfma_f32_16x16x32_bf16 v[48:51], v[100:103], v[128:131], v[48:51]
    ds_read_b64_tr_b16 v[116:117], v19 offset:8192
    v_mfma_f32_16x16x32_bf16 v[52:55], v[100:103], v[132:135], v[52:55]
    ds_read_b64_tr_b16 v[118:119], v19 offset:12288
    s_waitcnt lgkmcnt(6)
    v_mfma_f32_16x16x32_bf16 v[56:59], v[104:107], v[128:131], v[56:59]
    ds_read_b64_tr_b16 v[88:89], v12 offset:16384
    v_mfma_f32_16x16x32_bf16 v[60:63], v[104:107], v[132:135], v[60:63]
    ds_read_b64_tr_b16 v[90:91], v12 offset:20480
    buffer_load_dwordx4 v[192:195], v9, s[44:47], s91 offen offset:0 sc1
    s_waitcnt lgkmcnt(6)
    v_mfma_f32_16x16x32_bf16 v[64:67], v[108:111], v[128:131], v[64:67]
    ds_read_b64_tr_b16 v[92:93], v13 offset:16384
    v_mfma_f32_16x16x32_bf16 v[68:71], v[108:111], v[132:135], v[68:71]
    ds_read_b64_tr_b16 v[94:95], v13 offset:20480
    s_waitcnt lgkmcnt(6)
    v_mfma_f32_16x16x32_bf16 v[72:75], v[112:115], v[128:131], v[72:75]
    ds_read_b64_tr_b16 v[96:97], v14 offset:16384
    v_mfma_f32_16x16x32_bf16 v[76:79], v[112:115], v[132:135], v[76:79]
    ds_read_b64_tr_b16 v[98:99], v14 offset:20480
    buffer_load_dwordx4 v[196:199], v9, s[44:47], s91 offen offset:1024 sc1
    s_add_u32 s91, s91, 0x20000
    s_waitcnt lgkmcnt(6)
    v_mfma_f32_16x16x32_bf16 v[80:83], v[116:119], v[128:131], v[80:83]
    ds_read_b64_tr_b16 v[100:101], v15 offset:16384
    v_mfma_f32_16x16x32_bf16 v[84:87], v[116:119], v[132:135], v[84:87]
    ds_read_b64_tr_b16 v[102:103], v15 offset:20480
    s_waitcnt vmcnt(15) lgkmcnt(6)
    v_mfma_f32_16x16x32_bf16 v[24:27], v[88:91], v[136:139], v[24:27]
    ds_read_b64_tr_b16 v[104:105], v16 offset:16384
    v_mfma_f32_16x16x32_bf16 v[28:31], v[88:91], v[140:143], v[28:31]
    ds_read_b64_tr_b16 v[106:107], v16 offset:20480
    buffer_load_dwordx4 v[200:203], v9, s[44:47], s91 offen offset:0 sc1
    s_waitcnt lgkmcnt(6)
    v_mfma_f32_16x16x32_bf16 v[32:35], v[92:95], v[136:139], v[32:35]
    ds_read_b64_tr_b16 v[108:109], v17 offset:16384
    v_mfma_f32_16x16x32_bf16 v[36:39], v[92:95], v[140:143], v[36:39]
    ds_read_b64_tr_b16 v[110:111], v17 offset:20480
    s_waitcnt lgkmcnt(6)
    v_mfma_f32_16x16x32_bf16 v[40:43], v[96:99], v[136:139], v[40:43]
    ds_read_b64_tr_b16 v[112:113], v18 offset:16384
    v_mfma_f32_16x16x32_bf16 v[44:47], v[96:99], v[140:143], v[44:47]
    ds_read_b64_tr_b16 v[114:115], v18 offset:20480
    buffer_load_dwordx4 v[204:207], v9, s[44:47], s91 offen offset:1024 sc1
    s_add_u32 s91, s91, 0x20000
    s_waitcnt lgkmcnt(6)
    v_mfma_f32_16x16x32_bf16 v[48:51], v[100:103], v[136:139], v[48:51]
    ds_read_b64_tr_b16 v[116:117], v19 offset:16384
    v_mfma_f32_16x16x32_bf16 v[52:55], v[100:103], v[140:143], v[52:55]
    ds_read_b64_tr_b16 v[118:119], v19 offset:20480
    s_cmp_lt_u32 s28, 4
    s_cbranch_scc1 L_skQY224
    s_waitcnt vmcnt(18)
    s_barrier
L_skQY224:
    s_waitcnt lgkmcnt(6)
    v_mfma_f32_16x16x32_bf16 v[56:59], v[104:107], v[136:139], v[56:59]
    ds_read_b64_tr_b16 v[88:89], v12 offset:24576
    v_mfma_f32_16x16x32_bf16 v[60:63], v[104:107], v[140:143], v[60:63]
    ds_read_b64_tr_b16 v[90:91], v12 offset:28672
    buffer_load_dwordx4 v[208:211], v9, s[44:47], s91 offen offset:0 sc1
    s_waitcnt lgkmcnt(6)
    v_mfma_f32_16x16x32_bf16 v[64:67], v[108:111], v[136:139], v[64:67]
    ds_read_b64_tr_b16 v[92:93], v13 offset:24576
    v_mfma_f32_16x16x32_bf16 v[68:71], v[108:111], v[140:143], v[68:71]
    ds_read_b64_tr_b16 v[94:95], v13 offset:28672
    s_waitcnt lgkmcnt(6)
    v_mfma_f32_16x16x32_bf16 v[72:75], v[112:115], v[136:139], v[72:75]
    ds_read_b64_tr_b16 v[96:97], v14 offset:24576
    v_mfma_f32_16x16x32_bf16 v[76:79], v[112:115], v[140:143], v[76:79]
    ds_read_b64_tr_b16 v[98:99], v14 offset:28672
    buffer_load_dwordx4 v[212:215], v9, s[44:47], s91 offen offset:1024 sc1
    s_add_u32 s91, s91, 0x20000
    s_waitcnt lgkmcnt(6)
    v_mfma_f32_16x16x32_bf16 v[80:83], v[116:119], v[136:139], v[80:83]
    ds_read_b64_tr_b16 v[100:101], v15 offset:24576
    v_mfma_f32_16x16x32_bf16 v[84:87], v[116:119], v[140:143], v[84:87]
    ds_read_b64_tr_b16 v[102:103], v15 offset:28672
    s_waitcnt vmcnt(16) lgkmcnt(6)
    v_mfma_f32_16x16x32_bf16 v[24:27], v[88:91], v[144:147], v[24:27]
    ds_read_b64_tr_b16 v[104:105], v16 offset:24576
    v_mfma_f32_16x16x32_bf16 v[28:31], v[88:91], v[148:151], v[28:31]
    ds_read_b64_tr_b16 v[106:107], v16 offset:28672
    buffer_load_dwordx4 v[216:219], v9, s[44:47], s91 offen offset:0 sc1
    s_waitcnt lgkmcnt(6)
    v_mfma_f32_16x16x32_bf16 v[32:35], v[92:95], v[144:147], v[32:35]
    ds_read_b64_tr_b16 v[108:109], v17 offset:24576
    v_mfma_f32_16x16x32_bf16 v[36:39], v[92:95], v[148:151], v[36:39]
    ds_read_b64_tr_b16 v[110:111], v17 offset:28672
    s_waitcnt lgkmcnt(6)
    v_mfma_f32_16x16x32_bf16 v[40:43], v[96:99], v[144:147], v[40:43]
    ds_read_b64_tr_b16 v[112:113], v18 offset:24576
    v_mfma_f32_16x16x32_bf16 v[44:47], v[96:99], v[148:151], v[44:47]
    ds_read_b64_tr_b16 v[114:115], v18 offset:28672
    buffer_load_dwordx4 v[220:223], v9, s[44:47], s91 offen offset:1024 sc1
    s_add_u32 s91, s91, 0x20000
    s_waitcnt lgkmcnt(6)
    v_mfma_f32_16x16x32_bf16 v[48:51], v[100:103], v[144:147], v[48:51]
    ds_read_b64_tr_b16 v[116:117], v19 offset:24576
    v_mfma_f32_16x16x32_bf16 v[52:55], v[100:103], v[148:151], v[52:55]
    ds_read_b64_tr_b16 v[118:119], v19 offset:28672
    s_cmp_lt_u32 s28, 4
    s_cbranch_scc0 L_skQX224
    s_waitcnt vmcnt(22)
    s_barrier
L_skQX224:
    s_cmp_lt_u32 s28, 4
    s_cbranch_scc1 L_skQY232
    s_waitcnt vmcnt(14)
    s_barrier
L_skQY232:
    v_add_u32 v14, 32768, v14
    s_waitcnt lgkmcnt(6)
    v_mfma_f32_16x16x32_bf16 v[56:59], v[104:107], v[144:147], v[56:59]
    ds_read_b64_tr_b16 v[88:89], v14 offset:0
    v_mfma_f32_16x16x32_bf16 v[60:63], v[104:107], v[148:151], v[60:63]
    ds_read_b64_tr_b16 v[90:91], v14 offset:4096
    buffer_load_dwordx4 v[224:227], v9, s[44:47], s91 offen offset:0 sc1
    v_add_u32 v15, 32768, v15
    s_waitcnt lgkmcnt(6)
    v_mfma_f32_16x16x32_bf16 v[64:67], v[108:111], v[144:147], v[64:67]
    ds_read_b64_tr_b16 v[92:93], v15 offset:0
    v_mfma_f32_16x16x32_bf16 v[68:71], v[108:111], v[148:151], v[68:71]
    ds_read_b64_tr_b16 v[94:95], v15 offset:4096
    v_add_u32 v16, 32768, v16
    s_waitcnt lgkmcnt(6)
    v_mfma_f32_16x16x32_bf16 v[72:75], v[112:115], v[144:147], v[72:75]
    ds_read_b64_tr_b16 v[96:97], v14 offset:8192
    v_mfma_f32_16x16x32_bf16 v[76:79], v[112:115], v[148:151], v[76:79]
    ds_read_b64_tr_b16 v[98:99], v14 offset:12288
    buffer_load_dwordx4 v[228:231], v9, s[44:47], s91 offen offset:1024 sc1
    s_add_u32 s91, s91, 0x20000
    v_add_u32 v17, 32768, v17
    s_waitcnt lgkmcnt(6)
    v_mfma_f32_16x16x32_bf16 v[80:83], v[116:119], v[144:147], v[80:83]
    ds_read_b64_tr_b16 v[100:101], v15 offset:8192
    v_mfma_f32_16x16x32_bf16 v[84:87], v[116:119], v[148:151], v[84:87]
    ds_read_b64_tr_b16 v[102:103], v15 offset:12288
    v_add_u32 v18, 32768, v18
    s_waitcnt vmcnt(14) lgkmcnt(6)
    v_mfma_f32_16x16x32_bf16 v[40:43], v[88:91], v[168:171], v[40:43]
    ds_read_b64_tr_b16 v[104:105], v14 offset:16384
    v_mfma_f32_16x16x32_bf16 v[44:47], v[88:91], v[172:175], v[44:47]
    ds_read_b64_tr_b16 v[106:107], v14 offset:20480
    v_add_u32 v19, 32768, v19
    s_waitcnt lgkmcnt(6)
    v_mfma_f32_16x16x32_bf16 v[48:51], v[92:95], v[168:171], v[48:51]
    ds_read_b64_tr_b16 v[108:109], v15 offset:16384
    v_mfma_f32_16x16x32_bf16 v[52:55], v[92:95], v[172:175], v[52:55]
    ds_read_b64_tr_b16 v[110:111], v15 offset:20480
    v_add_u32 v12, 32768, v12
    s_waitcnt vmcnt(12) lgkmcnt(6)
    v_mfma_f32_16x16x32_bf16 v[40:43], v[96:99], v[176:179], v[40:43]
    ds_read_b64_tr_b16 v[112:113], v14 offset:24576
    v_mfma_f32_16x16x32_bf16 v[44:47], v[96:99], v[180:183], v[44:47]
    ds_read_b64_tr_b16 v[114:115], v14 offset:28672
    v_add_u32 v13, 32768, v13
    s_waitcnt lgkmcnt(6)
    v_mfma_f32_16x16x32_bf16 v[48:51], v[100:103], v[176:179], v[48:51]
    ds_read_b64_tr_b16 v[116:117], v15 offset:24576
    v_mfma_f32_16x16x32_bf16 v[52:55], v[100:103], v[180:183], v[52:55]
    ds_read_b64_tr_b16 v[118:119], v15 offset:28672
    s_cmp_lt_u32 s28, 4
    s_cbranch_scc0 L_skQX232
    s_waitcnt vmcnt(16)
    s_barrier
L_skQX232:
    s_waitcnt vmcnt(10) lgkmcnt(6)
    v_mfma_f32_16x16x32_bf16 v[40:43], v[104:107], v[184:187], v[40:43]
    ds_read_b64_tr_b16 v[88:89], v14 offset:32768
    v_mfma_f32_16x16x32_bf16 v[44:47], v[104:107], v[188:191], v[44:47]
    ds_read_b64_tr_b16 v[90:91], v14 offset:36864
    s_waitcnt lgkmcnt(6)
    v_mfma_f32_16x16x32_bf16 v[48:51], v[108:111], v[184:187], v[48:51]
    ds_read_b64_tr_b16 v[92:93], v15 offset:32768
    v_mfma_f32_16x16x32_bf16 v[52:55], v[108:111], v[188:191], v[52:55]
    ds_read_b64_tr_b16 v[94:95], v15 offset:36864
    s_waitcnt vmcnt(8) lgkmcnt(6)
    v_mfma_f32_16x16x32_bf16 v[40:43], v[112:115], v[192:195], v[40:43]
    ds_read_b64_tr_b16 v[96:97], v14 offset:40960
    v_mfma_f32_16x16x32_bf16 v[44:47], v[112:115], v[196:199], v[44:47]
    ds_read_b64_tr_b16 v[98:99], v14 offset:45056
    s_waitcnt lgkmcnt(6)
    v_mfma_f32_16x16x32_bf16 v[48:51], v[116:119], v[192:195], v[48:51]
    ds_read_b64_tr_b16 v[100:101], v15 offset:40960
    v_mfma_f32_16x16x32_bf16 v[52:55], v[116:119], v[196:199], v[52:55]
    ds_read_b64_tr_b16 v[102:103], v15 offset:45056
    s_waitcnt vmcnt(6) lgkmcnt(6)
    v_mfma_f32_16x16x32_bf16 v[40:43], v[88:91], v[200:203], v[40:43]
    ds_read_b64_tr_b16 v[104:105], v14 offset:49152
    v_mfma_f32_16x16x32_bf16 v[44:47], v[88:91], v[204:207], v[44:47]
    ds_read_b64_tr_b16 v[106:107], v14 offset:53248
    s_waitcnt lgkmcnt(6)
    v_mfma_f32_16x16x32_bf16 v[48:51], v[92:95], v[200:203], v[48:51]
    ds_read_b64_tr_b16 v[108:109], v15 offset:49152
    v_mfma_f32_16x16x32_bf16 v[52:55], v[92:95], v[204:207], v[52:55]
    ds_read_b64_tr_b16 v[110:111], v15 offset:53248
    s_waitcnt vmcnt(4) lgkmcnt(6)
    v_mfma_f32_16x16x32_bf16 v[40:43], v[96:99], v[208:211], v[40:43]
    ds_read_b64_tr_b16 v[112:113], v14 offset:57344
    v_mfma_f32_16x16x32_bf16 v[44:47], v[96:99], v[212:215], v[44:47]
    ds_read_b64_tr_b16 v[114:115], v14 offset:61440
    s_waitcnt lgkmcnt(6)
    v_mfma_f32_16x16x32_bf16 v[48:51], v[100:103], v[208:211], v[48:51]
    ds_read_b64_tr_b16 v[116:117], v15 offset:57344
    v_mfma_f32_16x16x32_bf16 v[52:55], v[100:103], v[212:215], v[52:55]
    ds_read_b64_tr_b16 v[118:119], v15 offset:61440
    s_waitcnt vmcnt(2) lgkmcnt(6)
    v_mfma_f32_16x16x32_bf16 v[40:43], v[104:107], v[216:219], v[40:43]
    ds_read_b64_tr_b16 v[88:89], v16 offset:0
    v_mfma_f32_16x16x32_bf16 v[44:47], v[104:107], v[220:223], v[44:47]
    ds_read_b64_tr_b16 v[90:91], v16 offset:4096
    s_waitcnt lgkmcnt(6)
    v_mfma_f32_16x16x32_bf16 v[48:51], v[108:111], v[216:219], v[48:51]
    ds_read_b64_tr_b16 v[92:93], v17 offset:0
    v_mfma_f32_16x16x32_bf16 v[52:55], v[108:111], v[220:223], v[52:55]
    ds_read_b64_tr_b16 v[94:95], v17 offset:4096
    s_waitcnt vmcnt(0) lgkmcnt(6)
    v_mfma_f32_16x16x32_bf16 v[40:43], v[112:115], v[224:227], v[40:43]
    ds_read_b64_tr_b16 v[96:97], v16 offset:8192
    v_mfma_f32_16x16x32_bf16 v[44:47], v[112:115], v[228:231], v[44:47]
    ds_read_b64_tr_b16 v[98:99], v16 offset:12288
    s_waitcnt lgkmcnt(6)
    v_mfma_f32_16x16x32_bf16 v[48:51], v[116:119], v[224:227], v[48:51]
    ds_read_b64_tr_b16 v[100:101], v17 offset:8192
    v_mfma_f32_16x16x32_bf16 v[52:55], v[116:119], v[228:231], v[52:55]
    ds_read_b64_tr_b16 v[102:103], v17 offset:12288
    s_waitcnt lgkmcnt(6)
    v_mfma_f32_16x16x32_bf16 v[56:59], v[88:91], v[168:171], v[56:59]
    ds_read_b64_tr_b16 v[104:105], v16 offset:16384
    v_mfma_f32_16x16x32_bf16 v[60:63], v[88:91], v[172:175], v[60:63]
    ds_read_b64_tr_b16 v[106:107], v16 offset:20480
    s_xor_b32 s93, s64, 1
    s_mul_i32 s93, s93, 49152
    s_add_u32 s93, s93, s92
    s_add_u32 s93, s93, 0
    s_waitcnt lgkmcnt(6)
    v_mfma_f32_16x16x32_bf16 v[64:67], v[92:95], v[168:171], v[64:67]
    ds_read_b64_tr_b16 v[108:109], v17 offset:16384
    v_mfma_f32_16x16x32_bf16 v[68:71], v[92:95], v[172:175], v[68:71]
    ds_read_b64_tr_b16 v[110:111], v17 offset:20480
    v_cvt_pk_bf16_f32 v120, v40, v41
    v_cvt_pk_bf16_f32 v121, v42, v43
    v_cvt_pk_bf16_f32 v122, v48, v49
    v_cvt_pk_bf16_f32 v123, v50, v51
    buffer_store_dwordx4 v[120:123], v11, s[56:59], s93 offen offset:0 sc1
    s_waitcnt lgkmcnt(6)
    v_mfma_f32_16x16x32_bf16 v[56:59], v[96:99], v[176:179], v[56:59]
    ds_read_b64_tr_b16 v[112:113], v16 offset:24576
    v_mfma_f32_16x16x32_bf16 v[60:63], v[96:99], v[180:183], v[60:63]
    ds_read_b64_tr_b16 v[114:115], v16 offset:28672
    v_cvt_pk_bf16_f32 v124, v44, v45
    v_cvt_pk_bf16_f32 v125, v46, v47
    v_cvt_pk_bf16_f32 v126, v52, v53
    v_cvt_pk_bf16_f32 v127, v54, v55
    buffer_store_dwordx4 v[124:127], v11, s[56:59], s93 offen offset:1024 sc1
    s_waitcnt lgkmcnt(6)
    v_mfma_f32_16x16x32_bf16 v[64:67], v[100:103], v[176:179], v[64:67]
    ds_read_b64_tr_b16 v[116:117], v17 offset:24576
    v_mfma_f32_16x16x32_bf16 v[68:71], v[100:103], v[180:183], v[68:71]
    ds_read_b64_tr_b16 v[118:119], v17 offset:28672
    s_waitcnt lgkmcnt(6)
    v_mfma_f32_16x16x32_bf16 v[56:59], v[104:107], v[184:187], v[56:59]
    ds_read_b64_tr_b16 v[88:89], v16 offset:32768
    v_mfma_f32_16x16x32_bf16 v[60:63], v[104:107], v[188:191], v[60:63]
    ds_read_b64_tr_b16 v[90:91], v16 offset:36864
    s_waitcnt lgkmcnt(6)
    v_mfma_f32_16x16x32_bf16 v[64:67], v[108:111], v[184:187], v[64:67]
    ds_read_b64_tr_b16 v[92:93], v17 offset:32768
    v_mfma_f32_16x16x32_bf16 v[68:71], v[108:111], v[188:191], v[68:71]
    ds_read_b64_tr_b16 v[94:95], v17 offset:36864
    s_waitcnt lgkmcnt(6)
    v_mfma_f32_16x16x32_bf16 v[56:59], v[112:115], v[192:195], v[56:59]
    ds_read_b64_tr_b16 v[96:97], v16 offset:40960
    v_mfma_f32_16x16x32_bf16 v[60:63], v[112:115], v[196:199], v[60:63]
    ds_read_b64_tr_b16 v[98:99], v16 offset:45056
    s_waitcnt vmcnt(35)
    v_lshlrev_b32 v40, 16, v232
    v_and_b32 v41, 0xffff0000, v232
    v_lshlrev_b32 v48, 16, v236
    v_and_b32 v49, 0xffff0000, v236
    s_waitcnt lgkmcnt(6)
    v_mfma_f32_16x16x32_bf16 v[64:67], v[116:119], v[192:195], v[64:67]
    ds_read_b64_tr_b16 v[100:101], v17 offset:40960
    v_mfma_f32_16x16x32_bf16 v[68:71], v[116:119], v[196:199], v[68:71]
    ds_read_b64_tr_b16 v[102:103], v17 offset:45056
    v_lshlrev_b32 v0, 16, v240
    v_and_b32 v20, 0xffff0000, v240
    v_add_f32 v40, v40, v0
    v_add_f32 v41, v41, v20
    v_add_f32 v48, v48, v0
    s_waitcnt lgkmcnt(6)
    v_mfma_f32_16x16x32_bf16 v[56:59], v[88:91], v[200:203], v[56:59]
    ds_read_b64_tr_b16 v[104:105], v16 offset:49152
    v_mfma_f32_16x16x32_bf16 v[60:63], v[88:91], v[204:207], v[60:63]
    ds_read_b64_tr_b16 v[106:107], v16 offset:53248
    v_add_f32 v49, v49, v20
    v_lshlrev_b32 v42, 16, v233
    v_and_b32 v43, 0xffff0000, v233
    v_lshlrev_b32 v50, 16, v237
    v_and_b32 v51, 0xffff0000, v237
    s_waitcnt lgkmcnt(6)
    v_mfma_f32_16x16x32_bf16 v[64:67], v[92:95], v[200:203], v[64:67]
    ds_read_b64_tr_b16 v[108:109], v17 offset:49152
    v_mfma_f32_16x16x32_bf16 v[68:71], v[92:95], v[204:207], v[68:71]
    ds_read_b64_tr_b16 v[110:111], v17 offset:53248
    v_lshlrev_b32 v0, 16, v241
    v_and_b32 v20, 0xffff0000, v241
    v_add_f32 v42, v42, v0
    v_add_f32 v43, v43, v20
    v_add_f32 v50, v50, v0
    s_waitcnt lgkmcnt(6)
    v_mfma_f32_16x16x32_bf16 v[56:59], v[96:99], v[208:211], v[56:59]
    ds_read_b64_tr_b16 v[112:113], v16 offset:57344
    v_mfma_f32_16x16x32_bf16 v[60:63], v[96:99], v[212:215], v[60:63]
    ds_read_b64_tr_b16 v[114:115], v16 offset:61440
    v_add_f32 v51, v51, v20
    v_lshlrev_b32 v44, 16, v234
    v_and_b32 v45, 0xffff0000, v234
    v_lshlrev_b32 v52, 16, v238
    v_and_b32 v53, 0xffff0000, v238
    s_waitcnt lgkmcnt(6)
    v_mfma_f32_16x16x32_bf16 v[64:67], v[100:103], v[208:211], v[64:67]
    ds_read_b64_tr_b16 v[116:117], v17 offset:57344
    v_mfma_f32_16x16x32_bf16 v[68:71], v[100:103], v[212:215], v[68:71]
    ds_read_b64_tr_b16 v[118:119], v17 offset:61440
    v_lshlrev_b32 v0, 16, v242
    v_and_b32 v20, 0xffff0000, v242
    v_add_f32 v44, v44, v0
    v_add_f32 v45, v45, v20
    v_add_f32 v52, v52, v0
    s_waitcnt lgkmcnt(6)
    v_mfma_f32_16x16x32_bf16 v[56:59], v[104:107], v[216:219], v[56:59]
    ds_read_b64_tr_b16 v[88:89], v18 offset:0
    v_mfma_f32_16x16x32_bf16 v[60:63], v[104:107], v[220:223], v[60:63]
    ds_read_b64_tr_b16 v[90:91], v18 offset:4096
    v_add_f32 v53, v53, v20
    v_lshlrev_b32 v46, 16, v235
    v_and_b32 v47, 0xffff0000, v235
    v_lshlrev_b32 v54, 16, v239
    v_and_b32 v55, 0xffff0000, v239
    s_waitcnt lgkmcnt(6)
    v_mfma_f32_16x16x32_bf16 v[64:67], v[108:111], v[216:219], v[64:67]
    ds_read_b64_tr_b16 v[92:93], v19 offset:0
    v_mfma_f32_16x16x32_bf16 v[68:71], v[108:111], v[220:223], v[68:71]
    ds_read_b64_tr_b16 v[94:95], v19 offset:4096
    v_lshlrev_b32 v0, 16, v243
    v_and_b32 v20, 0xffff0000, v243
    v_add_f32 v46, v46, v0
    v_add_f32 v47, v47, v20
    v_add_f32 v54, v54, v0
    s_waitcnt lgkmcnt(6)
    v_mfma_f32_16x16x32_bf16 v[56:59], v[112:115], v[224:227], v[56:59]
    ds_read_b64_tr_b16 v[96:97], v18 offset:8192
    v_mfma_f32_16x16x32_bf16 v[60:63], v[112:115], v[228:231], v[60:63]
    ds_read_b64_tr_b16 v[98:99], v18 offset:12288
    v_add_f32 v55, v55, v20
    v_mul_f32 v244, v244, v244
    v_mul_f32 v245, v245, v245
    s_waitcnt lgkmcnt(6)
    v_mfma_f32_16x16x32_bf16 v[64:67], v[116:119], v[224:227], v[64:67]
    ds_read_b64_tr_b16 v[100:101], v19 offset:8192
    v_mfma_f32_16x16x32_bf16 v[68:71], v[116:119], v[228:231], v[68:71]
    ds_read_b64_tr_b16 v[102:103], v19 offset:12288
    s_waitcnt lgkmcnt(6)
    v_mfma_f32_16x16x32_bf16 v[72:75], v[88:91], v[168:171], v[72:75]
    ds_read_b64_tr_b16 v[104:105], v18 offset:16384
    v_mfma_f32_16x16x32_bf16 v[76:79], v[88:91], v[172:175], v[76:79]
    ds_read_b64_tr_b16 v[106:107], v18 offset:20480
    s_xor_b32 s93, s64, 2
    s_mul_i32 s93, s93, 49152
    s_add_u32 s93, s93, s92
    s_add_u32 s93, s93, 16384
    s_waitcnt lgkmcnt(6)
    v_mfma_f32_16x16x32_bf16 v[80:83], v[92:95], v[168:171], v[80:83]
    ds_read_b64_tr_b16 v[108:109], v19 offset:16384
    v_mfma_f32_16x16x32_bf16 v[84:87], v[92:95], v[172:175], v[84:87]
    ds_read_b64_tr_b16 v[110:111], v19 offset:20480
    v_cvt_pk_bf16_f32 v128, v56, v57
    v_cvt_pk_bf16_f32 v129, v58, v59
    v_cvt_pk_bf16_f32 v130, v64, v65
    v_cvt_pk_bf16_f32 v131, v66, v67
    buffer_store_dwordx4 v[128:131], v11, s[56:59], s93 offen offset:0 sc1
    s_waitcnt lgkmcnt(6)
    v_mfma_f32_16x16x32_bf16 v[72:75], v[96:99], v[176:179], v[72:75]
    ds_read_b64_tr_b16 v[112:113], v18 offset:24576
    v_mfma_f32_16x16x32_bf16 v[76:79], v[96:99], v[180:183], v[76:79]
    ds_read_b64_tr_b16 v[114:115], v18 offset:28672
    v_cvt_pk_bf16_f32 v132, v60, v61
    v_cvt_pk_bf16_f32 v133, v62, v63
    v_cvt_pk_bf16_f32 v134, v68, v69
    v_cvt_pk_bf16_f32 v135, v70, v71
    buffer_store_dwordx4 v[132:135], v11, s[56:59], s93 offen offset:1024 sc1
    s_waitcnt lgkmcnt(6)
    v_mfma_f32_16x16x32_bf16 v[80:83], v[100:103], v[176:179], v[80:83]
    ds_read_b64_tr_b16 v[116:117], v19 offset:24576
    v_mfma_f32_16x16x32_bf16 v[84:87], v[100:103], v[180:183], v[84:87]
    ds_read_b64_tr_b16 v[118:119], v19 offset:28672
    s_waitcnt lgkmcnt(6)
    v_mfma_f32_16x16x32_bf16 v[72:75], v[104:107], v[184:187], v[72:75]
    ds_read_b64_tr_b16 v[88:89], v18 offset:32768
    v_mfma_f32_16x16x32_bf16 v[76:79], v[104:107], v[188:191], v[76:79]
    ds_read_b64_tr_b16 v[90:91], v18 offset:36864
    s_waitcnt lgkmcnt(6)
    v_mfma_f32_16x16x32_bf16 v[80:83], v[108:111], v[184:187], v[80:83]
    ds_read_b64_tr_b16 v[92:93], v19 offset:32768
    v_mfma_f32_16x16x32_bf16 v[84:87], v[108:111], v[188:191], v[84:87]
    ds_read_b64_tr_b16 v[94:95], v19 offset:36864
    s_waitcnt lgkmcnt(6)
    v_mfma_f32_16x16x32_bf16 v[72:75], v[112:115], v[192:195], v[72:75]
    ds_read_b64_tr_b16 v[96:97], v18 offset:40960
    v_mfma_f32_16x16x32_bf16 v[76:79], v[112:115], v[196:199], v[76:79]
    ds_read_b64_tr_b16 v[98:99], v18 offset:45056
    s_waitcnt lgkmcnt(6)
    v_mfma_f32_16x16x32_bf16 v[80:83], v[116:119], v[192:195], v[80:83]
    ds_read_b64_tr_b16 v[100:101], v19 offset:40960
    v_mfma_f32_16x16x32_bf16 v[84:87], v[116:119], v[196:199], v[84:87]
    ds_read_b64_tr_b16 v[102:103], v19 offset:45056
    s_waitcnt lgkmcnt(6)
    v_mfma_f32_16x16x32_bf16 v[72:75], v[88:91], v[200:203], v[72:75]
    ds_read_b64_tr_b16 v[104:105], v18 offset:49152
    v_mfma_f32_16x16x32_bf16 v[76:79], v[88:91], v[204:207], v[76:79]
    ds_read_b64_tr_b16 v[106:107], v18 offset:53248
    s_waitcnt lgkmcnt(6)
    v_mfma_f32_16x16x32_bf16 v[80:83], v[92:95], v[200:203], v[80:83]
    ds_read_b64_tr_b16 v[108:109], v19 offset:49152
    v_mfma_f32_16x16x32_bf16 v[84:87], v[92:95], v[204:207], v[84:87]
    ds_read_b64_tr_b16 v[110:111], v19 offset:53248
    s_waitcnt lgkmcnt(6)
    v_mfma_f32_16x16x32_bf16 v[72:75], v[96:99], v[208:211], v[72:75]
    ds_read_b64_tr_b16 v[112:113], v18 offset:57344
    v_mfma_f32_16x16x32_bf16 v[76:79], v[96:99], v[212:215], v[76:79]
    ds_read_b64_tr_b16 v[114:115], v18 offset:61440
    s_waitcnt lgkmcnt(6)
    v_mfma_f32_16x16x32_bf16 v[80:83], v[100:103], v[208:211], v[80:83]
    ds_read_b64_tr_b16 v[116:117], v19 offset:57344
    v_mfma_f32_16x16x32_bf16 v[84:87], v[100:103], v[212:215], v[84:87]
    ds_read_b64_tr_b16 v[118:119], v19 offset:61440
    s_waitcnt lgkmcnt(6)
    v_mfma_f32_16x16x32_bf16 v[72:75], v[104:107], v[216:219], v[72:75]
    ds_read_b64_tr_b16 v[88:89], v12 offset:0
    v_mfma_f32_16x16x32_bf16 v[76:79], v[104:107], v[220:223], v[76:79]
    ds_read_b64_tr_b16 v[90:91], v12 offset:4096
    s_waitcnt lgkmcnt(6)
    v_mfma_f32_16x16x32_bf16 v[80:83], v[108:111], v[216:219], v[80:83]
    ds_read_b64_tr_b16 v[92:93], v13 offset:0
    v_mfma_f32_16x16x32_bf16 v[84:87], v[108:111], v[220:223], v[84:87]
    ds_read_b64_tr_b16 v[94:95], v13 offset:4096
    s_waitcnt lgkmcnt(6)
    v_mfma_f32_16x16x32_bf16 v[72:75], v[112:115], v[224:227], v[72:75]
    ds_read_b64_tr_b16 v[96:97], v12 offset:8192
    v_mfma_f32_16x16x32_bf16 v[76:79], v[112:115], v[228:231], v[76:79]
    ds_read_b64_tr_b16 v[98:99], v12 offset:12288
    s_waitcnt lgkmcnt(6)
    v_mfma_f32_16x16x32_bf16 v[80:83], v[116:119], v[224:227], v[80:83]
    ds_read_b64_tr_b16 v[100:101], v13 offset:8192
    v_mfma_f32_16x16x32_bf16 v[84:87], v[116:119], v[228:231], v[84:87]
    ds_read_b64_tr_b16 v[102:103], v13 offset:12288
    s_waitcnt lgkmcnt(6)
    v_mfma_f32_16x16x32_bf16 v[24:27], v[88:91], v[168:171], v[24:27]
    ds_read_b64_tr_b16 v[104:105], v12 offset:16384
    v_mfma_f32_16x16x32_bf16 v[28:31], v[88:91], v[172:175], v[28:31]
    ds_read_b64_tr_b16 v[106:107], v12 offset:20480
    s_xor_b32 s93, s64, 3
    s_mul_i32 s93, s93, 49152
    s_add_u32 s93, s93, s92
    s_add_u32 s93, s93, 32768
    s_waitcnt lgkmcnt(6)
    v_mfma_f32_16x16x32_bf16 v[32:35], v[92:95], v[168:171], v[32:35]
    ds_read_b64_tr_b16 v[108:109], v13 offset:16384
    v_mfma_f32_16x16x32_bf16 v[36:39], v[92:95], v[172:175], v[36:39]
    ds_read_b64_tr_b16 v[110:111], v13 offset:20480
    v_cvt_pk_bf16_f32 v136, v72, v73
    v_cvt_pk_bf16_f32 v137, v74, v75
    v_cvt_pk_bf16_f32 v138, v80, v81
    v_cvt_pk_bf16_f32 v139, v82, v83
    buffer_store_dwordx4 v[136:139], v11, s[56:59], s93 offen offset:0 sc1
    s_waitcnt lgkmcnt(6)
    v_mfma_f32_16x16x32_bf16 v[24:27], v[96:99], v[176:179], v[24:27]
    ds_read_b64_tr_b16 v[112:113], v12 offset:24576
    v_mfma_f32_16x16x32_bf16 v[28:31], v[96:99], v[180:183], v[28:31]
    ds_read_b64_tr_b16 v[114:115], v12 offset:28672
    v_cvt_pk_bf16_f32 v140, v76, v77
    v_cvt_pk_bf16_f32 v141, v78, v79
    v_cvt_pk_bf16_f32 v142, v84, v85
    v_cvt_pk_bf16_f32 v143, v86, v87
    buffer_store_dwordx4 v[140:143], v11, s[56:59], s93 offen offset:1024 sc1
    s_waitcnt lgkmcnt(6)
    v_mfma_f32_16x16x32_bf16 v[32:35], v[100:103], v[176:179], v[32:35]
    ds_read_b64_tr_b16 v[116:117], v13 offset:24576
    v_mfma_f32_16x16x32_bf16 v[36:39], v[100:103], v[180:183], v[36:39]
    ds_read_b64_tr_b16 v[118:119], v13 offset:28672
    s_waitcnt lgkmcnt(6)
    v_mfma_f32_16x16x32_bf16 v[24:27], v[104:107], v[184:187], v[24:27]
    ds_read_b64_tr_b16 v[88:89], v12 offset:32768
    v_mfma_f32_16x16x32_bf16 v[28:31], v[104:107], v[188:191], v[28:31]
    ds_read_b64_tr_b16 v[90:91], v12 offset:36864
    s_add_u32 s33, s94, 0
    buffer_load_dwordx4 v[144:147], v11, s[56:59], s33 offen offset:0 sc1
    buffer_load_dwordx4 v[156:159], v11, s[56:59], s33 offen offset:1024 sc1
    s_waitcnt lgkmcnt(6)
    v_mfma_f32_16x16x32_bf16 v[32:35], v[108:111], v[184:187], v[32:35]
    ds_read_b64_tr_b16 v[92:93], v13 offset:32768
    v_mfma_f32_16x16x32_bf16 v[36:39], v[108:111], v[188:191], v[36:39]
    ds_read_b64_tr_b16 v[94:95], v13 offset:36864
    s_add_u32 s33, s94, 16384
    buffer_load_dwordx4 v[148:151], v11, s[56:59], s33 offen offset:0 sc1
    buffer_load_dwordx4 v[160:163], v11, s[56:59], s33 offen offset:1024 sc1
    s_waitcnt lgkmcnt(6)
    v_mfma_f32_16x16x32_bf16 v[24:27], v[112:115], v[192:195], v[24:27]
    ds_read_b64_tr_b16 v[96:97], v12 offset:40960
    v_mfma_f32_16x16x32_bf16 v[28:31], v[112:115], v[196:199], v[28:31]
    ds_read_b64_tr_b16 v[98:99], v12 offset:45056
    s_waitcnt lgkmcnt(6)
    v_mfma_f32_16x16x32_bf16 v[32:35], v[116:119], v[192:195], v[32:35]
    ds_read_b64_tr_b16 v[100:101], v13 offset:40960
    v_mfma_f32_16x16x32_bf16 v[36:39], v[116:119], v[196:199], v[36:39]
    ds_read_b64_tr_b16 v[102:103], v13 offset:45056
    s_waitcnt lgkmcnt(6)
    v_mfma_f32_16x16x32_bf16 v[24:27], v[88:91], v[200:203], v[24:27]
    ds_read_b64_tr_b16 v[104:105], v12 offset:49152
    v_mfma_f32_16x16x32_bf16 v[28:31], v[88:91], v[204:207], v[28:31]
    ds_read_b64_tr_b16 v[106:107], v12 offset:53248
    s_waitcnt lgkmcnt(6)
    v_mfma_f32_16x16x32_bf16 v[32:35], v[92:95], v[200:203], v[32:35]
    ds_read_b64_tr_b16 v[108:109], v13 offset:49152
    v_mfma_f32_16x16x32_bf16 v[36:39], v[92:95], v[204:207], v[36:39]
    ds_read_b64_tr_b16 v[110:111], v13 offset:53248
    s_waitcnt lgkmcnt(6)
    v_mfma_f32_16x16x32_bf16 v[24:27], v[96:99], v[208:211], v[24:27]
    ds_read_b64_tr_b16 v[112:113], v12 offset:57344
    v_mfma_f32_16x16x32_bf16 v[28:31], v[96:99], v[212:215], v[28:31]
    ds_read_b64_tr_b16 v[114:115], v12 offset:61440
    s_waitcnt lgkmcnt(6)
    v_mfma_f32_16x16x32_bf16 v[32:35], v[100:103], v[208:211], v[32:35]
    ds_read_b64_tr_b16 v[116:117], v13 offset:57344
    v_mfma_f32_16x16x32_bf16 v[36:39], v[100:103], v[212:215], v[36:39]
    ds_read_b64_tr_b16 v[118:119], v13 offset:61440
    s_waitcnt lgkmcnt(6)
    v_mfma_f32_16x16x32_bf16 v[24:27], v[104:107], v[216:219], v[24:27]
    v_mfma_f32_16x16x32_bf16 v[28:31], v[104:107], v[220:223], v[28:31]
    s_waitcnt lgkmcnt(4)
    v_mfma_f32_16x16x32_bf16 v[32:35], v[108:111], v[216:219], v[32:35]
    v_mfma_f32_16x16x32_bf16 v[36:39], v[108:111], v[220:223], v[36:39]
    s_waitcnt lgkmcnt(2)
    v_mfma_f32_16x16x32_bf16 v[24:27], v[112:115], v[224:227], v[24:27]
    v_mfma_f32_16x16x32_bf16 v[28:31], v[112:115], v[228:231], v[28:31]
    s_waitcnt lgkmcnt(0)
    v_mfma_f32_16x16x32_bf16 v[32:35], v[116:119], v[224:227], v[32:35]
    v_mfma_f32_16x16x32_bf16 v[36:39], v[116:119], v[228:231], v[36:39]
L_exch:
    s_add_u32 s33, s94, 32768
    buffer_load_dwordx4 v[152:155], v11, s[56:59], s33 offen offset:0 sc1
    buffer_load_dwordx4 v[164:167], v11, s[56:59], s33 offen offset:1024 sc1
    s_mov_b32 s60, s12
    s_mov_b32 s61, s13
    s_mov_b32 s62, 4194304
    s_mov_b32 s63, 0x00020000
    s_waitcnt vmcnt(0)
    v_max3_u32 v16, v144, v145, v146
    v_max3_u32 v17, v147, v148, v149
    v_max3_u32 v16, v16, v150, v151
    v_max3_u32 v17, v17, v152, v153
    v_max3_u32 v16, v16, v154, v155
    v_max3_u32 v17, v17, v156, v157
    v_max3_u32 v16, v16, v158, v159
    v_max3_u32 v17, v17, v160, v161
    v_max3_u32 v16, v16, v162, v163
    v_max3_u32 v17, v17, v164, v165
    v_max3_u32 v16, v16, v166, v167
    v_max_u32 v16, v16, v17
    v_cmp_eq_u32 vcc, -1, v16
    s_mov_b32 s34, 0
    s_cbranch_vccz L_go3
L_poll3:
    s_add_u32 s33, s94, 0
    buffer_load_dwordx4 v[144:147], v11, s[56:59], s33 offen offset:0 sc1
    buffer_load_dwordx4 v[156:159], v11, s[56:59], s33 offen offset:1024 sc1
    s_add_u32 s33, s94, 16384
    buffer_load_dwordx4 v[148:151], v11, s[56:59], s33 offen offset:0 sc1
    buffer_load_dwordx4 v[160:163], v11, s[56:59], s33 offen offset:1024 sc1
    s_add_u32 s33, s94, 32768
    buffer_load_dwordx4 v[152:155], v11, s[56:59], s33 offen offset:0 sc1
    buffer_load_dwordx4 v[164:167], v11, s[56:59], s33 offen offset:1024 sc1
    s_add_u32 s34, s34, 1
    s_waitcnt vmcnt(0)
    v_max3_u32 v16, v144, v145, v146
    v_max3_u32 v17, v147, v148, v149
    v_max3_u32 v16, v16, v150, v151
    v_max3_u32 v17, v17, v152, v153
    v_max3_u32 v16, v16, v154, v155
    v_max3_u32 v17, v17, v156, v157
    v_max3_u32 v16, v16, v158, v159
    v_max3_u32 v17, v17, v160, v161
    v_max3_u32 v16, v16, v162, v163
    v_max3_u32 v17, v17, v164, v165
    v_max3_u32 v16, v16, v166, v167
    v_max_u32 v16, v16, v17
    v_cmp_eq_u32 vcc, -1, v16
    s_cmp_gt_u32 s34, 4000
    s_cbranch_scc1 L_go3
    s_cbranch_vccnz L_poll3
L_go3:
    v_lshlrev_b32 v17, 16, v144
    v_and_b32 v18, 0xffff0000, v144
    v_add_f32 v24, v24, v17
    v_add_f32 v25, v25, v18
    v_lshlrev_b32 v17, 16, v145
    v_and_b32 v18, 0xffff0000, v145
    v_add_f32 v26, v26, v17
    v_add_f32 v27, v27, v18
    v_lshlrev_b32 v17, 16, v146
    v_and_b32 v18, 0xffff0000, v146
    v_add_f32 v32, v32, v17
    v_add_f32 v33, v33, v18
    v_lshlrev_b32 v17, 16, v147
    v_and_b32 v18, 0xffff0000, v147
    v_add_f32 v34, v34, v17
    v_add_f32 v35, v35, v18
    v_lshlrev_b32 v17, 16, v148
    v_and_b32 v18, 0xffff0000, v148
    v_add_f32 v24, v24, v17
    v_add_f32 v25, v25, v18
    v_lshlrev_b32 v17, 16, v149
    v_and_b32 v18, 0xffff0000, v149
    v_add_f32 v26, v26, v17
    v_add_f32 v27, v27, v18
    v_lshlrev_b32 v17, 16, v150
    v_and_b32 v18, 0xffff0000, v150
    v_add_f32 v32, v32, v17
    v_add_f32 v33, v33, v18
    v_lshlrev_b32 v17, 16, v151
    v_and_b32 v18, 0xffff0000, v151
    v_add_f32 v34, v34, v17
    v_add_f32 v35, v35, v18
    v_lshlrev_b32 v17, 16, v152
    v_and_b32 v18, 0xffff0000, v152
    v_add_f32 v24, v24, v17
    v_add_f32 v25, v25, v18
    v_lshlrev_b32 v17, 16, v153
    v_and_b32 v18, 0xffff0000, v153
    v_add_f32 v26, v26, v17
    v_add_f32 v27, v27, v18
    v_lshlrev_b32 v17, 16, v154
    v_and_b32 v18, 0xffff0000, v154
    v_add_f32 v32, v32, v17
    v_add_f32 v33, v33, v18
    v_lshlrev_b32 v17, 16, v155
    v_and_b32 v18, 0xffff0000, v155
    v_add_f32 v34, v34, v17
    v_add_f32 v35, v35, v18
    v_permlane16_swap_b32 v24, v32
    v_permlane16_swap_b32 v25, v33
    v_permlane16_swap_b32 v26, v34
    v_permlane16_swap_b32 v27, v35
    v_fma_f32 v24, v24, v244, v40
    v_fma_f32 v32, v32, v244, v44
    v_fma_f32 v25, v25, v244, v41
    v_fma_f32 v33, v33, v244, v45
    v_fma_f32 v26, v26, v244, v42
    v_fma_f32 v34, v34, v244, v46
    v_fma_f32 v27, v27, v244, v43
    v_fma_f32 v35, v35, v244, v47
    v_cvt_pk_bf16_f32 v232, v24, v25
    v_cvt_pk_bf16_f32 v233, v26, v27
    v_cvt_pk_bf16_f32 v234, v32, v33
    v_cvt_pk_bf16_f32 v235, v34, v35
    buffer_store_dwordx4 v[232:235], v246, s[60:63], 0 offen
    v_lshlrev_b32 v17, 16, v156
    v_and_b32 v18, 0xffff0000, v156
    v_add_f32 v28, v28, v17
    v_add_f32 v29, v29, v18
    v_lshlrev_b32 v17, 16, v157
    v_and_b32 v18, 0xffff0000, v157
    v_add_f32 v30, v30, v17
    v_add_f32 v31, v31, v18
    v_lshlrev_b32 v17, 16, v158
    v_and_b32 v18, 0xffff0000, v158
    v_add_f32 v36, v36, v17
    v_add_f32 v37, v37, v18
    v_lshlrev_b32 v17, 16, v159
    v_and_b32 v18, 0xffff0000, v159
    v_add_f32 v38, v38, v17
    v_add_f32 v39, v39, v18
    v_lshlrev_b32 v17, 16, v160
    v_and_b32 v18, 0xffff0000, v160
    v_add_f32 v28, v28, v17
    v_add_f32 v29, v29, v18
    v_lshlrev_b32 v17, 16, v161
    v_and_b32 v18, 0xffff0000, v161
    v_add_f32 v30, v30, v17
    v_add_f32 v31, v31, v18
    v_lshlrev_b32 v17, 16, v162
    v_and_b32 v18, 0xffff0000, v162
    v_add_f32 v36, v36, v17
    v_add_f32 v37, v37, v18
    v_lshlrev_b32 v17, 16, v163
    v_and_b32 v18, 0xffff0000, v163
    v_add_f32 v38, v38, v17
    v_add_f32 v39, v39, v18
    v_lshlrev_b32 v17, 16, v164
    v_and_b32 v18, 0xffff0000, v164
    v_add_f32 v28, v28, v17
    v_add_f32 v29, v29, v18
    v_lshlrev_b32 v17, 16, v165
    v_and_b32 v18, 0xffff0000, v165
    v_add_f32 v30, v30, v17
    v_add_f32 v31, v31, v18
    v_lshlrev_b32 v17, 16, v166
    v_and_b32 v18, 0xffff0000, v166
    v_add_f32 v36, v36, v17
    v_add_f32 v37, v37, v18
    v_lshlrev_b32 v17, 16, v167
    v_and_b32 v18, 0xffff0000, v167
    v_add_f32 v38, v38, v17
    v_add_f32 v39, v39, v18
    v_permlane16_swap_b32 v28, v36
    v_permlane16_swap_b32 v29, v37
    v_permlane16_swap_b32 v30, v38
    v_permlane16_swap_b32 v31, v39
    v_fma_f32 v28, v28, v245, v48
    v_fma_f32 v36, v36, v245, v52
    v_fma_f32 v29, v29, v245, v49
    v_fma_f32 v37, v37, v245, v53
    v_fma_f32 v30, v30, v245, v50
    v_fma_f32 v38, v38, v245, v54
    v_fma_f32 v31, v31, v245, v51
    v_fma_f32 v39, v39, v245, v55
    v_cvt_pk_bf16_f32 v236, v28, v29
    v_cvt_pk_bf16_f32 v237, v30, v31
    v_cvt_pk_bf16_f32 v238, v36, v37
    v_cvt_pk_bf16_f32 v239, v38, v39
    buffer_store_dwordx4 v[236:239], v247, s[60:63], 0 offen
L_done:
    s_endpgm
L_ss0:
    buffer_store_dwordx4 v[88:91], v11, s[56:59], s42 offen offset:0 sc1
    s_branch L_sb0
L_ss1:
    buffer_store_dwordx4 v[92:95], v11, s[56:59], s42 offen offset:1024 sc1
    s_branch L_sb1
L_ss2:
    buffer_store_dwordx4 v[104:107], v11, s[56:59], s42 offen offset:0 sc1
    s_branch L_sb2
L_ss3:
    buffer_store_dwordx4 v[108:111], v11, s[56:59], s42 offen offset:1024 sc1
    s_branch L_sb3
L_ss4:
    buffer_store_dwordx2 v[120:121], v11, s[56:59], s40 offen offset:0 sc1
    s_branch L_sb4
L_ss5:
    buffer_store_dwordx2 v[124:125], v11, s[56:59], s40 offen offset:1024 sc1
    s_branch L_sb5
L_ss6:
    buffer_store_dword v23, v21, s[56:59], s81 offen sc1
    s_branch L_sb6
L_ss7:
    buffer_store_dwordx4 v[56:59], v11, s[56:59], s41 offen offset:0 sc1
    s_branch L_sb7
L_ss8:
    buffer_store_dwordx4 v[60:63], v11, s[56:59], s41 offen offset:1024 sc1
    s_branch L_sb8
L_ss9:
    buffer_store_dwordx4 v[72:75], v11, s[56:59], s41 offen offset:0 sc1
    s_branch L_sb9
L_ss10:
    buffer_store_dwordx4 v[76:79], v11, s[56:59], s41 offen offset:1024 sc1
    s_branch L_sb10
L_ss11:
    buffer_store_dword v23, v21, s[56:59], s81 offen sc1
    s_branch L_sb11
L_ss12:
    buffer_store_dwordx4 v[248:251], v11, s[56:59], s85 offen offset:0 sc1
    s_branch L_sb12
L_ss13:
    buffer_store_dwordx4 v[252:255], v11, s[56:59], s85 offen offset:1024 sc1
    s_branch L_sb13
L_ss14:
    buffer_store_dwordx4 v[248:251], v11, s[56:59], s85 offen offset:0 sc1
    s_branch L_sb14
L_ss15:
    buffer_store_dwordx4 v[252:255], v11, s[56:59], s85 offen offset:1024 sc1
    s_branch L_sb15
L_ss16:
    buffer_store_dword v23, v21, s[56:59], s82 offen sc1
    s_branch L_sb16
.section .rodata,"a"
.p2align 6
.amdhsa_kernel fused_kernel
  .amdhsa_next_free_vgpr 256
  .amdhsa_next_free_sgpr 102
  .amdhsa_accum_offset 256
  .amdhsa_group_segment_fixed_size 0
  .amdhsa_kernarg_size 96
  .amdhsa_user_sgpr_count 2
  .amdhsa_user_sgpr_kernarg_segment_ptr 1
  .amdhsa_system_sgpr_workgroup_id_x 1
.end_amdhsa_kernel
```
